```python
import torch

def _softmax(x, axis=-1):
    return torch.softmax(x, dim=axis)
def _gelu(x):
    return torch.nn.functional.gelu(x, approximate="tanh")
def _silu(x):
    return torch.nn.functional.silu(x)
def _sigmoid(x):
    return torch.sigmoid(x)
def _layernorm(x, axis=-1, eps=1e-5):
    m = x.mean(dim=axis, keepdim=True)
    v = x.var(dim=axis, keepdim=True, unbiased=False)
    return (x - m) / torch.sqrt(v + eps)
def _scatter_add(tgt, idx, src, axis=0):
    return tgt.clone().index_add_(axis, idx, src)
def _segment_sum(src, seg, n):
    out = torch.zeros((n,) + src.shape[1:], dtype=src.dtype)
    return out.index_add_(0, seg, src)
def _pad(x, pw):
    flat = tuple(v for pair in reversed(pw) for v in pair)
    return torch.nn.functional.pad(x, flat)

kernel_name = 'standalone__mha_block_cached__near_ridge'

def setup_inputs():

    _w = (lambda a: (lambda t: t.to(torch.bfloat16) if t.is_floating_point() else t)(torch.as_tensor(a)))
    B, Sq, D = 8, 192, 448
    H, Sk, Dh = 16, 1024, 256
    return {
        "x": _w((lambda *s: torch.randn(*s, dtype=torch.bfloat16) * 0.8)(B, Sq, D)),
        "k_cache": _w((lambda *s: torch.randn(*s, dtype=torch.bfloat16) * 0.8)(B, H, Sk, Dh)),
        "v_cache": _w((lambda *s: torch.randn(*s, dtype=torch.bfloat16) * 0.05)(B, H, Sk, Dh)),
        "wq": _w((lambda *s: torch.randn(*s, dtype=torch.bfloat16) * 0.8)(D, H * Dh) * (D ** -0.5)),
        "wo": _w((lambda *s: torch.randn(*s, dtype=torch.bfloat16) * 0.05)(H * Dh, D) * ((H * Dh) ** -0.5)),
    }

def reference(x, k_cache, v_cache, wq, wo):
    B, Sq, D = x.shape
    H, Dh = 16, 256
    q = (lambda x, *d: x.permute(*d))((x @ wq).reshape(B, Sq, H, Dh), 0, 2, 1, 3)
    scores = torch.einsum("bhqd,bhkd->bhqk", q, k_cache) * (Dh ** -0.5)
    p = _softmax(scores, axis=-1)
    o = torch.einsum("bhqk,bhkd->bhqd", p, v_cache)
    return (lambda x, *d: x.permute(*d))(o, 0, 2, 1, 3).reshape(B, Sq, H * Dh) @ wo
```

```asm
; @launch kernel=attn_kernel grid=(256,1,1) block=(256,1,1) lds=163840
; @launch kernel=reduce_kernel grid=(336,1,1) block=(256,1,1) lds=0
.amdgcn_target "amdgcn-amd-amdhsa--gfx950"
.text
.globl attn_kernel
.p2align 8
.type attn_kernel,@function
attn_kernel:
    s_cmp_ge_u32 s2, 256
    s_cbranch_scc1 attn_end
    s_load_dwordx16 s[4:19], s[0:1], 0
    s_lshr_b32 s45, s2, 4
    s_lshl_b32 s45, s45, 3
    s_and_b32 s46, s2, 7
    s_add_u32 s40, s45, s46
    s_lshr_b32 s45, s2, 3
    s_and_b32 s41, s45, 1
    s_lshr_b32 s42, s40, 4
    s_and_b32 s43, s40, 15
    v_lshrrev_b32 v1, 6, v0
    s_nop 0
    v_readfirstlane_b32 s44, v1
    s_mov_b32 s50, 0x3db8aa3b
    s_mul_i32 s58, s40, 11
    s_and_b32 s58, s58, 31
    s_lshl_b32 s58, s58, 14
    s_lshl_b32 s65, s42, 1
    s_add_u32 s65, s65, s41
    s_cmp_ge_u32 s65, 14
    s_cselect_b32 s45, 14, 0
    s_sub_u32 s65, s65, s45
    s_waitcnt lgkmcnt(0)
    s_lshl_b32 s45, s40, 19
    s_add_u32 s20, s6, s45
    s_addc_u32 s21, s7, 0
    s_mov_b32 s22, 0x80000
    s_mov_b32 s23, 0x00020000
    s_add_u32 s24, s8, s45
    s_addc_u32 s25, s9, 0
    s_mov_b32 s26, 0x80000
    s_mov_b32 s27, 0x00020000
    s_mov_b32 s28, s10
    s_mov_b32 s29, s11
    s_mov_b32 s30, 0x380000
    s_mov_b32 s31, 0x00020000
    s_mov_b32 s32, s4
    s_mov_b32 s33, s5
    s_mov_b32 s34, 0x150000
    s_mov_b32 s35, 0x00020000
    s_mov_b32 s36, s18
    s_mov_b32 s37, s19
    s_mov_b32 s38, 0x1500000
    s_mov_b32 s39, 0x00020000
    s_mul_i32 s45, s43, 229376
    s_add_u32 s76, s12, s45
    s_addc_u32 s77, s13, 0
    s_mov_b32 s78, 0x38000
    s_mov_b32 s79, 0x00020000
    v_and_b32 v1, 63, v0
    v_lshrrev_b32 v2, 5, v1
    v_and_b32 v3, 31, v1
    v_add_u32 v24, 0, v2
    v_xor_b32 v24, v24, v3
    v_lshlrev_b32 v24, 4, v24
    v_lshl_add_u32 v32, v2, 9, v24
    v_add_u32 v24, 2, v2
    v_xor_b32 v24, v24, v3
    v_lshlrev_b32 v24, 4, v24
    v_lshl_add_u32 v33, v2, 9, v24
    v_add_u32 v24, 4, v2
    v_xor_b32 v24, v24, v3
    v_lshlrev_b32 v24, 4, v24
    v_lshl_add_u32 v34, v2, 9, v24
    v_add_u32 v24, 6, v2
    v_xor_b32 v24, v24, v3
    v_lshlrev_b32 v24, 4, v24
    v_lshl_add_u32 v35, v2, 9, v24
    v_add_u32 v24, 8, v2
    v_xor_b32 v24, v24, v3
    v_lshlrev_b32 v24, 4, v24
    v_lshl_add_u32 v36, v2, 9, v24
    v_add_u32 v24, 10, v2
    v_xor_b32 v24, v24, v3
    v_lshlrev_b32 v24, 4, v24
    v_lshl_add_u32 v37, v2, 9, v24
    v_add_u32 v24, 12, v2
    v_xor_b32 v24, v24, v3
    v_lshlrev_b32 v24, 4, v24
    v_lshl_add_u32 v38, v2, 9, v24
    v_add_u32 v24, 14, v2
    v_xor_b32 v24, v24, v3
    v_lshlrev_b32 v24, 4, v24
    v_lshl_add_u32 v39, v2, 9, v24
    v_add_u32 v24, 0, v2
    v_lshlrev_b32 v24, 2, v24
    v_xor_b32 v24, v24, v3
    v_lshlrev_b32 v24, 4, v24
    v_lshl_add_u32 v40, v2, 9, v24
    v_lshl_add_u32 v42, v2, 13, v24
    v_add_u32 v24, 2, v2
    v_lshlrev_b32 v24, 2, v24
    v_xor_b32 v24, v24, v3
    v_lshlrev_b32 v24, 4, v24
    v_lshl_add_u32 v41, v2, 9, v24
    v_lshl_add_u32 v43, v2, 13, v24
    s_mov_b32 s67, 0
    s_mov_b32 s83, 0
    s_mov_b32 s84, 98304
    s_lshl_b32 s85, s43, 9
    s_cmp_eq_u32 s44, 3
    s_cbranch_scc1 attn_loader
    s_mul_i32 s45, s41, 96
    s_lshl_b32 s46, s44, 5
    s_add_u32 s45, s45, s46
    s_mul_i32 s46, s42, 192
    s_add_u32 s45, s45, s46
    v_add_u32 v4, s45, v3
    s_mov_b32 s46, 896
    v_mul_lo_u32 v5, v4, s46
    v_lshl_add_u32 v5, v2, 4, v5
    s_add_u32 s66, s65, 0
    s_cmp_ge_u32 s66, 14
    s_cselect_b32 s46, 14, 0
    s_sub_u32 s66, s66, s46
    s_lshl_b32 s66, s66, 6
    buffer_load_dwordx4 a[128:131], v5, s[32:35], s66 offen offset:0
    buffer_load_dwordx4 a[132:135], v5, s[32:35], s66 offen offset:32
    s_add_u32 s66, s65, 1
    s_cmp_ge_u32 s66, 14
    s_cselect_b32 s46, 14, 0
    s_sub_u32 s66, s66, s46
    s_lshl_b32 s66, s66, 6
    buffer_load_dwordx4 a[136:139], v5, s[32:35], s66 offen offset:0
    buffer_load_dwordx4 a[140:143], v5, s[32:35], s66 offen offset:32
    s_add_u32 s66, s65, 2
    s_cmp_ge_u32 s66, 14
    s_cselect_b32 s46, 14, 0
    s_sub_u32 s66, s66, s46
    s_lshl_b32 s66, s66, 6
    buffer_load_dwordx4 a[144:147], v5, s[32:35], s66 offen offset:0
    buffer_load_dwordx4 a[148:151], v5, s[32:35], s66 offen offset:32
    s_lshl_b32 s46, s43, 9
    v_lshlrev_b32 v6, 13, v4
    v_add_u32 v6, s46, v6
    v_lshl_add_u32 v6, v2, 4, v6
    v_and_b32 v25, 15, v3
    v_add_u32 v24, 0, v2
    v_xor_b32 v24, v24, v25
    v_lshlrev_b32 v24, 4, v24
    v_lshl_add_u32 v8, v3, 9, v24
    v_add_u32 v24, 2, v2
    v_xor_b32 v24, v24, v25
    v_lshlrev_b32 v24, 4, v24
    v_lshl_add_u32 v9, v3, 9, v24
    v_add_u32 v24, 4, v2
    v_xor_b32 v24, v24, v25
    v_lshlrev_b32 v24, 4, v24
    v_lshl_add_u32 v10, v3, 9, v24
    v_add_u32 v24, 6, v2
    v_xor_b32 v24, v24, v25
    v_lshlrev_b32 v24, 4, v24
    v_lshl_add_u32 v11, v3, 9, v24
    v_add_u32 v24, 8, v2
    v_xor_b32 v24, v24, v25
    v_lshlrev_b32 v24, 4, v24
    v_lshl_add_u32 v12, v3, 9, v24
    v_add_u32 v24, 10, v2
    v_xor_b32 v24, v24, v25
    v_lshlrev_b32 v24, 4, v24
    v_lshl_add_u32 v13, v3, 9, v24
    v_add_u32 v24, 12, v2
    v_xor_b32 v24, v24, v25
    v_lshlrev_b32 v24, 4, v24
    v_lshl_add_u32 v14, v3, 9, v24
    v_add_u32 v24, 14, v2
    v_xor_b32 v24, v24, v25
    v_lshlrev_b32 v24, 4, v24
    v_lshl_add_u32 v15, v3, 9, v24
    v_lshrrev_b32 v27, 2, v1
    v_and_b32 v27, 3, v27
    v_lshrrev_b32 v24, 4, v1
    v_and_b32 v24, 1, v24
    v_and_b32 v28, 3, v1
    v_lshl_add_u32 v28, v24, 2, v28
    v_and_b32 v29, 4, v28
    v_and_b32 v24, 1, v28
    v_lshlrev_b32 v24, 1, v24
    v_or_b32 v29, v29, v24
    v_lshrrev_b32 v24, 1, v28
    v_and_b32 v24, 1, v24
    v_or_b32 v29, v29, v24
    v_xor_b32 v24, 0, v27
    v_lshlrev_b32 v24, 6, v24
    v_lshl_add_u32 v24, v29, 3, v24
    v_add_u32 v24, 98304, v24
    v_lshl_add_u32 v25, v2, 2, v27
    v_lshl_add_u32 v16, v25, 9, v24
    v_lshl_add_u32 v25, v2, 3, v27
    v_lshl_add_u32 v20, v25, 9, v24
    v_subrev_u32 v20, 98304, v20
    v_add_u32 v44, 65536, v20
    v_add_u32 v48, 131072, v20
    v_xor_b32 v24, 1, v27
    v_lshlrev_b32 v24, 6, v24
    v_lshl_add_u32 v24, v29, 3, v24
    v_add_u32 v24, 98304, v24
    v_lshl_add_u32 v25, v2, 2, v27
    v_lshl_add_u32 v17, v25, 9, v24
    v_lshl_add_u32 v25, v2, 3, v27
    v_lshl_add_u32 v21, v25, 9, v24
    v_subrev_u32 v21, 98304, v21
    v_add_u32 v45, 65536, v21
    v_add_u32 v49, 131072, v21
    v_xor_b32 v24, 2, v27
    v_lshlrev_b32 v24, 6, v24
    v_lshl_add_u32 v24, v29, 3, v24
    v_add_u32 v24, 98304, v24
    v_lshl_add_u32 v25, v2, 2, v27
    v_lshl_add_u32 v18, v25, 9, v24
    v_lshl_add_u32 v25, v2, 3, v27
    v_lshl_add_u32 v22, v25, 9, v24
    v_subrev_u32 v22, 98304, v22
    v_add_u32 v46, 65536, v22
    v_add_u32 v50, 131072, v22
    v_xor_b32 v24, 3, v27
    v_lshlrev_b32 v24, 6, v24
    v_lshl_add_u32 v24, v29, 3, v24
    v_add_u32 v24, 98304, v24
    v_lshl_add_u32 v25, v2, 2, v27
    v_lshl_add_u32 v19, v25, 9, v24
    v_lshl_add_u32 v25, v2, 3, v27
    v_lshl_add_u32 v23, v25, 9, v24
    v_subrev_u32 v23, 98304, v23
    v_add_u32 v47, 65536, v23
    v_add_u32 v51, 131072, v23
    s_mov_b32 s62, 0
    s_mov_b32 s64, 0xfffec000
    s_barrier
    ds_read_b64_tr_b16 a[0:1], v44 offset:32768
    ds_read_b64_tr_b16 a[2:3], v44 offset:34816
    ds_read_b64_tr_b16 a[4:5], v44 offset:40960
    ds_read_b64_tr_b16 a[6:7], v44 offset:43008
    ds_read_b64_tr_b16 a[8:9], v45 offset:32768
    ds_read_b64_tr_b16 a[10:11], v45 offset:34816
    ds_read_b64_tr_b16 a[12:13], v45 offset:40960
    ds_read_b64_tr_b16 a[14:15], v45 offset:43008
    ds_read_b64_tr_b16 a[16:17], v46 offset:32768
    ds_read_b64_tr_b16 a[18:19], v46 offset:34816
    ds_read_b64_tr_b16 a[20:21], v46 offset:40960
    ds_read_b64_tr_b16 a[22:23], v46 offset:43008
    ds_read_b64_tr_b16 a[24:25], v47 offset:32768
    ds_read_b64_tr_b16 a[26:27], v47 offset:34816
    ds_read_b64_tr_b16 a[28:29], v47 offset:40960
    ds_read_b64_tr_b16 a[30:31], v47 offset:43008
    ds_read_b64_tr_b16 a[32:33], v44 offset:33024
    ds_read_b64_tr_b16 a[34:35], v44 offset:35072
    ds_read_b64_tr_b16 a[36:37], v44 offset:41216
    ds_read_b64_tr_b16 a[38:39], v44 offset:43264
    ds_read_b64_tr_b16 a[40:41], v45 offset:33024
    ds_read_b64_tr_b16 a[42:43], v45 offset:35072
    ds_read_b64_tr_b16 a[44:45], v45 offset:41216
    ds_read_b64_tr_b16 a[46:47], v45 offset:43264
    ds_read_b64_tr_b16 a[48:49], v46 offset:33024
    ds_read_b64_tr_b16 a[50:51], v46 offset:35072
    ds_read_b64_tr_b16 a[52:53], v46 offset:41216
    ds_read_b64_tr_b16 a[54:55], v46 offset:43264
    ds_read_b64_tr_b16 a[56:57], v47 offset:33024
    ds_read_b64_tr_b16 a[58:59], v47 offset:35072
    ds_read_b64_tr_b16 a[60:61], v47 offset:41216
    ds_read_b64_tr_b16 a[62:63], v47 offset:43264
    s_add_u32 s66, s65, 3
    s_cmp_ge_u32 s66, 14
    s_cselect_b32 s46, 14, 0
    s_sub_u32 s66, s66, s46
    s_lshl_b32 s66, s66, 6
    buffer_load_dwordx4 a[152:155], v5, s[32:35], s66 offen offset:0
    buffer_load_dwordx4 a[156:159], v5, s[32:35], s66 offen offset:32
    s_waitcnt vmcnt(7) lgkmcnt(15)
    v_mfma_f32_32x32x16_bf16 v[128:143], a[0:3], a[128:131], 0
    ds_read_b64_tr_b16 a[64:65], v44 offset:49152
    ds_read_b64_tr_b16 a[66:67], v44 offset:51200
    s_waitcnt vmcnt(6)
    v_mfma_f32_32x32x16_bf16 v[128:143], a[4:7], a[132:135], v[128:143]
    ds_read_b64_tr_b16 a[68:69], v44 offset:57344
    ds_read_b64_tr_b16 a[70:71], v44 offset:59392
    v_mfma_f32_32x32x16_bf16 v[144:159], a[8:11], a[128:131], 0
    ds_read_b64_tr_b16 a[72:73], v45 offset:49152
    ds_read_b64_tr_b16 a[74:75], v45 offset:51200
    v_mfma_f32_32x32x16_bf16 v[144:159], a[12:15], a[132:135], v[144:159]
    ds_read_b64_tr_b16 a[76:77], v45 offset:57344
    ds_read_b64_tr_b16 a[78:79], v45 offset:59392
    v_mfma_f32_32x32x16_bf16 v[160:175], a[16:19], a[128:131], 0
    ds_read_b64_tr_b16 a[80:81], v46 offset:49152
    ds_read_b64_tr_b16 a[82:83], v46 offset:51200
    v_mfma_f32_32x32x16_bf16 v[160:175], a[20:23], a[132:135], v[160:175]
    ds_read_b64_tr_b16 a[84:85], v46 offset:57344
    ds_read_b64_tr_b16 a[86:87], v46 offset:59392
    v_mfma_f32_32x32x16_bf16 v[176:191], a[24:27], a[128:131], 0
    ds_read_b64_tr_b16 a[88:89], v47 offset:49152
    ds_read_b64_tr_b16 a[90:91], v47 offset:51200
    v_mfma_f32_32x32x16_bf16 v[176:191], a[28:31], a[132:135], v[176:191]
    ds_read_b64_tr_b16 a[92:93], v47 offset:57344
    ds_read_b64_tr_b16 a[94:95], v47 offset:59392
    s_waitcnt lgkmcnt(15)
    v_mfma_f32_32x32x16_bf16 v[192:207], a[32:35], a[128:131], 0
    ds_read_b64_tr_b16 a[96:97], v44 offset:49408
    ds_read_b64_tr_b16 a[98:99], v44 offset:51456
    v_mfma_f32_32x32x16_bf16 v[192:207], a[36:39], a[132:135], v[192:207]
    ds_read_b64_tr_b16 a[100:101], v44 offset:57600
    ds_read_b64_tr_b16 a[102:103], v44 offset:59648
    v_mfma_f32_32x32x16_bf16 v[208:223], a[40:43], a[128:131], 0
    ds_read_b64_tr_b16 a[104:105], v45 offset:49408
    ds_read_b64_tr_b16 a[106:107], v45 offset:51456
    v_mfma_f32_32x32x16_bf16 v[208:223], a[44:47], a[132:135], v[208:223]
    ds_read_b64_tr_b16 a[108:109], v45 offset:57600
    ds_read_b64_tr_b16 a[110:111], v45 offset:59648
    v_mfma_f32_32x32x16_bf16 v[224:239], a[48:51], a[128:131], 0
    ds_read_b64_tr_b16 a[112:113], v46 offset:49408
    ds_read_b64_tr_b16 a[114:115], v46 offset:51456
    v_mfma_f32_32x32x16_bf16 v[224:239], a[52:55], a[132:135], v[224:239]
    ds_read_b64_tr_b16 a[116:117], v46 offset:57600
    ds_read_b64_tr_b16 a[118:119], v46 offset:59648
    v_mfma_f32_32x32x16_bf16 v[240:255], a[56:59], a[128:131], 0
    ds_read_b64_tr_b16 a[120:121], v47 offset:49408
    ds_read_b64_tr_b16 a[122:123], v47 offset:51456
    v_mfma_f32_32x32x16_bf16 v[240:255], a[60:63], a[132:135], v[240:255]
    ds_read_b64_tr_b16 a[124:125], v47 offset:57600
    ds_read_b64_tr_b16 a[126:127], v47 offset:59648
    s_waitcnt lgkmcnt(0)
    s_barrier
    s_add_u32 s66, s65, 4
    s_cmp_ge_u32 s66, 14
    s_cselect_b32 s46, 14, 0
    s_sub_u32 s66, s66, s46
    s_lshl_b32 s66, s66, 6
    buffer_load_dwordx4 a[160:163], v5, s[32:35], s66 offen offset:0
    buffer_load_dwordx4 a[164:167], v5, s[32:35], s66 offen offset:32
    s_waitcnt vmcnt(7)
    v_mfma_f32_32x32x16_bf16 v[128:143], a[64:67], a[136:139], v[128:143]
    ds_read_b64_tr_b16 a[0:1], v48 offset:0
    ds_read_b64_tr_b16 a[2:3], v48 offset:2048
    s_waitcnt vmcnt(6)
    v_mfma_f32_32x32x16_bf16 v[128:143], a[68:71], a[140:143], v[128:143]
    ds_read_b64_tr_b16 a[4:5], v48 offset:8192
    ds_read_b64_tr_b16 a[6:7], v48 offset:10240
    v_mfma_f32_32x32x16_bf16 v[144:159], a[72:75], a[136:139], v[144:159]
    ds_read_b64_tr_b16 a[8:9], v49 offset:0
    ds_read_b64_tr_b16 a[10:11], v49 offset:2048
    v_mfma_f32_32x32x16_bf16 v[144:159], a[76:79], a[140:143], v[144:159]
    ds_read_b64_tr_b16 a[12:13], v49 offset:8192
    ds_read_b64_tr_b16 a[14:15], v49 offset:10240
    v_mfma_f32_32x32x16_bf16 v[160:175], a[80:83], a[136:139], v[160:175]
    ds_read_b64_tr_b16 a[16:17], v50 offset:0
    ds_read_b64_tr_b16 a[18:19], v50 offset:2048
    v_mfma_f32_32x32x16_bf16 v[160:175], a[84:87], a[140:143], v[160:175]
    ds_read_b64_tr_b16 a[20:21], v50 offset:8192
    ds_read_b64_tr_b16 a[22:23], v50 offset:10240
    v_mfma_f32_32x32x16_bf16 v[176:191], a[88:91], a[136:139], v[176:191]
    ds_read_b64_tr_b16 a[24:25], v51 offset:0
    ds_read_b64_tr_b16 a[26:27], v51 offset:2048
    v_mfma_f32_32x32x16_bf16 v[176:191], a[92:95], a[140:143], v[176:191]
    ds_read_b64_tr_b16 a[28:29], v51 offset:8192
    ds_read_b64_tr_b16 a[30:31], v51 offset:10240
    v_mfma_f32_32x32x16_bf16 v[192:207], a[96:99], a[136:139], v[192:207]
    ds_read_b64_tr_b16 a[32:33], v48 offset:256
    ds_read_b64_tr_b16 a[34:35], v48 offset:2304
    v_mfma_f32_32x32x16_bf16 v[192:207], a[100:103], a[140:143], v[192:207]
    ds_read_b64_tr_b16 a[36:37], v48 offset:8448
    ds_read_b64_tr_b16 a[38:39], v48 offset:10496
    v_mfma_f32_32x32x16_bf16 v[208:223], a[104:107], a[136:139], v[208:223]
    ds_read_b64_tr_b16 a[40:41], v49 offset:256
    ds_read_b64_tr_b16 a[42:43], v49 offset:2304
    v_mfma_f32_32x32x16_bf16 v[208:223], a[108:111], a[140:143], v[208:223]
    ds_read_b64_tr_b16 a[44:45], v49 offset:8448
    ds_read_b64_tr_b16 a[46:47], v49 offset:10496
    v_mfma_f32_32x32x16_bf16 v[224:239], a[112:115], a[136:139], v[224:239]
    ds_read_b64_tr_b16 a[48:49], v50 offset:256
    ds_read_b64_tr_b16 a[50:51], v50 offset:2304
    v_mfma_f32_32x32x16_bf16 v[224:239], a[116:119], a[140:143], v[224:239]
    ds_read_b64_tr_b16 a[52:53], v50 offset:8448
    ds_read_b64_tr_b16 a[54:55], v50 offset:10496
    v_mfma_f32_32x32x16_bf16 v[240:255], a[120:123], a[136:139], v[240:255]
    ds_read_b64_tr_b16 a[56:57], v51 offset:256
    ds_read_b64_tr_b16 a[58:59], v51 offset:2304
    v_mfma_f32_32x32x16_bf16 v[240:255], a[124:127], a[140:143], v[240:255]
    ds_read_b64_tr_b16 a[60:61], v51 offset:8448
    ds_read_b64_tr_b16 a[62:63], v51 offset:10496
    s_waitcnt lgkmcnt(0)
    s_barrier
    s_add_u32 s66, s65, 5
    s_cmp_ge_u32 s66, 14
    s_cselect_b32 s46, 14, 0
    s_sub_u32 s66, s66, s46
    s_lshl_b32 s66, s66, 6
    buffer_load_dwordx4 a[168:171], v5, s[32:35], s66 offen offset:0
    buffer_load_dwordx4 a[172:175], v5, s[32:35], s66 offen offset:32
    s_waitcnt vmcnt(7)
    v_mfma_f32_32x32x16_bf16 v[128:143], a[0:3], a[144:147], v[128:143]
    ds_read_b64_tr_b16 a[64:65], v48 offset:16384
    ds_read_b64_tr_b16 a[66:67], v48 offset:18432
    s_waitcnt vmcnt(6)
    v_mfma_f32_32x32x16_bf16 v[128:143], a[4:7], a[148:151], v[128:143]
    ds_read_b64_tr_b16 a[68:69], v48 offset:24576
    ds_read_b64_tr_b16 a[70:71], v48 offset:26624
    v_mfma_f32_32x32x16_bf16 v[144:159], a[8:11], a[144:147], v[144:159]
    ds_read_b64_tr_b16 a[72:73], v49 offset:16384
    ds_read_b64_tr_b16 a[74:75], v49 offset:18432
    v_mfma_f32_32x32x16_bf16 v[144:159], a[12:15], a[148:151], v[144:159]
    ds_read_b64_tr_b16 a[76:77], v49 offset:24576
    ds_read_b64_tr_b16 a[78:79], v49 offset:26624
    v_mfma_f32_32x32x16_bf16 v[160:175], a[16:19], a[144:147], v[160:175]
    ds_read_b64_tr_b16 a[80:81], v50 offset:16384
    ds_read_b64_tr_b16 a[82:83], v50 offset:18432
    v_mfma_f32_32x32x16_bf16 v[160:175], a[20:23], a[148:151], v[160:175]
    ds_read_b64_tr_b16 a[84:85], v50 offset:24576
    ds_read_b64_tr_b16 a[86:87], v50 offset:26624
    v_mfma_f32_32x32x16_bf16 v[176:191], a[24:27], a[144:147], v[176:191]
    ds_read_b64_tr_b16 a[88:89], v51 offset:16384
    ds_read_b64_tr_b16 a[90:91], v51 offset:18432
    v_mfma_f32_32x32x16_bf16 v[176:191], a[28:31], a[148:151], v[176:191]
    ds_read_b64_tr_b16 a[92:93], v51 offset:24576
    ds_read_b64_tr_b16 a[94:95], v51 offset:26624
    v_mfma_f32_32x32x16_bf16 v[192:207], a[32:35], a[144:147], v[192:207]
    ds_read_b64_tr_b16 a[96:97], v48 offset:16640
    ds_read_b64_tr_b16 a[98:99], v48 offset:18688
    v_mfma_f32_32x32x16_bf16 v[192:207], a[36:39], a[148:151], v[192:207]
    ds_read_b64_tr_b16 a[100:101], v48 offset:24832
    ds_read_b64_tr_b16 a[102:103], v48 offset:26880
    v_mfma_f32_32x32x16_bf16 v[208:223], a[40:43], a[144:147], v[208:223]
    ds_read_b64_tr_b16 a[104:105], v49 offset:16640
    ds_read_b64_tr_b16 a[106:107], v49 offset:18688
    v_mfma_f32_32x32x16_bf16 v[208:223], a[44:47], a[148:151], v[208:223]
    ds_read_b64_tr_b16 a[108:109], v49 offset:24832
    ds_read_b64_tr_b16 a[110:111], v49 offset:26880
    v_mfma_f32_32x32x16_bf16 v[224:239], a[48:51], a[144:147], v[224:239]
    ds_read_b64_tr_b16 a[112:113], v50 offset:16640
    ds_read_b64_tr_b16 a[114:115], v50 offset:18688
    v_mfma_f32_32x32x16_bf16 v[224:239], a[52:55], a[148:151], v[224:239]
    ds_read_b64_tr_b16 a[116:117], v50 offset:24832
    ds_read_b64_tr_b16 a[118:119], v50 offset:26880
    v_mfma_f32_32x32x16_bf16 v[240:255], a[56:59], a[144:147], v[240:255]
    ds_read_b64_tr_b16 a[120:121], v51 offset:16640
    ds_read_b64_tr_b16 a[122:123], v51 offset:18688
    v_mfma_f32_32x32x16_bf16 v[240:255], a[60:63], a[148:151], v[240:255]
    ds_read_b64_tr_b16 a[124:125], v51 offset:24832
    ds_read_b64_tr_b16 a[126:127], v51 offset:26880
    s_waitcnt lgkmcnt(0)
    s_barrier
    s_add_u32 s66, s65, 6
    s_cmp_ge_u32 s66, 14
    s_cselect_b32 s46, 14, 0
    s_sub_u32 s66, s66, s46
    s_lshl_b32 s66, s66, 6
    buffer_load_dwordx4 a[176:179], v5, s[32:35], s66 offen offset:0
    buffer_load_dwordx4 a[180:183], v5, s[32:35], s66 offen offset:32
    s_waitcnt vmcnt(7)
    v_mfma_f32_32x32x16_bf16 v[128:143], a[64:67], a[152:155], v[128:143]
    ds_read_b64_tr_b16 a[0:1], v44 offset:32768
    ds_read_b64_tr_b16 a[2:3], v44 offset:34816
    s_waitcnt vmcnt(6)
    v_mfma_f32_32x32x16_bf16 v[128:143], a[68:71], a[156:159], v[128:143]
    ds_read_b64_tr_b16 a[4:5], v44 offset:40960
    ds_read_b64_tr_b16 a[6:7], v44 offset:43008
    v_mfma_f32_32x32x16_bf16 v[144:159], a[72:75], a[152:155], v[144:159]
    ds_read_b64_tr_b16 a[8:9], v45 offset:32768
    ds_read_b64_tr_b16 a[10:11], v45 offset:34816
    v_mfma_f32_32x32x16_bf16 v[144:159], a[76:79], a[156:159], v[144:159]
    ds_read_b64_tr_b16 a[12:13], v45 offset:40960
    ds_read_b64_tr_b16 a[14:15], v45 offset:43008
    v_mfma_f32_32x32x16_bf16 v[160:175], a[80:83], a[152:155], v[160:175]
    ds_read_b64_tr_b16 a[16:17], v46 offset:32768
    ds_read_b64_tr_b16 a[18:19], v46 offset:34816
    v_mfma_f32_32x32x16_bf16 v[160:175], a[84:87], a[156:159], v[160:175]
    ds_read_b64_tr_b16 a[20:21], v46 offset:40960
    ds_read_b64_tr_b16 a[22:23], v46 offset:43008
    v_mfma_f32_32x32x16_bf16 v[176:191], a[88:91], a[152:155], v[176:191]
    ds_read_b64_tr_b16 a[24:25], v47 offset:32768
    ds_read_b64_tr_b16 a[26:27], v47 offset:34816
    v_mfma_f32_32x32x16_bf16 v[176:191], a[92:95], a[156:159], v[176:191]
    ds_read_b64_tr_b16 a[28:29], v47 offset:40960
    ds_read_b64_tr_b16 a[30:31], v47 offset:43008
    v_mfma_f32_32x32x16_bf16 v[192:207], a[96:99], a[152:155], v[192:207]
    ds_read_b64_tr_b16 a[32:33], v44 offset:33024
    ds_read_b64_tr_b16 a[34:35], v44 offset:35072
    v_mfma_f32_32x32x16_bf16 v[192:207], a[100:103], a[156:159], v[192:207]
    ds_read_b64_tr_b16 a[36:37], v44 offset:41216
    ds_read_b64_tr_b16 a[38:39], v44 offset:43264
    v_mfma_f32_32x32x16_bf16 v[208:223], a[104:107], a[152:155], v[208:223]
    ds_read_b64_tr_b16 a[40:41], v45 offset:33024
    ds_read_b64_tr_b16 a[42:43], v45 offset:35072
    v_mfma_f32_32x32x16_bf16 v[208:223], a[108:111], a[156:159], v[208:223]
    ds_read_b64_tr_b16 a[44:45], v45 offset:41216
    ds_read_b64_tr_b16 a[46:47], v45 offset:43264
    v_mfma_f32_32x32x16_bf16 v[224:239], a[112:115], a[152:155], v[224:239]
    ds_read_b64_tr_b16 a[48:49], v46 offset:33024
    ds_read_b64_tr_b16 a[50:51], v46 offset:35072
    v_mfma_f32_32x32x16_bf16 v[224:239], a[116:119], a[156:159], v[224:239]
    ds_read_b64_tr_b16 a[52:53], v46 offset:41216
    ds_read_b64_tr_b16 a[54:55], v46 offset:43264
    v_mfma_f32_32x32x16_bf16 v[240:255], a[120:123], a[152:155], v[240:255]
    ds_read_b64_tr_b16 a[56:57], v47 offset:33024
    ds_read_b64_tr_b16 a[58:59], v47 offset:35072
    v_mfma_f32_32x32x16_bf16 v[240:255], a[124:127], a[156:159], v[240:255]
    ds_read_b64_tr_b16 a[60:61], v47 offset:41216
    ds_read_b64_tr_b16 a[62:63], v47 offset:43264
    s_waitcnt lgkmcnt(0)
    s_barrier
    s_add_u32 s66, s65, 7
    s_cmp_ge_u32 s66, 14
    s_cselect_b32 s46, 14, 0
    s_sub_u32 s66, s66, s46
    s_lshl_b32 s66, s66, 6
    buffer_load_dwordx4 a[184:187], v5, s[32:35], s66 offen offset:0
    buffer_load_dwordx4 a[188:191], v5, s[32:35], s66 offen offset:32
    s_waitcnt vmcnt(7)
    v_mfma_f32_32x32x16_bf16 v[128:143], a[0:3], a[160:163], v[128:143]
    ds_read_b64_tr_b16 a[64:65], v44 offset:49152
    ds_read_b64_tr_b16 a[66:67], v44 offset:51200
    s_waitcnt vmcnt(6)
    v_mfma_f32_32x32x16_bf16 v[128:143], a[4:7], a[164:167], v[128:143]
    ds_read_b64_tr_b16 a[68:69], v44 offset:57344
    ds_read_b64_tr_b16 a[70:71], v44 offset:59392
    v_mfma_f32_32x32x16_bf16 v[144:159], a[8:11], a[160:163], v[144:159]
    ds_read_b64_tr_b16 a[72:73], v45 offset:49152
    ds_read_b64_tr_b16 a[74:75], v45 offset:51200
    v_mfma_f32_32x32x16_bf16 v[144:159], a[12:15], a[164:167], v[144:159]
    ds_read_b64_tr_b16 a[76:77], v45 offset:57344
    ds_read_b64_tr_b16 a[78:79], v45 offset:59392
    v_mfma_f32_32x32x16_bf16 v[160:175], a[16:19], a[160:163], v[160:175]
    ds_read_b64_tr_b16 a[80:81], v46 offset:49152
    ds_read_b64_tr_b16 a[82:83], v46 offset:51200
    v_mfma_f32_32x32x16_bf16 v[160:175], a[20:23], a[164:167], v[160:175]
    ds_read_b64_tr_b16 a[84:85], v46 offset:57344
    ds_read_b64_tr_b16 a[86:87], v46 offset:59392
    v_mfma_f32_32x32x16_bf16 v[176:191], a[24:27], a[160:163], v[176:191]
    ds_read_b64_tr_b16 a[88:89], v47 offset:49152
    ds_read_b64_tr_b16 a[90:91], v47 offset:51200
    v_mfma_f32_32x32x16_bf16 v[176:191], a[28:31], a[164:167], v[176:191]
    ds_read_b64_tr_b16 a[92:93], v47 offset:57344
    ds_read_b64_tr_b16 a[94:95], v47 offset:59392
    v_mfma_f32_32x32x16_bf16 v[192:207], a[32:35], a[160:163], v[192:207]
    ds_read_b64_tr_b16 a[96:97], v44 offset:49408
    ds_read_b64_tr_b16 a[98:99], v44 offset:51456
    v_mfma_f32_32x32x16_bf16 v[192:207], a[36:39], a[164:167], v[192:207]
    ds_read_b64_tr_b16 a[100:101], v44 offset:57600
    ds_read_b64_tr_b16 a[102:103], v44 offset:59648
    v_mfma_f32_32x32x16_bf16 v[208:223], a[40:43], a[160:163], v[208:223]
    ds_read_b64_tr_b16 a[104:105], v45 offset:49408
    ds_read_b64_tr_b16 a[106:107], v45 offset:51456
    v_mfma_f32_32x32x16_bf16 v[208:223], a[44:47], a[164:167], v[208:223]
    ds_read_b64_tr_b16 a[108:109], v45 offset:57600
    ds_read_b64_tr_b16 a[110:111], v45 offset:59648
    v_mfma_f32_32x32x16_bf16 v[224:239], a[48:51], a[160:163], v[224:239]
    ds_read_b64_tr_b16 a[112:113], v46 offset:49408
    ds_read_b64_tr_b16 a[114:115], v46 offset:51456
    v_mfma_f32_32x32x16_bf16 v[224:239], a[52:55], a[164:167], v[224:239]
    ds_read_b64_tr_b16 a[116:117], v46 offset:57600
    ds_read_b64_tr_b16 a[118:119], v46 offset:59648
    v_mfma_f32_32x32x16_bf16 v[240:255], a[56:59], a[160:163], v[240:255]
    ds_read_b64_tr_b16 a[120:121], v47 offset:49408
    ds_read_b64_tr_b16 a[122:123], v47 offset:51456
    v_mfma_f32_32x32x16_bf16 v[240:255], a[60:63], a[164:167], v[240:255]
    ds_read_b64_tr_b16 a[124:125], v47 offset:57600
    ds_read_b64_tr_b16 a[126:127], v47 offset:59648
    s_waitcnt lgkmcnt(0)
    s_barrier
    s_add_u32 s66, s65, 8
    s_cmp_ge_u32 s66, 14
    s_cselect_b32 s46, 14, 0
    s_sub_u32 s66, s66, s46
    s_lshl_b32 s66, s66, 6
    buffer_load_dwordx4 a[192:195], v5, s[32:35], s66 offen offset:0
    buffer_load_dwordx4 a[196:199], v5, s[32:35], s66 offen offset:32
    s_waitcnt vmcnt(7)
    v_mfma_f32_32x32x16_bf16 v[128:143], a[64:67], a[168:171], v[128:143]
    ds_read_b64_tr_b16 a[0:1], v48 offset:0
    ds_read_b64_tr_b16 a[2:3], v48 offset:2048
    s_waitcnt vmcnt(6)
    v_mfma_f32_32x32x16_bf16 v[128:143], a[68:71], a[172:175], v[128:143]
    ds_read_b64_tr_b16 a[4:5], v48 offset:8192
    ds_read_b64_tr_b16 a[6:7], v48 offset:10240
    v_mfma_f32_32x32x16_bf16 v[144:159], a[72:75], a[168:171], v[144:159]
    ds_read_b64_tr_b16 a[8:9], v49 offset:0
    ds_read_b64_tr_b16 a[10:11], v49 offset:2048
    v_mfma_f32_32x32x16_bf16 v[144:159], a[76:79], a[172:175], v[144:159]
    ds_read_b64_tr_b16 a[12:13], v49 offset:8192
    ds_read_b64_tr_b16 a[14:15], v49 offset:10240
    v_mfma_f32_32x32x16_bf16 v[160:175], a[80:83], a[168:171], v[160:175]
    ds_read_b64_tr_b16 a[16:17], v50 offset:0
    ds_read_b64_tr_b16 a[18:19], v50 offset:2048
    v_mfma_f32_32x32x16_bf16 v[160:175], a[84:87], a[172:175], v[160:175]
    ds_read_b64_tr_b16 a[20:21], v50 offset:8192
    ds_read_b64_tr_b16 a[22:23], v50 offset:10240
    v_mfma_f32_32x32x16_bf16 v[176:191], a[88:91], a[168:171], v[176:191]
    ds_read_b64_tr_b16 a[24:25], v51 offset:0
    ds_read_b64_tr_b16 a[26:27], v51 offset:2048
    v_mfma_f32_32x32x16_bf16 v[176:191], a[92:95], a[172:175], v[176:191]
    ds_read_b64_tr_b16 a[28:29], v51 offset:8192
    ds_read_b64_tr_b16 a[30:31], v51 offset:10240
    v_mfma_f32_32x32x16_bf16 v[192:207], a[96:99], a[168:171], v[192:207]
    ds_read_b64_tr_b16 a[32:33], v48 offset:256
    ds_read_b64_tr_b16 a[34:35], v48 offset:2304
    v_mfma_f32_32x32x16_bf16 v[192:207], a[100:103], a[172:175], v[192:207]
    ds_read_b64_tr_b16 a[36:37], v48 offset:8448
    ds_read_b64_tr_b16 a[38:39], v48 offset:10496
    v_mfma_f32_32x32x16_bf16 v[208:223], a[104:107], a[168:171], v[208:223]
    ds_read_b64_tr_b16 a[40:41], v49 offset:256
    ds_read_b64_tr_b16 a[42:43], v49 offset:2304
    v_mfma_f32_32x32x16_bf16 v[208:223], a[108:111], a[172:175], v[208:223]
    ds_read_b64_tr_b16 a[44:45], v49 offset:8448
    ds_read_b64_tr_b16 a[46:47], v49 offset:10496
    v_mfma_f32_32x32x16_bf16 v[224:239], a[112:115], a[168:171], v[224:239]
    ds_read_b64_tr_b16 a[48:49], v50 offset:256
    ds_read_b64_tr_b16 a[50:51], v50 offset:2304
    v_mfma_f32_32x32x16_bf16 v[224:239], a[116:119], a[172:175], v[224:239]
    ds_read_b64_tr_b16 a[52:53], v50 offset:8448
    ds_read_b64_tr_b16 a[54:55], v50 offset:10496
    v_mfma_f32_32x32x16_bf16 v[240:255], a[120:123], a[168:171], v[240:255]
    ds_read_b64_tr_b16 a[56:57], v51 offset:256
    ds_read_b64_tr_b16 a[58:59], v51 offset:2304
    v_mfma_f32_32x32x16_bf16 v[240:255], a[124:127], a[172:175], v[240:255]
    ds_read_b64_tr_b16 a[60:61], v51 offset:8448
    ds_read_b64_tr_b16 a[62:63], v51 offset:10496
    s_waitcnt lgkmcnt(0)
    s_barrier
    s_add_u32 s66, s65, 9
    s_cmp_ge_u32 s66, 14
    s_cselect_b32 s46, 14, 0
    s_sub_u32 s66, s66, s46
    s_lshl_b32 s66, s66, 6
    buffer_load_dwordx4 a[200:203], v5, s[32:35], s66 offen offset:0
    buffer_load_dwordx4 a[204:207], v5, s[32:35], s66 offen offset:32
    s_waitcnt vmcnt(7)
    v_mfma_f32_32x32x16_bf16 v[128:143], a[0:3], a[176:179], v[128:143]
    ds_read_b64_tr_b16 a[64:65], v48 offset:16384
    ds_read_b64_tr_b16 a[66:67], v48 offset:18432
    s_waitcnt vmcnt(6)
    v_mfma_f32_32x32x16_bf16 v[128:143], a[4:7], a[180:183], v[128:143]
    ds_read_b64_tr_b16 a[68:69], v48 offset:24576
    ds_read_b64_tr_b16 a[70:71], v48 offset:26624
    v_mfma_f32_32x32x16_bf16 v[144:159], a[8:11], a[176:179], v[144:159]
    ds_read_b64_tr_b16 a[72:73], v49 offset:16384
    ds_read_b64_tr_b16 a[74:75], v49 offset:18432
    v_mfma_f32_32x32x16_bf16 v[144:159], a[12:15], a[180:183], v[144:159]
    ds_read_b64_tr_b16 a[76:77], v49 offset:24576
    ds_read_b64_tr_b16 a[78:79], v49 offset:26624
    v_mfma_f32_32x32x16_bf16 v[160:175], a[16:19], a[176:179], v[160:175]
    ds_read_b64_tr_b16 a[80:81], v50 offset:16384
    ds_read_b64_tr_b16 a[82:83], v50 offset:18432
    v_mfma_f32_32x32x16_bf16 v[160:175], a[20:23], a[180:183], v[160:175]
    ds_read_b64_tr_b16 a[84:85], v50 offset:24576
    ds_read_b64_tr_b16 a[86:87], v50 offset:26624
    v_mfma_f32_32x32x16_bf16 v[176:191], a[24:27], a[176:179], v[176:191]
    ds_read_b64_tr_b16 a[88:89], v51 offset:16384
    ds_read_b64_tr_b16 a[90:91], v51 offset:18432
    v_mfma_f32_32x32x16_bf16 v[176:191], a[28:31], a[180:183], v[176:191]
    ds_read_b64_tr_b16 a[92:93], v51 offset:24576
    ds_read_b64_tr_b16 a[94:95], v51 offset:26624
    v_mfma_f32_32x32x16_bf16 v[192:207], a[32:35], a[176:179], v[192:207]
    ds_read_b64_tr_b16 a[96:97], v48 offset:16640
    ds_read_b64_tr_b16 a[98:99], v48 offset:18688
    v_mfma_f32_32x32x16_bf16 v[192:207], a[36:39], a[180:183], v[192:207]
    ds_read_b64_tr_b16 a[100:101], v48 offset:24832
    ds_read_b64_tr_b16 a[102:103], v48 offset:26880
    v_mfma_f32_32x32x16_bf16 v[208:223], a[40:43], a[176:179], v[208:223]
    ds_read_b64_tr_b16 a[104:105], v49 offset:16640
    ds_read_b64_tr_b16 a[106:107], v49 offset:18688
    v_mfma_f32_32x32x16_bf16 v[208:223], a[44:47], a[180:183], v[208:223]
    ds_read_b64_tr_b16 a[108:109], v49 offset:24832
    ds_read_b64_tr_b16 a[110:111], v49 offset:26880
    v_mfma_f32_32x32x16_bf16 v[224:239], a[48:51], a[176:179], v[224:239]
    ds_read_b64_tr_b16 a[112:113], v50 offset:16640
    ds_read_b64_tr_b16 a[114:115], v50 offset:18688
    v_mfma_f32_32x32x16_bf16 v[224:239], a[52:55], a[180:183], v[224:239]
    ds_read_b64_tr_b16 a[116:117], v50 offset:24832
    ds_read_b64_tr_b16 a[118:119], v50 offset:26880
    v_mfma_f32_32x32x16_bf16 v[240:255], a[56:59], a[176:179], v[240:255]
    ds_read_b64_tr_b16 a[120:121], v51 offset:16640
    ds_read_b64_tr_b16 a[122:123], v51 offset:18688
    v_mfma_f32_32x32x16_bf16 v[240:255], a[60:63], a[180:183], v[240:255]
    ds_read_b64_tr_b16 a[124:125], v51 offset:24832
    ds_read_b64_tr_b16 a[126:127], v51 offset:26880
    s_waitcnt lgkmcnt(0)
    s_barrier
    s_add_u32 s66, s65, 10
    s_cmp_ge_u32 s66, 14
    s_cselect_b32 s46, 14, 0
    s_sub_u32 s66, s66, s46
    s_lshl_b32 s66, s66, 6
    buffer_load_dwordx4 a[208:211], v5, s[32:35], s66 offen offset:0
    buffer_load_dwordx4 a[212:215], v5, s[32:35], s66 offen offset:32
    s_waitcnt vmcnt(7)
    v_mfma_f32_32x32x16_bf16 v[128:143], a[64:67], a[184:187], v[128:143]
    ds_read_b64_tr_b16 a[0:1], v44 offset:32768
    ds_read_b64_tr_b16 a[2:3], v44 offset:34816
    s_waitcnt vmcnt(6)
    v_mfma_f32_32x32x16_bf16 v[128:143], a[68:71], a[188:191], v[128:143]
    ds_read_b64_tr_b16 a[4:5], v44 offset:40960
    ds_read_b64_tr_b16 a[6:7], v44 offset:43008
    v_mfma_f32_32x32x16_bf16 v[144:159], a[72:75], a[184:187], v[144:159]
    ds_read_b64_tr_b16 a[8:9], v45 offset:32768
    ds_read_b64_tr_b16 a[10:11], v45 offset:34816
    v_mfma_f32_32x32x16_bf16 v[144:159], a[76:79], a[188:191], v[144:159]
    ds_read_b64_tr_b16 a[12:13], v45 offset:40960
    ds_read_b64_tr_b16 a[14:15], v45 offset:43008
    v_mfma_f32_32x32x16_bf16 v[160:175], a[80:83], a[184:187], v[160:175]
    ds_read_b64_tr_b16 a[16:17], v46 offset:32768
    ds_read_b64_tr_b16 a[18:19], v46 offset:34816
    v_mfma_f32_32x32x16_bf16 v[160:175], a[84:87], a[188:191], v[160:175]
    ds_read_b64_tr_b16 a[20:21], v46 offset:40960
    ds_read_b64_tr_b16 a[22:23], v46 offset:43008
    v_mfma_f32_32x32x16_bf16 v[176:191], a[88:91], a[184:187], v[176:191]
    ds_read_b64_tr_b16 a[24:25], v47 offset:32768
    ds_read_b64_tr_b16 a[26:27], v47 offset:34816
    v_mfma_f32_32x32x16_bf16 v[176:191], a[92:95], a[188:191], v[176:191]
    ds_read_b64_tr_b16 a[28:29], v47 offset:40960
    ds_read_b64_tr_b16 a[30:31], v47 offset:43008
    v_mfma_f32_32x32x16_bf16 v[192:207], a[96:99], a[184:187], v[192:207]
    ds_read_b64_tr_b16 a[32:33], v44 offset:33024
    ds_read_b64_tr_b16 a[34:35], v44 offset:35072
    v_mfma_f32_32x32x16_bf16 v[192:207], a[100:103], a[188:191], v[192:207]
    ds_read_b64_tr_b16 a[36:37], v44 offset:41216
    ds_read_b64_tr_b16 a[38:39], v44 offset:43264
    v_mfma_f32_32x32x16_bf16 v[208:223], a[104:107], a[184:187], v[208:223]
    ds_read_b64_tr_b16 a[40:41], v45 offset:33024
    ds_read_b64_tr_b16 a[42:43], v45 offset:35072
    v_mfma_f32_32x32x16_bf16 v[208:223], a[108:111], a[188:191], v[208:223]
    ds_read_b64_tr_b16 a[44:45], v45 offset:41216
    ds_read_b64_tr_b16 a[46:47], v45 offset:43264
    v_mfma_f32_32x32x16_bf16 v[224:239], a[112:115], a[184:187], v[224:239]
    ds_read_b64_tr_b16 a[48:49], v46 offset:33024
    ds_read_b64_tr_b16 a[50:51], v46 offset:35072
    v_mfma_f32_32x32x16_bf16 v[224:239], a[116:119], a[188:191], v[224:239]
    ds_read_b64_tr_b16 a[52:53], v46 offset:41216
    ds_read_b64_tr_b16 a[54:55], v46 offset:43264
    v_mfma_f32_32x32x16_bf16 v[240:255], a[120:123], a[184:187], v[240:255]
    ds_read_b64_tr_b16 a[56:57], v47 offset:33024
    ds_read_b64_tr_b16 a[58:59], v47 offset:35072
    v_mfma_f32_32x32x16_bf16 v[240:255], a[124:127], a[188:191], v[240:255]
    ds_read_b64_tr_b16 a[60:61], v47 offset:41216
    ds_read_b64_tr_b16 a[62:63], v47 offset:43264
    s_waitcnt lgkmcnt(0)
    s_barrier
    s_add_u32 s66, s65, 11
    s_cmp_ge_u32 s66, 14
    s_cselect_b32 s46, 14, 0
    s_sub_u32 s66, s66, s46
    s_lshl_b32 s66, s66, 6
    buffer_load_dwordx4 a[216:219], v5, s[32:35], s66 offen offset:0
    buffer_load_dwordx4 a[220:223], v5, s[32:35], s66 offen offset:32
    s_waitcnt vmcnt(7)
    v_mfma_f32_32x32x16_bf16 v[128:143], a[0:3], a[192:195], v[128:143]
    ds_read_b64_tr_b16 a[64:65], v44 offset:49152
    ds_read_b64_tr_b16 a[66:67], v44 offset:51200
    s_waitcnt vmcnt(6)
    v_mfma_f32_32x32x16_bf16 v[128:143], a[4:7], a[196:199], v[128:143]
    ds_read_b64_tr_b16 a[68:69], v44 offset:57344
    ds_read_b64_tr_b16 a[70:71], v44 offset:59392
    v_mfma_f32_32x32x16_bf16 v[144:159], a[8:11], a[192:195], v[144:159]
    ds_read_b64_tr_b16 a[72:73], v45 offset:49152
    ds_read_b64_tr_b16 a[74:75], v45 offset:51200
    v_mfma_f32_32x32x16_bf16 v[144:159], a[12:15], a[196:199], v[144:159]
    ds_read_b64_tr_b16 a[76:77], v45 offset:57344
    ds_read_b64_tr_b16 a[78:79], v45 offset:59392
    v_mfma_f32_32x32x16_bf16 v[160:175], a[16:19], a[192:195], v[160:175]
    ds_read_b64_tr_b16 a[80:81], v46 offset:49152
    ds_read_b64_tr_b16 a[82:83], v46 offset:51200
    v_mfma_f32_32x32x16_bf16 v[160:175], a[20:23], a[196:199], v[160:175]
    ds_read_b64_tr_b16 a[84:85], v46 offset:57344
    ds_read_b64_tr_b16 a[86:87], v46 offset:59392
    v_mfma_f32_32x32x16_bf16 v[176:191], a[24:27], a[192:195], v[176:191]
    ds_read_b64_tr_b16 a[88:89], v47 offset:49152
    ds_read_b64_tr_b16 a[90:91], v47 offset:51200
    v_mfma_f32_32x32x16_bf16 v[176:191], a[28:31], a[196:199], v[176:191]
    ds_read_b64_tr_b16 a[92:93], v47 offset:57344
    ds_read_b64_tr_b16 a[94:95], v47 offset:59392
    v_mfma_f32_32x32x16_bf16 v[192:207], a[32:35], a[192:195], v[192:207]
    ds_read_b64_tr_b16 a[96:97], v44 offset:49408
    ds_read_b64_tr_b16 a[98:99], v44 offset:51456
    v_mfma_f32_32x32x16_bf16 v[192:207], a[36:39], a[196:199], v[192:207]
    ds_read_b64_tr_b16 a[100:101], v44 offset:57600
    ds_read_b64_tr_b16 a[102:103], v44 offset:59648
    v_mfma_f32_32x32x16_bf16 v[208:223], a[40:43], a[192:195], v[208:223]
    ds_read_b64_tr_b16 a[104:105], v45 offset:49408
    ds_read_b64_tr_b16 a[106:107], v45 offset:51456
    v_mfma_f32_32x32x16_bf16 v[208:223], a[44:47], a[196:199], v[208:223]
    ds_read_b64_tr_b16 a[108:109], v45 offset:57600
    ds_read_b64_tr_b16 a[110:111], v45 offset:59648
    v_mfma_f32_32x32x16_bf16 v[224:239], a[48:51], a[192:195], v[224:239]
    ds_read_b64_tr_b16 a[112:113], v46 offset:49408
    ds_read_b64_tr_b16 a[114:115], v46 offset:51456
    v_mfma_f32_32x32x16_bf16 v[224:239], a[52:55], a[196:199], v[224:239]
    ds_read_b64_tr_b16 a[116:117], v46 offset:57600
    ds_read_b64_tr_b16 a[118:119], v46 offset:59648
    v_mfma_f32_32x32x16_bf16 v[240:255], a[56:59], a[192:195], v[240:255]
    ds_read_b64_tr_b16 a[120:121], v47 offset:49408
    ds_read_b64_tr_b16 a[122:123], v47 offset:51456
    v_mfma_f32_32x32x16_bf16 v[240:255], a[60:63], a[196:199], v[240:255]
    ds_read_b64_tr_b16 a[124:125], v47 offset:57600
    ds_read_b64_tr_b16 a[126:127], v47 offset:59648
    s_waitcnt lgkmcnt(0)
    s_barrier
    s_add_u32 s66, s65, 12
    s_cmp_ge_u32 s66, 14
    s_cselect_b32 s46, 14, 0
    s_sub_u32 s66, s66, s46
    s_lshl_b32 s66, s66, 6
    buffer_load_dwordx4 a[224:227], v5, s[32:35], s66 offen offset:0
    buffer_load_dwordx4 a[228:231], v5, s[32:35], s66 offen offset:32
    s_waitcnt vmcnt(7)
    v_mfma_f32_32x32x16_bf16 v[128:143], a[64:67], a[200:203], v[128:143]
    ds_read_b64_tr_b16 a[0:1], v48 offset:0
    ds_read_b64_tr_b16 a[2:3], v48 offset:2048
    s_waitcnt vmcnt(6)
    v_mfma_f32_32x32x16_bf16 v[128:143], a[68:71], a[204:207], v[128:143]
    ds_read_b64_tr_b16 a[4:5], v48 offset:8192
    ds_read_b64_tr_b16 a[6:7], v48 offset:10240
    v_mfma_f32_32x32x16_bf16 v[144:159], a[72:75], a[200:203], v[144:159]
    ds_read_b64_tr_b16 a[8:9], v49 offset:0
    ds_read_b64_tr_b16 a[10:11], v49 offset:2048
    v_mfma_f32_32x32x16_bf16 v[144:159], a[76:79], a[204:207], v[144:159]
    ds_read_b64_tr_b16 a[12:13], v49 offset:8192
    ds_read_b64_tr_b16 a[14:15], v49 offset:10240
    v_mfma_f32_32x32x16_bf16 v[160:175], a[80:83], a[200:203], v[160:175]
    ds_read_b64_tr_b16 a[16:17], v50 offset:0
    ds_read_b64_tr_b16 a[18:19], v50 offset:2048
    v_mfma_f32_32x32x16_bf16 v[160:175], a[84:87], a[204:207], v[160:175]
    ds_read_b64_tr_b16 a[20:21], v50 offset:8192
    ds_read_b64_tr_b16 a[22:23], v50 offset:10240
    v_mfma_f32_32x32x16_bf16 v[176:191], a[88:91], a[200:203], v[176:191]
    ds_read_b64_tr_b16 a[24:25], v51 offset:0
    ds_read_b64_tr_b16 a[26:27], v51 offset:2048
    v_mfma_f32_32x32x16_bf16 v[176:191], a[92:95], a[204:207], v[176:191]
    ds_read_b64_tr_b16 a[28:29], v51 offset:8192
    ds_read_b64_tr_b16 a[30:31], v51 offset:10240
    v_mfma_f32_32x32x16_bf16 v[192:207], a[96:99], a[200:203], v[192:207]
    ds_read_b64_tr_b16 a[32:33], v48 offset:256
    ds_read_b64_tr_b16 a[34:35], v48 offset:2304
    v_mfma_f32_32x32x16_bf16 v[192:207], a[100:103], a[204:207], v[192:207]
    ds_read_b64_tr_b16 a[36:37], v48 offset:8448
    ds_read_b64_tr_b16 a[38:39], v48 offset:10496
    v_mfma_f32_32x32x16_bf16 v[208:223], a[104:107], a[200:203], v[208:223]
    ds_read_b64_tr_b16 a[40:41], v49 offset:256
    ds_read_b64_tr_b16 a[42:43], v49 offset:2304
    v_mfma_f32_32x32x16_bf16 v[208:223], a[108:111], a[204:207], v[208:223]
    ds_read_b64_tr_b16 a[44:45], v49 offset:8448
    ds_read_b64_tr_b16 a[46:47], v49 offset:10496
    v_mfma_f32_32x32x16_bf16 v[224:239], a[112:115], a[200:203], v[224:239]
    ds_read_b64_tr_b16 a[48:49], v50 offset:256
    ds_read_b64_tr_b16 a[50:51], v50 offset:2304
    v_mfma_f32_32x32x16_bf16 v[224:239], a[116:119], a[204:207], v[224:239]
    ds_read_b64_tr_b16 a[52:53], v50 offset:8448
    ds_read_b64_tr_b16 a[54:55], v50 offset:10496
    v_mfma_f32_32x32x16_bf16 v[240:255], a[120:123], a[200:203], v[240:255]
    ds_read_b64_tr_b16 a[56:57], v51 offset:256
    ds_read_b64_tr_b16 a[58:59], v51 offset:2304
    v_mfma_f32_32x32x16_bf16 v[240:255], a[124:127], a[204:207], v[240:255]
    ds_read_b64_tr_b16 a[60:61], v51 offset:8448
    ds_read_b64_tr_b16 a[62:63], v51 offset:10496
    s_waitcnt lgkmcnt(0)
    s_barrier
    s_add_u32 s66, s65, 13
    s_cmp_ge_u32 s66, 14
    s_cselect_b32 s46, 14, 0
    s_sub_u32 s66, s66, s46
    s_lshl_b32 s66, s66, 6
    buffer_load_dwordx4 a[232:235], v5, s[32:35], s66 offen offset:0
    buffer_load_dwordx4 a[236:239], v5, s[32:35], s66 offen offset:32
    s_waitcnt vmcnt(7)
    v_mfma_f32_32x32x16_bf16 v[128:143], a[0:3], a[208:211], v[128:143]
    ds_read_b64_tr_b16 a[64:65], v48 offset:16384
    ds_read_b64_tr_b16 a[66:67], v48 offset:18432
    s_waitcnt vmcnt(6)
    v_mfma_f32_32x32x16_bf16 v[128:143], a[4:7], a[212:215], v[128:143]
    ds_read_b64_tr_b16 a[68:69], v48 offset:24576
    ds_read_b64_tr_b16 a[70:71], v48 offset:26624
    v_mfma_f32_32x32x16_bf16 v[144:159], a[8:11], a[208:211], v[144:159]
    ds_read_b64_tr_b16 a[72:73], v49 offset:16384
    ds_read_b64_tr_b16 a[74:75], v49 offset:18432
    v_mfma_f32_32x32x16_bf16 v[144:159], a[12:15], a[212:215], v[144:159]
    ds_read_b64_tr_b16 a[76:77], v49 offset:24576
    ds_read_b64_tr_b16 a[78:79], v49 offset:26624
    v_mfma_f32_32x32x16_bf16 v[160:175], a[16:19], a[208:211], v[160:175]
    ds_read_b64_tr_b16 a[80:81], v50 offset:16384
    ds_read_b64_tr_b16 a[82:83], v50 offset:18432
    v_mfma_f32_32x32x16_bf16 v[160:175], a[20:23], a[212:215], v[160:175]
    ds_read_b64_tr_b16 a[84:85], v50 offset:24576
    ds_read_b64_tr_b16 a[86:87], v50 offset:26624
    v_mfma_f32_32x32x16_bf16 v[176:191], a[24:27], a[208:211], v[176:191]
    ds_read_b64_tr_b16 a[88:89], v51 offset:16384
    ds_read_b64_tr_b16 a[90:91], v51 offset:18432
    v_mfma_f32_32x32x16_bf16 v[176:191], a[28:31], a[212:215], v[176:191]
    ds_read_b64_tr_b16 a[92:93], v51 offset:24576
    ds_read_b64_tr_b16 a[94:95], v51 offset:26624
    v_mfma_f32_32x32x16_bf16 v[192:207], a[32:35], a[208:211], v[192:207]
    ds_read_b64_tr_b16 a[96:97], v48 offset:16640
    ds_read_b64_tr_b16 a[98:99], v48 offset:18688
    v_mfma_f32_32x32x16_bf16 v[192:207], a[36:39], a[212:215], v[192:207]
    ds_read_b64_tr_b16 a[100:101], v48 offset:24832
    ds_read_b64_tr_b16 a[102:103], v48 offset:26880
    v_mfma_f32_32x32x16_bf16 v[208:223], a[40:43], a[208:211], v[208:223]
    ds_read_b64_tr_b16 a[104:105], v49 offset:16640
    ds_read_b64_tr_b16 a[106:107], v49 offset:18688
    v_mfma_f32_32x32x16_bf16 v[208:223], a[44:47], a[212:215], v[208:223]
    ds_read_b64_tr_b16 a[108:109], v49 offset:24832
    ds_read_b64_tr_b16 a[110:111], v49 offset:26880
    v_mfma_f32_32x32x16_bf16 v[224:239], a[48:51], a[208:211], v[224:239]
    ds_read_b64_tr_b16 a[112:113], v50 offset:16640
    ds_read_b64_tr_b16 a[114:115], v50 offset:18688
    v_mfma_f32_32x32x16_bf16 v[224:239], a[52:55], a[212:215], v[224:239]
    ds_read_b64_tr_b16 a[116:117], v50 offset:24832
    ds_read_b64_tr_b16 a[118:119], v50 offset:26880
    v_mfma_f32_32x32x16_bf16 v[240:255], a[56:59], a[208:211], v[240:255]
    ds_read_b64_tr_b16 a[120:121], v51 offset:16640
    ds_read_b64_tr_b16 a[122:123], v51 offset:18688
    v_mfma_f32_32x32x16_bf16 v[240:255], a[60:63], a[212:215], v[240:255]
    ds_read_b64_tr_b16 a[124:125], v51 offset:24832
    ds_read_b64_tr_b16 a[126:127], v51 offset:26880
    s_waitcnt lgkmcnt(0)
    s_barrier
    s_waitcnt vmcnt(5)
    v_mfma_f32_32x32x16_bf16 v[128:143], a[64:67], a[216:219], v[128:143]
    ds_read_b64_tr_b16 a[0:1], v44 offset:32768
    ds_read_b64_tr_b16 a[2:3], v44 offset:34816
    s_waitcnt vmcnt(4)
    v_mfma_f32_32x32x16_bf16 v[128:143], a[68:71], a[220:223], v[128:143]
    ds_read_b64_tr_b16 a[4:5], v44 offset:40960
    ds_read_b64_tr_b16 a[6:7], v44 offset:43008
    v_mfma_f32_32x32x16_bf16 v[144:159], a[72:75], a[216:219], v[144:159]
    ds_read_b64_tr_b16 a[8:9], v45 offset:32768
    ds_read_b64_tr_b16 a[10:11], v45 offset:34816
    v_mfma_f32_32x32x16_bf16 v[144:159], a[76:79], a[220:223], v[144:159]
    ds_read_b64_tr_b16 a[12:13], v45 offset:40960
    ds_read_b64_tr_b16 a[14:15], v45 offset:43008
    v_mfma_f32_32x32x16_bf16 v[160:175], a[80:83], a[216:219], v[160:175]
    ds_read_b64_tr_b16 a[16:17], v46 offset:32768
    ds_read_b64_tr_b16 a[18:19], v46 offset:34816
    v_mfma_f32_32x32x16_bf16 v[160:175], a[84:87], a[220:223], v[160:175]
    ds_read_b64_tr_b16 a[20:21], v46 offset:40960
    ds_read_b64_tr_b16 a[22:23], v46 offset:43008
    v_mfma_f32_32x32x16_bf16 v[176:191], a[88:91], a[216:219], v[176:191]
    ds_read_b64_tr_b16 a[24:25], v47 offset:32768
    ds_read_b64_tr_b16 a[26:27], v47 offset:34816
    v_mfma_f32_32x32x16_bf16 v[176:191], a[92:95], a[220:223], v[176:191]
    ds_read_b64_tr_b16 a[28:29], v47 offset:40960
    ds_read_b64_tr_b16 a[30:31], v47 offset:43008
    v_mfma_f32_32x32x16_bf16 v[192:207], a[96:99], a[216:219], v[192:207]
    ds_read_b64_tr_b16 a[32:33], v44 offset:33024
    ds_read_b64_tr_b16 a[34:35], v44 offset:35072
    v_mfma_f32_32x32x16_bf16 v[192:207], a[100:103], a[220:223], v[192:207]
    ds_read_b64_tr_b16 a[36:37], v44 offset:41216
    ds_read_b64_tr_b16 a[38:39], v44 offset:43264
    v_mfma_f32_32x32x16_bf16 v[208:223], a[104:107], a[216:219], v[208:223]
    ds_read_b64_tr_b16 a[40:41], v45 offset:33024
    ds_read_b64_tr_b16 a[42:43], v45 offset:35072
    v_mfma_f32_32x32x16_bf16 v[208:223], a[108:111], a[220:223], v[208:223]
    ds_read_b64_tr_b16 a[44:45], v45 offset:41216
    ds_read_b64_tr_b16 a[46:47], v45 offset:43264
    v_mfma_f32_32x32x16_bf16 v[224:239], a[112:115], a[216:219], v[224:239]
    ds_read_b64_tr_b16 a[48:49], v46 offset:33024
    ds_read_b64_tr_b16 a[50:51], v46 offset:35072
    v_mfma_f32_32x32x16_bf16 v[224:239], a[116:119], a[220:223], v[224:239]
    ds_read_b64_tr_b16 a[52:53], v46 offset:41216
    ds_read_b64_tr_b16 a[54:55], v46 offset:43264
    v_mfma_f32_32x32x16_bf16 v[240:255], a[120:123], a[216:219], v[240:255]
    ds_read_b64_tr_b16 a[56:57], v47 offset:33024
    ds_read_b64_tr_b16 a[58:59], v47 offset:35072
    v_mfma_f32_32x32x16_bf16 v[240:255], a[124:127], a[220:223], v[240:255]
    ds_read_b64_tr_b16 a[60:61], v47 offset:41216
    ds_read_b64_tr_b16 a[62:63], v47 offset:43264
    s_waitcnt lgkmcnt(0)
    s_barrier
    s_waitcnt vmcnt(3)
    v_mfma_f32_32x32x16_bf16 v[128:143], a[0:3], a[224:227], v[128:143]
    ds_read_b64_tr_b16 a[64:65], v44 offset:49152
    ds_read_b64_tr_b16 a[66:67], v44 offset:51200
    s_waitcnt vmcnt(2)
    v_mfma_f32_32x32x16_bf16 v[128:143], a[4:7], a[228:231], v[128:143]
    ds_read_b64_tr_b16 a[68:69], v44 offset:57344
    ds_read_b64_tr_b16 a[70:71], v44 offset:59392
    v_mfma_f32_32x32x16_bf16 v[144:159], a[8:11], a[224:227], v[144:159]
    ds_read_b64_tr_b16 a[72:73], v45 offset:49152
    ds_read_b64_tr_b16 a[74:75], v45 offset:51200
    v_mfma_f32_32x32x16_bf16 v[144:159], a[12:15], a[228:231], v[144:159]
    ds_read_b64_tr_b16 a[76:77], v45 offset:57344
    ds_read_b64_tr_b16 a[78:79], v45 offset:59392
    v_mfma_f32_32x32x16_bf16 v[160:175], a[16:19], a[224:227], v[160:175]
    ds_read_b64_tr_b16 a[80:81], v46 offset:49152
    ds_read_b64_tr_b16 a[82:83], v46 offset:51200
    v_mfma_f32_32x32x16_bf16 v[160:175], a[20:23], a[228:231], v[160:175]
    ds_read_b64_tr_b16 a[84:85], v46 offset:57344
    ds_read_b64_tr_b16 a[86:87], v46 offset:59392
    v_mfma_f32_32x32x16_bf16 v[176:191], a[24:27], a[224:227], v[176:191]
    ds_read_b64_tr_b16 a[88:89], v47 offset:49152
    ds_read_b64_tr_b16 a[90:91], v47 offset:51200
    v_mfma_f32_32x32x16_bf16 v[176:191], a[28:31], a[228:231], v[176:191]
    ds_read_b64_tr_b16 a[92:93], v47 offset:57344
    ds_read_b64_tr_b16 a[94:95], v47 offset:59392
    v_mfma_f32_32x32x16_bf16 v[192:207], a[32:35], a[224:227], v[192:207]
    ds_read_b64_tr_b16 a[96:97], v44 offset:49408
    ds_read_b64_tr_b16 a[98:99], v44 offset:51456
    v_mfma_f32_32x32x16_bf16 v[192:207], a[36:39], a[228:231], v[192:207]
    ds_read_b64_tr_b16 a[100:101], v44 offset:57600
    ds_read_b64_tr_b16 a[102:103], v44 offset:59648
    v_mfma_f32_32x32x16_bf16 v[208:223], a[40:43], a[224:227], v[208:223]
    ds_read_b64_tr_b16 a[104:105], v45 offset:49408
    ds_read_b64_tr_b16 a[106:107], v45 offset:51456
    v_mfma_f32_32x32x16_bf16 v[208:223], a[44:47], a[228:231], v[208:223]
    ds_read_b64_tr_b16 a[108:109], v45 offset:57600
    ds_read_b64_tr_b16 a[110:111], v45 offset:59648
    v_mfma_f32_32x32x16_bf16 v[224:239], a[48:51], a[224:227], v[224:239]
    ds_read_b64_tr_b16 a[112:113], v46 offset:49408
    ds_read_b64_tr_b16 a[114:115], v46 offset:51456
    v_mfma_f32_32x32x16_bf16 v[224:239], a[52:55], a[228:231], v[224:239]
    ds_read_b64_tr_b16 a[116:117], v46 offset:57600
    ds_read_b64_tr_b16 a[118:119], v46 offset:59648
    v_mfma_f32_32x32x16_bf16 v[240:255], a[56:59], a[224:227], v[240:255]
    ds_read_b64_tr_b16 a[120:121], v47 offset:49408
    ds_read_b64_tr_b16 a[122:123], v47 offset:51456
    v_mfma_f32_32x32x16_bf16 v[240:255], a[60:63], a[228:231], v[240:255]
    ds_read_b64_tr_b16 a[124:125], v47 offset:57600
    ds_read_b64_tr_b16 a[126:127], v47 offset:59648
    s_waitcnt lgkmcnt(0)
    s_barrier
    s_waitcnt vmcnt(1)
    v_mfma_f32_32x32x16_bf16 v[128:143], a[64:67], a[232:235], v[128:143]
    s_waitcnt vmcnt(0)
    v_mfma_f32_32x32x16_bf16 v[128:143], a[68:71], a[236:239], v[128:143]
    v_mfma_f32_32x32x16_bf16 v[144:159], a[72:75], a[232:235], v[144:159]
    v_mfma_f32_32x32x16_bf16 v[144:159], a[76:79], a[236:239], v[144:159]
    v_mfma_f32_32x32x16_bf16 v[160:175], a[80:83], a[232:235], v[160:175]
    v_mfma_f32_32x32x16_bf16 v[160:175], a[84:87], a[236:239], v[160:175]
    v_mfma_f32_32x32x16_bf16 v[176:191], a[88:91], a[232:235], v[176:191]
    v_mfma_f32_32x32x16_bf16 v[176:191], a[92:95], a[236:239], v[176:191]
    v_mfma_f32_32x32x16_bf16 v[192:207], a[96:99], a[232:235], v[192:207]
    v_mfma_f32_32x32x16_bf16 v[192:207], a[100:103], a[236:239], v[192:207]
    v_mfma_f32_32x32x16_bf16 v[208:223], a[104:107], a[232:235], v[208:223]
    v_mfma_f32_32x32x16_bf16 v[208:223], a[108:111], a[236:239], v[208:223]
    v_mfma_f32_32x32x16_bf16 v[224:239], a[112:115], a[232:235], v[224:239]
    v_mfma_f32_32x32x16_bf16 v[224:239], a[116:119], a[236:239], v[224:239]
    v_mfma_f32_32x32x16_bf16 v[240:255], a[120:123], a[232:235], v[240:255]
    v_mfma_f32_32x32x16_bf16 v[240:255], a[124:127], a[236:239], v[240:255]
    s_waitcnt lgkmcnt(0)
    v_cvt_pk_bf16_f32 v76, v128, v129
    v_cvt_pk_bf16_f32 v77, v130, v131
    v_cvt_pk_bf16_f32 v78, v132, v133
    v_cvt_pk_bf16_f32 v79, v134, v135
    v_accvgpr_write_b32 a128, v76
    v_accvgpr_write_b32 a129, v77
    v_accvgpr_write_b32 a130, v78
    v_accvgpr_write_b32 a131, v79
    v_cvt_pk_bf16_f32 v76, v136, v137
    v_cvt_pk_bf16_f32 v77, v138, v139
    v_cvt_pk_bf16_f32 v78, v140, v141
    v_cvt_pk_bf16_f32 v79, v142, v143
    v_accvgpr_write_b32 a132, v76
    v_accvgpr_write_b32 a133, v77
    v_accvgpr_write_b32 a134, v78
    v_accvgpr_write_b32 a135, v79
    v_cvt_pk_bf16_f32 v76, v144, v145
    v_cvt_pk_bf16_f32 v77, v146, v147
    v_cvt_pk_bf16_f32 v78, v148, v149
    v_cvt_pk_bf16_f32 v79, v150, v151
    v_accvgpr_write_b32 a136, v76
    v_accvgpr_write_b32 a137, v77
    v_accvgpr_write_b32 a138, v78
    v_accvgpr_write_b32 a139, v79
    v_cvt_pk_bf16_f32 v76, v152, v153
    v_cvt_pk_bf16_f32 v77, v154, v155
    v_cvt_pk_bf16_f32 v78, v156, v157
    v_cvt_pk_bf16_f32 v79, v158, v159
    v_accvgpr_write_b32 a140, v76
    v_accvgpr_write_b32 a141, v77
    v_accvgpr_write_b32 a142, v78
    v_accvgpr_write_b32 a143, v79
    v_cvt_pk_bf16_f32 v76, v160, v161
    v_cvt_pk_bf16_f32 v77, v162, v163
    v_cvt_pk_bf16_f32 v78, v164, v165
    v_cvt_pk_bf16_f32 v79, v166, v167
    v_accvgpr_write_b32 a144, v76
    v_accvgpr_write_b32 a145, v77
    v_accvgpr_write_b32 a146, v78
    v_accvgpr_write_b32 a147, v79
    v_cvt_pk_bf16_f32 v76, v168, v169
    v_cvt_pk_bf16_f32 v77, v170, v171
    v_cvt_pk_bf16_f32 v78, v172, v173
    v_cvt_pk_bf16_f32 v79, v174, v175
    v_accvgpr_write_b32 a148, v76
    v_accvgpr_write_b32 a149, v77
    v_accvgpr_write_b32 a150, v78
    v_accvgpr_write_b32 a151, v79
    v_cvt_pk_bf16_f32 v76, v176, v177
    v_cvt_pk_bf16_f32 v77, v178, v179
    v_cvt_pk_bf16_f32 v78, v180, v181
    v_cvt_pk_bf16_f32 v79, v182, v183
    v_accvgpr_write_b32 a152, v76
    v_accvgpr_write_b32 a153, v77
    v_accvgpr_write_b32 a154, v78
    v_accvgpr_write_b32 a155, v79
    v_cvt_pk_bf16_f32 v76, v184, v185
    v_cvt_pk_bf16_f32 v77, v186, v187
    v_cvt_pk_bf16_f32 v78, v188, v189
    v_cvt_pk_bf16_f32 v79, v190, v191
    v_accvgpr_write_b32 a156, v76
    v_accvgpr_write_b32 a157, v77
    v_accvgpr_write_b32 a158, v78
    v_accvgpr_write_b32 a159, v79
    v_cvt_pk_bf16_f32 v76, v192, v193
    v_cvt_pk_bf16_f32 v77, v194, v195
    v_cvt_pk_bf16_f32 v78, v196, v197
    v_cvt_pk_bf16_f32 v79, v198, v199
    v_accvgpr_write_b32 a160, v76
    v_accvgpr_write_b32 a161, v77
    v_accvgpr_write_b32 a162, v78
    v_accvgpr_write_b32 a163, v79
    v_cvt_pk_bf16_f32 v76, v200, v201
    v_cvt_pk_bf16_f32 v77, v202, v203
    v_cvt_pk_bf16_f32 v78, v204, v205
    v_cvt_pk_bf16_f32 v79, v206, v207
    v_accvgpr_write_b32 a164, v76
    v_accvgpr_write_b32 a165, v77
    v_accvgpr_write_b32 a166, v78
    v_accvgpr_write_b32 a167, v79
    v_cvt_pk_bf16_f32 v76, v208, v209
    v_cvt_pk_bf16_f32 v77, v210, v211
    v_cvt_pk_bf16_f32 v78, v212, v213
    v_cvt_pk_bf16_f32 v79, v214, v215
    v_accvgpr_write_b32 a168, v76
    v_accvgpr_write_b32 a169, v77
    v_accvgpr_write_b32 a170, v78
    v_accvgpr_write_b32 a171, v79
    v_cvt_pk_bf16_f32 v76, v216, v217
    v_cvt_pk_bf16_f32 v77, v218, v219
    v_cvt_pk_bf16_f32 v78, v220, v221
    v_cvt_pk_bf16_f32 v79, v222, v223
    v_accvgpr_write_b32 a172, v76
    v_accvgpr_write_b32 a173, v77
    v_accvgpr_write_b32 a174, v78
    v_accvgpr_write_b32 a175, v79
    v_cvt_pk_bf16_f32 v76, v224, v225
    v_cvt_pk_bf16_f32 v77, v226, v227
    v_cvt_pk_bf16_f32 v78, v228, v229
    v_cvt_pk_bf16_f32 v79, v230, v231
    v_accvgpr_write_b32 a176, v76
    v_accvgpr_write_b32 a177, v77
    v_accvgpr_write_b32 a178, v78
    v_accvgpr_write_b32 a179, v79
    v_cvt_pk_bf16_f32 v76, v232, v233
    v_cvt_pk_bf16_f32 v77, v234, v235
    v_cvt_pk_bf16_f32 v78, v236, v237
    v_cvt_pk_bf16_f32 v79, v238, v239
    v_accvgpr_write_b32 a180, v76
    v_accvgpr_write_b32 a181, v77
    v_accvgpr_write_b32 a182, v78
    v_accvgpr_write_b32 a183, v79
    v_cvt_pk_bf16_f32 v76, v240, v241
    v_cvt_pk_bf16_f32 v77, v242, v243
    v_cvt_pk_bf16_f32 v78, v244, v245
    v_cvt_pk_bf16_f32 v79, v246, v247
    v_accvgpr_write_b32 a184, v76
    v_accvgpr_write_b32 a185, v77
    v_accvgpr_write_b32 a186, v78
    v_accvgpr_write_b32 a187, v79
    v_cvt_pk_bf16_f32 v76, v248, v249
    v_cvt_pk_bf16_f32 v77, v250, v251
    v_cvt_pk_bf16_f32 v78, v252, v253
    v_cvt_pk_bf16_f32 v79, v254, v255
    v_accvgpr_write_b32 a188, v76
    v_accvgpr_write_b32 a189, v77
    v_accvgpr_write_b32 a190, v78
    v_accvgpr_write_b32 a191, v79
    v_mov_b32 v128, 0
    v_mov_b32 v129, 0
    v_mov_b32 v130, 0
    v_mov_b32 v131, 0
    v_mov_b32 v132, 0
    v_mov_b32 v133, 0
    v_mov_b32 v134, 0
    v_mov_b32 v135, 0
    v_mov_b32 v136, 0
    v_mov_b32 v137, 0
    v_mov_b32 v138, 0
    v_mov_b32 v139, 0
    v_mov_b32 v140, 0
    v_mov_b32 v141, 0
    v_mov_b32 v142, 0
    v_mov_b32 v143, 0
    v_mov_b32 v144, 0
    v_mov_b32 v145, 0
    v_mov_b32 v146, 0
    v_mov_b32 v147, 0
    v_mov_b32 v148, 0
    v_mov_b32 v149, 0
    v_mov_b32 v150, 0
    v_mov_b32 v151, 0
    v_mov_b32 v152, 0
    v_mov_b32 v153, 0
    v_mov_b32 v154, 0
    v_mov_b32 v155, 0
    v_mov_b32 v156, 0
    v_mov_b32 v157, 0
    v_mov_b32 v158, 0
    v_mov_b32 v159, 0
    v_mov_b32 v160, 0
    v_mov_b32 v161, 0
    v_mov_b32 v162, 0
    v_mov_b32 v163, 0
    v_mov_b32 v164, 0
    v_mov_b32 v165, 0
    v_mov_b32 v166, 0
    v_mov_b32 v167, 0
    v_mov_b32 v168, 0
    v_mov_b32 v169, 0
    v_mov_b32 v170, 0
    v_mov_b32 v171, 0
    v_mov_b32 v172, 0
    v_mov_b32 v173, 0
    v_mov_b32 v174, 0
    v_mov_b32 v175, 0
    v_mov_b32 v176, 0
    v_mov_b32 v177, 0
    v_mov_b32 v178, 0
    v_mov_b32 v179, 0
    v_mov_b32 v180, 0
    v_mov_b32 v181, 0
    v_mov_b32 v182, 0
    v_mov_b32 v183, 0
    v_mov_b32 v184, 0
    v_mov_b32 v185, 0
    v_mov_b32 v186, 0
    v_mov_b32 v187, 0
    v_mov_b32 v188, 0
    v_mov_b32 v189, 0
    v_mov_b32 v190, 0
    v_mov_b32 v191, 0
    v_mov_b32 v192, 0
    v_mov_b32 v193, 0
    v_mov_b32 v194, 0
    v_mov_b32 v195, 0
    v_mov_b32 v196, 0
    v_mov_b32 v197, 0
    v_mov_b32 v198, 0
    v_mov_b32 v199, 0
    v_mov_b32 v200, 0
    v_mov_b32 v201, 0
    v_mov_b32 v202, 0
    v_mov_b32 v203, 0
    v_mov_b32 v204, 0
    v_mov_b32 v205, 0
    v_mov_b32 v206, 0
    v_mov_b32 v207, 0
    v_mov_b32 v208, 0
    v_mov_b32 v209, 0
    v_mov_b32 v210, 0
    v_mov_b32 v211, 0
    v_mov_b32 v212, 0
    v_mov_b32 v213, 0
    v_mov_b32 v214, 0
    v_mov_b32 v215, 0
    v_mov_b32 v216, 0
    v_mov_b32 v217, 0
    v_mov_b32 v218, 0
    v_mov_b32 v219, 0
    v_mov_b32 v220, 0
    v_mov_b32 v221, 0
    v_mov_b32 v222, 0
    v_mov_b32 v223, 0
    v_mov_b32 v224, 0
    v_mov_b32 v225, 0
    v_mov_b32 v226, 0
    v_mov_b32 v227, 0
    v_mov_b32 v228, 0
    v_mov_b32 v229, 0
    v_mov_b32 v230, 0
    v_mov_b32 v231, 0
    v_mov_b32 v232, 0
    v_mov_b32 v233, 0
    v_mov_b32 v234, 0
    v_mov_b32 v235, 0
    v_mov_b32 v236, 0
    v_mov_b32 v237, 0
    v_mov_b32 v238, 0
    v_mov_b32 v239, 0
    v_mov_b32 v240, 0
    v_mov_b32 v241, 0
    v_mov_b32 v242, 0
    v_mov_b32 v243, 0
    v_mov_b32 v244, 0
    v_mov_b32 v245, 0
    v_mov_b32 v246, 0
    v_mov_b32 v247, 0
    v_mov_b32 v248, 0
    v_mov_b32 v249, 0
    v_mov_b32 v250, 0
    v_mov_b32 v251, 0
    v_mov_b32 v252, 0
    v_mov_b32 v253, 0
    v_mov_b32 v254, 0
    v_mov_b32 v255, 0
    v_mov_b32 v72, 0xf149f2ca
    v_mov_b32 v73, 0
    s_barrier
    ds_read_b128 a[0:3], v8 offset:0
    ds_read_b128 a[4:7], v9 offset:0
    ds_read_b128 a[8:11], v10 offset:0
    ds_read_b128 a[12:15], v11 offset:0
    ds_read_b128 a[16:19], v12 offset:0
    ds_read_b128 a[20:23], v13 offset:0
    ds_read_b128 a[24:27], v14 offset:0
    ds_read_b128 a[28:31], v15 offset:0
    ds_read_b128 a[32:35], v8 offset:256
    ds_read_b128 a[36:39], v9 offset:256
    ds_read_b128 a[40:43], v10 offset:256
    ds_read_b128 a[44:47], v11 offset:256
    ds_read_b128 a[48:51], v12 offset:256
    ds_read_b128 a[52:55], v13 offset:256
    ds_read_b128 a[56:59], v14 offset:256
    ds_read_b128 a[60:63], v15 offset:256
    s_waitcnt lgkmcnt(15)
    v_mfma_f32_32x32x16_bf16 v[32:47], a[0:3], a[128:131], 0
    s_waitcnt lgkmcnt(14)
    v_mfma_f32_32x32x16_bf16 v[32:47], a[4:7], a[132:135], v[32:47]
    s_waitcnt lgkmcnt(13)
    v_mfma_f32_32x32x16_bf16 v[32:47], a[8:11], a[136:139], v[32:47]
    s_waitcnt lgkmcnt(12)
    v_mfma_f32_32x32x16_bf16 v[32:47], a[12:15], a[140:143], v[32:47]
    s_waitcnt lgkmcnt(11)
    v_mfma_f32_32x32x16_bf16 v[32:47], a[16:19], a[144:147], v[32:47]
    s_waitcnt lgkmcnt(10)
    v_mfma_f32_32x32x16_bf16 v[32:47], a[20:23], a[148:151], v[32:47]
    s_waitcnt lgkmcnt(9)
    v_mfma_f32_32x32x16_bf16 v[32:47], a[24:27], a[152:155], v[32:47]
    s_waitcnt lgkmcnt(8)
    v_mfma_f32_32x32x16_bf16 v[32:47], a[28:31], a[156:159], v[32:47]
    s_waitcnt lgkmcnt(7)
    v_mfma_f32_32x32x16_bf16 v[32:47], a[32:35], a[160:163], v[32:47]
    s_waitcnt lgkmcnt(6)
    v_mfma_f32_32x32x16_bf16 v[32:47], a[36:39], a[164:167], v[32:47]
    s_waitcnt lgkmcnt(5)
    v_mfma_f32_32x32x16_bf16 v[32:47], a[40:43], a[168:171], v[32:47]
    s_waitcnt lgkmcnt(4)
    v_mfma_f32_32x32x16_bf16 v[32:47], a[44:47], a[172:175], v[32:47]
    s_waitcnt lgkmcnt(3)
    v_mfma_f32_32x32x16_bf16 v[32:47], a[48:51], a[176:179], v[32:47]
    s_waitcnt lgkmcnt(2)
    v_mfma_f32_32x32x16_bf16 v[32:47], a[52:55], a[180:183], v[32:47]
    s_waitcnt lgkmcnt(1)
    v_mfma_f32_32x32x16_bf16 v[32:47], a[56:59], a[184:187], v[32:47]
    s_waitcnt lgkmcnt(0)
    v_mfma_f32_32x32x16_bf16 v[32:47], a[60:63], a[188:191], v[32:47]
    ds_read_b128 a[0:3], v8 offset:16384
    ds_read_b128 a[4:7], v9 offset:16384
    ds_read_b128 a[8:11], v10 offset:16384
    ds_read_b128 a[12:15], v11 offset:16384
    ds_read_b128 a[16:19], v12 offset:16384
    ds_read_b128 a[20:23], v13 offset:16384
    ds_read_b128 a[24:27], v14 offset:16384
    ds_read_b128 a[28:31], v15 offset:16384
    ds_read_b128 a[32:35], v8 offset:16640
    ds_read_b128 a[36:39], v9 offset:16640
    ds_read_b128 a[40:43], v10 offset:16640
    ds_read_b128 a[44:47], v11 offset:16640
    ds_read_b128 a[48:51], v12 offset:16640
    ds_read_b128 a[52:55], v13 offset:16640
    ds_read_b128 a[56:59], v14 offset:16640
    ds_read_b128 a[60:63], v15 offset:16640
    s_add_u32 s62, s62, 1
    s_cmp_eq_u32 s62, 6
    s_cselect_b32 s63, s64, 16384
    s_cselect_b32 s62, 0, s62
    v_add_u32 v8, s63, v8
    v_add_u32 v9, s63, v9
    v_add_u32 v10, s63, v10
    v_add_u32 v11, s63, v11
    v_add_u32 v12, s63, v12
    v_add_u32 v13, s63, v13
    v_add_u32 v14, s63, v14
    v_add_u32 v15, s63, v15
    s_add_u32 s62, s62, 1
    s_cmp_eq_u32 s62, 6
    s_cselect_b32 s63, s64, 16384
    s_cselect_b32 s62, 0, s62
    v_add_u32 v8, s63, v8
    v_add_u32 v9, s63, v9
    v_add_u32 v10, s63, v10
    v_add_u32 v11, s63, v11
    v_add_u32 v12, s63, v12
    v_add_u32 v13, s63, v13
    v_add_u32 v14, s63, v14
    v_add_u32 v15, s63, v15
    v_max3_f32 v74, v32, v33, v34
    v_max3_f32 v74, v74, v35, v36
    v_max3_f32 v74, v74, v37, v38
    v_max3_f32 v74, v74, v39, v40
    v_max3_f32 v74, v74, v41, v42
    v_max3_f32 v74, v74, v43, v44
    v_max3_f32 v74, v74, v45, v46
    v_max_f32 v74, v74, v47
    v_mov_b32 v75, v74
    s_nop 1
    v_permlane32_swap_b32 v74, v75
    v_max_f32 v74, v74, v75
    v_mul_f32 v74, s50, v74
    v_sub_f32 v75, v74, v72
    v_cmp_lt_f32 vcc, 0x41000000, v75
    ds_read_b64_tr_b16 a[64:65], v16 offset:32768
    ds_read_b64_tr_b16 a[66:67], v16 offset:36864
    ds_read_b64_tr_b16 a[72:73], v17 offset:32768
    ds_read_b64_tr_b16 a[74:75], v17 offset:36864
    ds_read_b64_tr_b16 a[80:81], v18 offset:32768
    ds_read_b64_tr_b16 a[82:83], v18 offset:36864
    ds_read_b64_tr_b16 a[88:89], v19 offset:32768
    ds_read_b64_tr_b16 a[90:91], v19 offset:36864
    ds_read_b64_tr_b16 a[96:97], v16 offset:33024
    ds_read_b64_tr_b16 a[98:99], v16 offset:37120
    ds_read_b64_tr_b16 a[104:105], v17 offset:33024
    ds_read_b64_tr_b16 a[106:107], v17 offset:37120
    ds_read_b64_tr_b16 a[112:113], v18 offset:33024
    ds_read_b64_tr_b16 a[114:115], v18 offset:37120
    ds_read_b64_tr_b16 a[120:121], v19 offset:33024
    ds_read_b64_tr_b16 a[122:123], v19 offset:37120
    s_cbranch_vccnz attn_rs_1
attn_rsb_2:
    s_waitcnt lgkmcnt(0)
    s_mov_b32 s51, 0
attn_loop:
    s_waitcnt vmcnt(0)
    s_barrier
    v_mfma_f32_32x32x16_bf16 v[48:63], a[0:3], a[128:131], 0
    v_fma_f32 v32, v32, s50, -v72
    ds_read_b64_tr_b16 a[68:69], v16 offset:40960
    v_fma_f32 v33, v33, s50, -v72
    v_exp_f32 v32, v32
    v_mfma_f32_32x32x16_bf16 v[48:63], a[4:7], a[132:135], v[48:63]
    v_fma_f32 v34, v34, s50, -v72
    v_exp_f32 v33, v33
    v_add_f32 v73, v73, v32
    v_fma_f32 v35, v35, s50, -v72
    v_mfma_f32_32x32x16_bf16 v[48:63], a[8:11], a[136:139], v[48:63]
    v_exp_f32 v34, v34
    ds_read_b64_tr_b16 a[70:71], v16 offset:45056
    v_add_f32 v73, v73, v33
    v_cvt_pk_bf16_f32 v64, v32, v33
    v_mfma_f32_32x32x16_bf16 v[48:63], a[12:15], a[140:143], v[48:63]
    v_fma_f32 v36, v36, s50, -v72
    v_exp_f32 v35, v35
    v_add_f32 v73, v73, v34
    v_fma_f32 v37, v37, s50, -v72
    v_mfma_f32_32x32x16_bf16 v[48:63], a[16:19], a[144:147], v[48:63]
    v_exp_f32 v36, v36
    ds_read_b64_tr_b16 a[76:77], v17 offset:40960
    v_add_f32 v73, v73, v35
    v_cvt_pk_bf16_f32 v65, v34, v35
    v_mfma_f32_32x32x16_bf16 v[48:63], a[20:23], a[148:151], v[48:63]
    v_fma_f32 v38, v38, s50, -v72
    v_exp_f32 v37, v37
    v_add_f32 v73, v73, v36
    v_fma_f32 v39, v39, s50, -v72
    v_mfma_f32_32x32x16_bf16 v[48:63], a[24:27], a[152:155], v[48:63]
    v_exp_f32 v38, v38
    ds_read_b64_tr_b16 a[78:79], v17 offset:45056
    v_add_f32 v73, v73, v37
    v_cvt_pk_bf16_f32 v66, v36, v37
    v_mfma_f32_32x32x16_bf16 v[48:63], a[28:31], a[156:159], v[48:63]
    v_exp_f32 v39, v39
    v_add_f32 v73, v73, v38
    v_add_f32 v73, v73, v39
    v_cvt_pk_bf16_f32 v67, v38, v39
    s_nop 1
    v_mfma_f32_32x32x16_bf16 v[128:143], a[64:67], v[64:67], v[128:143]
    v_fma_f32 v40, v40, s50, -v72
    ds_read_b64_tr_b16 a[84:85], v18 offset:40960
    ds_read_b64_tr_b16 a[86:87], v18 offset:45056
    v_fma_f32 v41, v41, s50, -v72
    v_mfma_f32_32x32x16_bf16 v[144:159], a[72:75], v[64:67], v[144:159]
    ds_read_b64_tr_b16 a[92:93], v19 offset:40960
    v_exp_f32 v40, v40
    ds_read_b64_tr_b16 a[94:95], v19 offset:45056
    v_fma_f32 v42, v42, s50, -v72
    v_mfma_f32_32x32x16_bf16 v[160:175], a[80:83], v[64:67], v[160:175]
    ds_read_b64_tr_b16 a[100:101], v16 offset:41216
    ds_read_b64_tr_b16 a[102:103], v16 offset:45312
    v_exp_f32 v41, v41
    ds_read_b64_tr_b16 a[108:109], v17 offset:41216
    v_mfma_f32_32x32x16_bf16 v[176:191], a[88:91], v[64:67], v[176:191]
    v_add_f32 v73, v73, v40
    ds_read_b64_tr_b16 a[110:111], v17 offset:45312
    v_fma_f32 v43, v43, s50, -v72
    ds_read_b64_tr_b16 a[116:117], v18 offset:41216
    v_mfma_f32_32x32x16_bf16 v[192:207], a[96:99], v[64:67], v[192:207]
    v_exp_f32 v42, v42
    ds_read_b64_tr_b16 a[118:119], v18 offset:45312
    ds_read_b64_tr_b16 a[124:125], v19 offset:41216
    v_add_f32 v73, v73, v41
    v_mfma_f32_32x32x16_bf16 v[208:223], a[104:107], v[64:67], v[208:223]
    ds_read_b64_tr_b16 a[126:127], v19 offset:45312
    v_cvt_pk_bf16_f32 v68, v40, v41
    ds_read_b128 a[0:3], v8 offset:0
    v_exp_f32 v43, v43
    v_mfma_f32_32x32x16_bf16 v[224:239], a[112:115], v[64:67], v[224:239]
    ds_read_b128 a[4:7], v9 offset:0
    ds_read_b128 a[8:11], v10 offset:0
    v_add_f32 v73, v73, v42
    ds_read_b128 a[12:15], v11 offset:0
    v_mfma_f32_32x32x16_bf16 v[240:255], a[120:123], v[64:67], v[240:255]
    v_add_f32 v73, v73, v43
    ds_read_b128 a[16:19], v12 offset:0
    v_cvt_pk_bf16_f32 v69, v42, v43
    ds_read_b128 a[20:23], v13 offset:0
    v_mfma_f32_32x32x16_bf16 v[48:63], a[32:35], a[160:163], v[48:63]
    v_fma_f32 v44, v44, s50, -v72
    ds_read_b128 a[24:27], v14 offset:0
    ds_read_b128 a[28:31], v15 offset:0
    v_fma_f32 v45, v45, s50, -v72
    v_mfma_f32_32x32x16_bf16 v[48:63], a[36:39], a[164:167], v[48:63]
    ds_read_b64_tr_b16 a[64:65], v16 offset:49152
    v_exp_f32 v44, v44
    ds_read_b64_tr_b16 a[66:67], v16 offset:53248
    v_fma_f32 v46, v46, s50, -v72
    v_mfma_f32_32x32x16_bf16 v[48:63], a[40:43], a[168:171], v[48:63]
    ds_read_b64_tr_b16 a[72:73], v17 offset:49152
    ds_read_b64_tr_b16 a[74:75], v17 offset:53248
    v_exp_f32 v45, v45
    ds_read_b64_tr_b16 a[80:81], v18 offset:49152
    v_mfma_f32_32x32x16_bf16 v[48:63], a[44:47], a[172:175], v[48:63]
    v_add_f32 v73, v73, v44
    ds_read_b64_tr_b16 a[82:83], v18 offset:53248
    v_fma_f32 v47, v47, s50, -v72
    ds_read_b64_tr_b16 a[88:89], v19 offset:49152
    v_mfma_f32_32x32x16_bf16 v[48:63], a[48:51], a[176:179], v[48:63]
    v_exp_f32 v46, v46
    ds_read_b64_tr_b16 a[90:91], v19 offset:53248
    ds_read_b64_tr_b16 a[96:97], v16 offset:49408
    v_add_f32 v73, v73, v45
    v_mfma_f32_32x32x16_bf16 v[48:63], a[52:55], a[180:183], v[48:63]
    ds_read_b64_tr_b16 a[98:99], v16 offset:53504
    v_cvt_pk_bf16_f32 v70, v44, v45
    ds_read_b64_tr_b16 a[104:105], v17 offset:49408
    v_exp_f32 v47, v47
    v_mfma_f32_32x32x16_bf16 v[48:63], a[56:59], a[184:187], v[48:63]
    ds_read_b64_tr_b16 a[106:107], v17 offset:53504
    ds_read_b64_tr_b16 a[112:113], v18 offset:49408
    v_add_f32 v73, v73, v46
    ds_read_b64_tr_b16 a[114:115], v18 offset:53504
    v_mfma_f32_32x32x16_bf16 v[48:63], a[60:63], a[188:191], v[48:63]
    v_add_f32 v73, v73, v47
    ds_read_b64_tr_b16 a[120:121], v19 offset:49408
    v_cvt_pk_bf16_f32 v71, v46, v47
    ds_read_b64_tr_b16 a[122:123], v19 offset:53504
    s_waitcnt lgkmcnt(15)
    v_mfma_f32_32x32x16_bf16 v[128:143], a[68:71], v[68:71], v[128:143]
    ds_read_b128 a[32:35], v8 offset:256
    ds_read_b128 a[36:39], v9 offset:256
    ds_read_b128 a[40:43], v10 offset:256
    ds_read_b128 a[44:47], v11 offset:256
    v_mfma_f32_32x32x16_bf16 v[144:159], a[76:79], v[68:71], v[144:159]
    s_nop 0
    v_max3_f32 v74, v48, v49, v50
    v_max3_f32 v74, v74, v51, v52
    v_max3_f32 v74, v74, v53, v54
    v_max3_f32 v74, v74, v55, v56
    v_mfma_f32_32x32x16_bf16 v[160:175], a[84:87], v[68:71], v[160:175]
    v_max3_f32 v74, v74, v57, v58
    v_max3_f32 v74, v74, v59, v60
    v_max3_f32 v74, v74, v61, v62
    v_max_f32 v74, v74, v63
    v_mfma_f32_32x32x16_bf16 v[176:191], a[92:95], v[68:71], v[176:191]
    v_mov_b32 v75, v74
    s_nop 1
    v_permlane32_swap_b32 v74, v75
    v_max_f32 v74, v74, v75
    v_mul_f32 v74, s50, v74
    v_sub_f32 v75, v74, v72
    v_mfma_f32_32x32x16_bf16 v[192:207], a[100:103], v[68:71], v[192:207]
    v_cmp_lt_f32 vcc, 0x41000000, v75
    ds_read_b128 a[48:51], v12 offset:256
    ds_read_b128 a[52:55], v13 offset:256
    ds_read_b128 a[56:59], v14 offset:256
    v_mfma_f32_32x32x16_bf16 v[208:223], a[108:111], v[68:71], v[208:223]
    ds_read_b128 a[60:63], v15 offset:256
    s_add_u32 s62, s62, 1
    s_cmp_eq_u32 s62, 6
    s_cselect_b32 s63, s64, 16384
    v_mfma_f32_32x32x16_bf16 v[224:239], a[116:119], v[68:71], v[224:239]
    s_cselect_b32 s62, 0, s62
    v_add_u32 v8, s63, v8
    v_add_u32 v9, s63, v9
    v_add_u32 v10, s63, v10
    v_mfma_f32_32x32x16_bf16 v[240:255], a[124:127], v[68:71], v[240:255]
    v_add_u32 v11, s63, v11
    v_add_u32 v12, s63, v12
    v_add_u32 v13, s63, v13
    v_add_u32 v14, s63, v14
    v_add_u32 v15, s63, v15
    s_cbranch_vccnz attn_rs_3
attn_rsb_4:
    s_waitcnt lgkmcnt(0)
    s_waitcnt vmcnt(0)
    s_barrier
    v_mfma_f32_32x32x16_bf16 v[32:47], a[0:3], a[128:131], 0
    v_fma_f32 v48, v48, s50, -v72
    ds_read_b64_tr_b16 a[68:69], v16 offset:57344
    v_fma_f32 v49, v49, s50, -v72
    v_exp_f32 v48, v48
    v_mfma_f32_32x32x16_bf16 v[32:47], a[4:7], a[132:135], v[32:47]
    v_fma_f32 v50, v50, s50, -v72
    v_exp_f32 v49, v49
    v_add_f32 v73, v73, v48
    v_fma_f32 v51, v51, s50, -v72
    v_mfma_f32_32x32x16_bf16 v[32:47], a[8:11], a[136:139], v[32:47]
    v_exp_f32 v50, v50
    ds_read_b64_tr_b16 a[70:71], v16 offset:61440
    v_add_f32 v73, v73, v49
    v_cvt_pk_bf16_f32 v64, v48, v49
    v_mfma_f32_32x32x16_bf16 v[32:47], a[12:15], a[140:143], v[32:47]
    v_fma_f32 v52, v52, s50, -v72
    v_exp_f32 v51, v51
    v_add_f32 v73, v73, v50
    v_fma_f32 v53, v53, s50, -v72
    v_mfma_f32_32x32x16_bf16 v[32:47], a[16:19], a[144:147], v[32:47]
    v_exp_f32 v52, v52
    ds_read_b64_tr_b16 a[76:77], v17 offset:57344
    v_add_f32 v73, v73, v51
    v_cvt_pk_bf16_f32 v65, v50, v51
    v_mfma_f32_32x32x16_bf16 v[32:47], a[20:23], a[148:151], v[32:47]
    v_fma_f32 v54, v54, s50, -v72
    v_exp_f32 v53, v53
    v_add_f32 v73, v73, v52
    v_fma_f32 v55, v55, s50, -v72
    v_mfma_f32_32x32x16_bf16 v[32:47], a[24:27], a[152:155], v[32:47]
    v_exp_f32 v54, v54
    ds_read_b64_tr_b16 a[78:79], v17 offset:61440
    v_add_f32 v73, v73, v53
    v_cvt_pk_bf16_f32 v66, v52, v53
    v_mfma_f32_32x32x16_bf16 v[32:47], a[28:31], a[156:159], v[32:47]
    v_exp_f32 v55, v55
    v_add_f32 v73, v73, v54
    v_add_f32 v73, v73, v55
    v_cvt_pk_bf16_f32 v67, v54, v55
    s_nop 1
    v_mfma_f32_32x32x16_bf16 v[128:143], a[64:67], v[64:67], v[128:143]
    v_fma_f32 v56, v56, s50, -v72
    ds_read_b64_tr_b16 a[84:85], v18 offset:57344
    ds_read_b64_tr_b16 a[86:87], v18 offset:61440
    v_fma_f32 v57, v57, s50, -v72
    v_mfma_f32_32x32x16_bf16 v[144:159], a[72:75], v[64:67], v[144:159]
    ds_read_b64_tr_b16 a[92:93], v19 offset:57344
    v_exp_f32 v56, v56
    ds_read_b64_tr_b16 a[94:95], v19 offset:61440
    v_fma_f32 v58, v58, s50, -v72
    v_mfma_f32_32x32x16_bf16 v[160:175], a[80:83], v[64:67], v[160:175]
    ds_read_b64_tr_b16 a[100:101], v16 offset:57600
    ds_read_b64_tr_b16 a[102:103], v16 offset:61696
    v_exp_f32 v57, v57
    ds_read_b64_tr_b16 a[108:109], v17 offset:57600
    v_mfma_f32_32x32x16_bf16 v[176:191], a[88:91], v[64:67], v[176:191]
    v_add_f32 v73, v73, v56
    ds_read_b64_tr_b16 a[110:111], v17 offset:61696
    v_fma_f32 v59, v59, s50, -v72
    ds_read_b64_tr_b16 a[116:117], v18 offset:57600
    v_mfma_f32_32x32x16_bf16 v[192:207], a[96:99], v[64:67], v[192:207]
    v_exp_f32 v58, v58
    ds_read_b64_tr_b16 a[118:119], v18 offset:61696
    ds_read_b64_tr_b16 a[124:125], v19 offset:57600
    v_add_f32 v73, v73, v57
    v_mfma_f32_32x32x16_bf16 v[208:223], a[104:107], v[64:67], v[208:223]
    ds_read_b64_tr_b16 a[126:127], v19 offset:61696
    v_cvt_pk_bf16_f32 v68, v56, v57
    ds_read_b128 a[0:3], v8 offset:0
    v_exp_f32 v59, v59
    v_mfma_f32_32x32x16_bf16 v[224:239], a[112:115], v[64:67], v[224:239]
    ds_read_b128 a[4:7], v9 offset:0
    ds_read_b128 a[8:11], v10 offset:0
    v_add_f32 v73, v73, v58
    ds_read_b128 a[12:15], v11 offset:0
    v_mfma_f32_32x32x16_bf16 v[240:255], a[120:123], v[64:67], v[240:255]
    v_add_f32 v73, v73, v59
    ds_read_b128 a[16:19], v12 offset:0
    v_cvt_pk_bf16_f32 v69, v58, v59
    ds_read_b128 a[20:23], v13 offset:0
    v_mfma_f32_32x32x16_bf16 v[32:47], a[32:35], a[160:163], v[32:47]
    v_fma_f32 v60, v60, s50, -v72
    ds_read_b128 a[24:27], v14 offset:0
    ds_read_b128 a[28:31], v15 offset:0
    v_fma_f32 v61, v61, s50, -v72
    v_mfma_f32_32x32x16_bf16 v[32:47], a[36:39], a[164:167], v[32:47]
    ds_read_b64_tr_b16 a[64:65], v16 offset:0
    v_exp_f32 v60, v60
    ds_read_b64_tr_b16 a[66:67], v16 offset:4096
    v_fma_f32 v62, v62, s50, -v72
    v_mfma_f32_32x32x16_bf16 v[32:47], a[40:43], a[168:171], v[32:47]
    ds_read_b64_tr_b16 a[72:73], v17 offset:0
    ds_read_b64_tr_b16 a[74:75], v17 offset:4096
    v_exp_f32 v61, v61
    ds_read_b64_tr_b16 a[80:81], v18 offset:0
    v_mfma_f32_32x32x16_bf16 v[32:47], a[44:47], a[172:175], v[32:47]
    v_add_f32 v73, v73, v60
    ds_read_b64_tr_b16 a[82:83], v18 offset:4096
    v_fma_f32 v63, v63, s50, -v72
    ds_read_b64_tr_b16 a[88:89], v19 offset:0
    v_mfma_f32_32x32x16_bf16 v[32:47], a[48:51], a[176:179], v[32:47]
    v_exp_f32 v62, v62
    ds_read_b64_tr_b16 a[90:91], v19 offset:4096
    ds_read_b64_tr_b16 a[96:97], v16 offset:256
    v_add_f32 v73, v73, v61
    v_mfma_f32_32x32x16_bf16 v[32:47], a[52:55], a[180:183], v[32:47]
    ds_read_b64_tr_b16 a[98:99], v16 offset:4352
    v_cvt_pk_bf16_f32 v70, v60, v61
    ds_read_b64_tr_b16 a[104:105], v17 offset:256
    v_exp_f32 v63, v63
    v_mfma_f32_32x32x16_bf16 v[32:47], a[56:59], a[184:187], v[32:47]
    ds_read_b64_tr_b16 a[106:107], v17 offset:4352
    ds_read_b64_tr_b16 a[112:113], v18 offset:256
    v_add_f32 v73, v73, v62
    ds_read_b64_tr_b16 a[114:115], v18 offset:4352
    v_mfma_f32_32x32x16_bf16 v[32:47], a[60:63], a[188:191], v[32:47]
    v_add_f32 v73, v73, v63
    ds_read_b64_tr_b16 a[120:121], v19 offset:256
    v_cvt_pk_bf16_f32 v71, v62, v63
    ds_read_b64_tr_b16 a[122:123], v19 offset:4352
    s_waitcnt lgkmcnt(15)
    v_mfma_f32_32x32x16_bf16 v[128:143], a[68:71], v[68:71], v[128:143]
    ds_read_b128 a[32:35], v8 offset:256
    ds_read_b128 a[36:39], v9 offset:256
    ds_read_b128 a[40:43], v10 offset:256
    ds_read_b128 a[44:47], v11 offset:256
    v_mfma_f32_32x32x16_bf16 v[144:159], a[76:79], v[68:71], v[144:159]
    s_nop 0
    v_max3_f32 v74, v32, v33, v34
    v_max3_f32 v74, v74, v35, v36
    v_max3_f32 v74, v74, v37, v38
    v_max3_f32 v74, v74, v39, v40
    v_mfma_f32_32x32x16_bf16 v[160:175], a[84:87], v[68:71], v[160:175]
    v_max3_f32 v74, v74, v41, v42
    v_max3_f32 v74, v74, v43, v44
    v_max3_f32 v74, v74, v45, v46
    v_max_f32 v74, v74, v47
    v_mfma_f32_32x32x16_bf16 v[176:191], a[92:95], v[68:71], v[176:191]
    v_mov_b32 v75, v74
    s_nop 1
    v_permlane32_swap_b32 v74, v75
    v_max_f32 v74, v74, v75
    v_mul_f32 v74, s50, v74
    v_sub_f32 v75, v74, v72
    v_mfma_f32_32x32x16_bf16 v[192:207], a[100:103], v[68:71], v[192:207]
    v_cmp_lt_f32 vcc, 0x41000000, v75
    ds_read_b128 a[48:51], v12 offset:256
    ds_read_b128 a[52:55], v13 offset:256
    ds_read_b128 a[56:59], v14 offset:256
    v_mfma_f32_32x32x16_bf16 v[208:223], a[108:111], v[68:71], v[208:223]
    ds_read_b128 a[60:63], v15 offset:256
    s_add_u32 s62, s62, 1
    s_cmp_eq_u32 s62, 6
    s_cselect_b32 s63, s64, 16384
    v_mfma_f32_32x32x16_bf16 v[224:239], a[116:119], v[68:71], v[224:239]
    s_cselect_b32 s62, 0, s62
    v_add_u32 v8, s63, v8
    v_add_u32 v9, s63, v9
    v_add_u32 v10, s63, v10
    v_mfma_f32_32x32x16_bf16 v[240:255], a[124:127], v[68:71], v[240:255]
    v_add_u32 v11, s63, v11
    v_add_u32 v12, s63, v12
    v_add_u32 v13, s63, v13
    v_add_u32 v14, s63, v14
    v_add_u32 v15, s63, v15
    s_cbranch_vccnz attn_rs_5
attn_rsb_6:
    s_waitcnt lgkmcnt(0)
    s_waitcnt vmcnt(0)
    s_barrier
    v_mfma_f32_32x32x16_bf16 v[48:63], a[0:3], a[128:131], 0
    v_fma_f32 v32, v32, s50, -v72
    ds_read_b64_tr_b16 a[68:69], v16 offset:8192
    v_fma_f32 v33, v33, s50, -v72
    v_exp_f32 v32, v32
    v_mfma_f32_32x32x16_bf16 v[48:63], a[4:7], a[132:135], v[48:63]
    v_fma_f32 v34, v34, s50, -v72
    v_exp_f32 v33, v33
    v_add_f32 v73, v73, v32
    v_fma_f32 v35, v35, s50, -v72
    v_mfma_f32_32x32x16_bf16 v[48:63], a[8:11], a[136:139], v[48:63]
    v_exp_f32 v34, v34
    ds_read_b64_tr_b16 a[70:71], v16 offset:12288
    v_add_f32 v73, v73, v33
    v_cvt_pk_bf16_f32 v64, v32, v33
    v_mfma_f32_32x32x16_bf16 v[48:63], a[12:15], a[140:143], v[48:63]
    v_fma_f32 v36, v36, s50, -v72
    v_exp_f32 v35, v35
    v_add_f32 v73, v73, v34
    v_fma_f32 v37, v37, s50, -v72
    v_mfma_f32_32x32x16_bf16 v[48:63], a[16:19], a[144:147], v[48:63]
    v_exp_f32 v36, v36
    ds_read_b64_tr_b16 a[76:77], v17 offset:8192
    v_add_f32 v73, v73, v35
    v_cvt_pk_bf16_f32 v65, v34, v35
    v_mfma_f32_32x32x16_bf16 v[48:63], a[20:23], a[148:151], v[48:63]
    v_fma_f32 v38, v38, s50, -v72
    v_exp_f32 v37, v37
    v_add_f32 v73, v73, v36
    v_fma_f32 v39, v39, s50, -v72
    v_mfma_f32_32x32x16_bf16 v[48:63], a[24:27], a[152:155], v[48:63]
    v_exp_f32 v38, v38
    ds_read_b64_tr_b16 a[78:79], v17 offset:12288
    v_add_f32 v73, v73, v37
    v_cvt_pk_bf16_f32 v66, v36, v37
    v_mfma_f32_32x32x16_bf16 v[48:63], a[28:31], a[156:159], v[48:63]
    v_exp_f32 v39, v39
    v_add_f32 v73, v73, v38
    v_add_f32 v73, v73, v39
    v_cvt_pk_bf16_f32 v67, v38, v39
    s_nop 1
    v_mfma_f32_32x32x16_bf16 v[128:143], a[64:67], v[64:67], v[128:143]
    v_fma_f32 v40, v40, s50, -v72
    ds_read_b64_tr_b16 a[84:85], v18 offset:8192
    ds_read_b64_tr_b16 a[86:87], v18 offset:12288
    v_fma_f32 v41, v41, s50, -v72
    v_mfma_f32_32x32x16_bf16 v[144:159], a[72:75], v[64:67], v[144:159]
    ds_read_b64_tr_b16 a[92:93], v19 offset:8192
    v_exp_f32 v40, v40
    ds_read_b64_tr_b16 a[94:95], v19 offset:12288
    v_fma_f32 v42, v42, s50, -v72
    v_mfma_f32_32x32x16_bf16 v[160:175], a[80:83], v[64:67], v[160:175]
    ds_read_b64_tr_b16 a[100:101], v16 offset:8448
    ds_read_b64_tr_b16 a[102:103], v16 offset:12544
    v_exp_f32 v41, v41
    ds_read_b64_tr_b16 a[108:109], v17 offset:8448
    v_mfma_f32_32x32x16_bf16 v[176:191], a[88:91], v[64:67], v[176:191]
    v_add_f32 v73, v73, v40
    ds_read_b64_tr_b16 a[110:111], v17 offset:12544
    v_fma_f32 v43, v43, s50, -v72
    ds_read_b64_tr_b16 a[116:117], v18 offset:8448
    v_mfma_f32_32x32x16_bf16 v[192:207], a[96:99], v[64:67], v[192:207]
    v_exp_f32 v42, v42
    ds_read_b64_tr_b16 a[118:119], v18 offset:12544
    ds_read_b64_tr_b16 a[124:125], v19 offset:8448
    v_add_f32 v73, v73, v41
    v_mfma_f32_32x32x16_bf16 v[208:223], a[104:107], v[64:67], v[208:223]
    ds_read_b64_tr_b16 a[126:127], v19 offset:12544
    v_cvt_pk_bf16_f32 v68, v40, v41
    ds_read_b128 a[0:3], v8 offset:0
    v_exp_f32 v43, v43
    v_mfma_f32_32x32x16_bf16 v[224:239], a[112:115], v[64:67], v[224:239]
    ds_read_b128 a[4:7], v9 offset:0
    ds_read_b128 a[8:11], v10 offset:0
    v_add_f32 v73, v73, v42
    ds_read_b128 a[12:15], v11 offset:0
    v_mfma_f32_32x32x16_bf16 v[240:255], a[120:123], v[64:67], v[240:255]
    v_add_f32 v73, v73, v43
    ds_read_b128 a[16:19], v12 offset:0
    v_cvt_pk_bf16_f32 v69, v42, v43
    ds_read_b128 a[20:23], v13 offset:0
    v_mfma_f32_32x32x16_bf16 v[48:63], a[32:35], a[160:163], v[48:63]
    v_fma_f32 v44, v44, s50, -v72
    ds_read_b128 a[24:27], v14 offset:0
    ds_read_b128 a[28:31], v15 offset:0
    v_fma_f32 v45, v45, s50, -v72
    v_mfma_f32_32x32x16_bf16 v[48:63], a[36:39], a[164:167], v[48:63]
    ds_read_b64_tr_b16 a[64:65], v16 offset:16384
    v_exp_f32 v44, v44
    ds_read_b64_tr_b16 a[66:67], v16 offset:20480
    v_fma_f32 v46, v46, s50, -v72
    v_mfma_f32_32x32x16_bf16 v[48:63], a[40:43], a[168:171], v[48:63]
    ds_read_b64_tr_b16 a[72:73], v17 offset:16384
    ds_read_b64_tr_b16 a[74:75], v17 offset:20480
    v_exp_f32 v45, v45
    ds_read_b64_tr_b16 a[80:81], v18 offset:16384
    v_mfma_f32_32x32x16_bf16 v[48:63], a[44:47], a[172:175], v[48:63]
    v_add_f32 v73, v73, v44
    ds_read_b64_tr_b16 a[82:83], v18 offset:20480
    v_fma_f32 v47, v47, s50, -v72
    ds_read_b64_tr_b16 a[88:89], v19 offset:16384
    v_mfma_f32_32x32x16_bf16 v[48:63], a[48:51], a[176:179], v[48:63]
    v_exp_f32 v46, v46
    ds_read_b64_tr_b16 a[90:91], v19 offset:20480
    ds_read_b64_tr_b16 a[96:97], v16 offset:16640
    v_add_f32 v73, v73, v45
    v_mfma_f32_32x32x16_bf16 v[48:63], a[52:55], a[180:183], v[48:63]
    ds_read_b64_tr_b16 a[98:99], v16 offset:20736
    v_cvt_pk_bf16_f32 v70, v44, v45
    ds_read_b64_tr_b16 a[104:105], v17 offset:16640
    v_exp_f32 v47, v47
    v_mfma_f32_32x32x16_bf16 v[48:63], a[56:59], a[184:187], v[48:63]
    ds_read_b64_tr_b16 a[106:107], v17 offset:20736
    ds_read_b64_tr_b16 a[112:113], v18 offset:16640
    v_add_f32 v73, v73, v46
    ds_read_b64_tr_b16 a[114:115], v18 offset:20736
    v_mfma_f32_32x32x16_bf16 v[48:63], a[60:63], a[188:191], v[48:63]
    v_add_f32 v73, v73, v47
    ds_read_b64_tr_b16 a[120:121], v19 offset:16640
    v_cvt_pk_bf16_f32 v71, v46, v47
    ds_read_b64_tr_b16 a[122:123], v19 offset:20736
    s_waitcnt lgkmcnt(15)
    v_mfma_f32_32x32x16_bf16 v[128:143], a[68:71], v[68:71], v[128:143]
    ds_read_b128 a[32:35], v8 offset:256
    ds_read_b128 a[36:39], v9 offset:256
    ds_read_b128 a[40:43], v10 offset:256
    ds_read_b128 a[44:47], v11 offset:256
    v_mfma_f32_32x32x16_bf16 v[144:159], a[76:79], v[68:71], v[144:159]
    s_nop 0
    v_max3_f32 v74, v48, v49, v50
    v_max3_f32 v74, v74, v51, v52
    v_max3_f32 v74, v74, v53, v54
    v_max3_f32 v74, v74, v55, v56
    v_mfma_f32_32x32x16_bf16 v[160:175], a[84:87], v[68:71], v[160:175]
    v_max3_f32 v74, v74, v57, v58
    v_max3_f32 v74, v74, v59, v60
    v_max3_f32 v74, v74, v61, v62
    v_max_f32 v74, v74, v63
    v_mfma_f32_32x32x16_bf16 v[176:191], a[92:95], v[68:71], v[176:191]
    v_mov_b32 v75, v74
    s_nop 1
    v_permlane32_swap_b32 v74, v75
    v_max_f32 v74, v74, v75
    v_mul_f32 v74, s50, v74
    v_sub_f32 v75, v74, v72
    v_mfma_f32_32x32x16_bf16 v[192:207], a[100:103], v[68:71], v[192:207]
    v_cmp_lt_f32 vcc, 0x41000000, v75
    ds_read_b128 a[48:51], v12 offset:256
    ds_read_b128 a[52:55], v13 offset:256
    ds_read_b128 a[56:59], v14 offset:256
    v_mfma_f32_32x32x16_bf16 v[208:223], a[108:111], v[68:71], v[208:223]
    ds_read_b128 a[60:63], v15 offset:256
    s_add_u32 s62, s62, 1
    s_cmp_eq_u32 s62, 6
    s_cselect_b32 s63, s64, 16384
    v_mfma_f32_32x32x16_bf16 v[224:239], a[116:119], v[68:71], v[224:239]
    s_cselect_b32 s62, 0, s62
    v_add_u32 v8, s63, v8
    v_add_u32 v9, s63, v9
    v_add_u32 v10, s63, v10
    v_mfma_f32_32x32x16_bf16 v[240:255], a[124:127], v[68:71], v[240:255]
    v_add_u32 v11, s63, v11
    v_add_u32 v12, s63, v12
    v_add_u32 v13, s63, v13
    v_add_u32 v14, s63, v14
    v_add_u32 v15, s63, v15
    s_cbranch_vccnz attn_rs_7
attn_rsb_8:
    s_waitcnt lgkmcnt(0)
    s_waitcnt vmcnt(0)
    s_barrier
    v_mfma_f32_32x32x16_bf16 v[32:47], a[0:3], a[128:131], 0
    v_fma_f32 v48, v48, s50, -v72
    ds_read_b64_tr_b16 a[68:69], v16 offset:24576
    v_fma_f32 v49, v49, s50, -v72
    v_exp_f32 v48, v48
    v_mfma_f32_32x32x16_bf16 v[32:47], a[4:7], a[132:135], v[32:47]
    v_fma_f32 v50, v50, s50, -v72
    v_exp_f32 v49, v49
    v_add_f32 v73, v73, v48
    v_fma_f32 v51, v51, s50, -v72
    v_mfma_f32_32x32x16_bf16 v[32:47], a[8:11], a[136:139], v[32:47]
    v_exp_f32 v50, v50
    ds_read_b64_tr_b16 a[70:71], v16 offset:28672
    v_add_f32 v73, v73, v49
    v_cvt_pk_bf16_f32 v64, v48, v49
    v_mfma_f32_32x32x16_bf16 v[32:47], a[12:15], a[140:143], v[32:47]
    v_fma_f32 v52, v52, s50, -v72
    v_exp_f32 v51, v51
    v_add_f32 v73, v73, v50
    v_fma_f32 v53, v53, s50, -v72
    v_mfma_f32_32x32x16_bf16 v[32:47], a[16:19], a[144:147], v[32:47]
    v_exp_f32 v52, v52
    ds_read_b64_tr_b16 a[76:77], v17 offset:24576
    v_add_f32 v73, v73, v51
    v_cvt_pk_bf16_f32 v65, v50, v51
    v_mfma_f32_32x32x16_bf16 v[32:47], a[20:23], a[148:151], v[32:47]
    v_fma_f32 v54, v54, s50, -v72
    v_exp_f32 v53, v53
    v_add_f32 v73, v73, v52
    v_fma_f32 v55, v55, s50, -v72
    v_mfma_f32_32x32x16_bf16 v[32:47], a[24:27], a[152:155], v[32:47]
    v_exp_f32 v54, v54
    ds_read_b64_tr_b16 a[78:79], v17 offset:28672
    v_add_f32 v73, v73, v53
    v_cvt_pk_bf16_f32 v66, v52, v53
    v_mfma_f32_32x32x16_bf16 v[32:47], a[28:31], a[156:159], v[32:47]
    v_exp_f32 v55, v55
    v_add_f32 v73, v73, v54
    v_add_f32 v73, v73, v55
    v_cvt_pk_bf16_f32 v67, v54, v55
    s_nop 1
    v_mfma_f32_32x32x16_bf16 v[128:143], a[64:67], v[64:67], v[128:143]
    v_fma_f32 v56, v56, s50, -v72
    ds_read_b64_tr_b16 a[84:85], v18 offset:24576
    ds_read_b64_tr_b16 a[86:87], v18 offset:28672
    v_fma_f32 v57, v57, s50, -v72
    v_mfma_f32_32x32x16_bf16 v[144:159], a[72:75], v[64:67], v[144:159]
    ds_read_b64_tr_b16 a[92:93], v19 offset:24576
    v_exp_f32 v56, v56
    ds_read_b64_tr_b16 a[94:95], v19 offset:28672
    v_fma_f32 v58, v58, s50, -v72
    v_mfma_f32_32x32x16_bf16 v[160:175], a[80:83], v[64:67], v[160:175]
    ds_read_b64_tr_b16 a[100:101], v16 offset:24832
    ds_read_b64_tr_b16 a[102:103], v16 offset:28928
    v_exp_f32 v57, v57
    ds_read_b64_tr_b16 a[108:109], v17 offset:24832
    v_mfma_f32_32x32x16_bf16 v[176:191], a[88:91], v[64:67], v[176:191]
    v_add_f32 v73, v73, v56
    ds_read_b64_tr_b16 a[110:111], v17 offset:28928
    v_fma_f32 v59, v59, s50, -v72
    ds_read_b64_tr_b16 a[116:117], v18 offset:24832
    v_mfma_f32_32x32x16_bf16 v[192:207], a[96:99], v[64:67], v[192:207]
    v_exp_f32 v58, v58
    ds_read_b64_tr_b16 a[118:119], v18 offset:28928
    ds_read_b64_tr_b16 a[124:125], v19 offset:24832
    v_add_f32 v73, v73, v57
    v_mfma_f32_32x32x16_bf16 v[208:223], a[104:107], v[64:67], v[208:223]
    ds_read_b64_tr_b16 a[126:127], v19 offset:28928
    v_cvt_pk_bf16_f32 v68, v56, v57
    ds_read_b128 a[0:3], v8 offset:0
    v_exp_f32 v59, v59
    v_mfma_f32_32x32x16_bf16 v[224:239], a[112:115], v[64:67], v[224:239]
    ds_read_b128 a[4:7], v9 offset:0
    ds_read_b128 a[8:11], v10 offset:0
    v_add_f32 v73, v73, v58
    ds_read_b128 a[12:15], v11 offset:0
    v_mfma_f32_32x32x16_bf16 v[240:255], a[120:123], v[64:67], v[240:255]
    v_add_f32 v73, v73, v59
    ds_read_b128 a[16:19], v12 offset:0
    v_cvt_pk_bf16_f32 v69, v58, v59
    ds_read_b128 a[20:23], v13 offset:0
    v_mfma_f32_32x32x16_bf16 v[32:47], a[32:35], a[160:163], v[32:47]
    v_fma_f32 v60, v60, s50, -v72
    ds_read_b128 a[24:27], v14 offset:0
    ds_read_b128 a[28:31], v15 offset:0
    v_fma_f32 v61, v61, s50, -v72
    v_mfma_f32_32x32x16_bf16 v[32:47], a[36:39], a[164:167], v[32:47]
    ds_read_b64_tr_b16 a[64:65], v16 offset:32768
    v_exp_f32 v60, v60
    ds_read_b64_tr_b16 a[66:67], v16 offset:36864
    v_fma_f32 v62, v62, s50, -v72
    v_mfma_f32_32x32x16_bf16 v[32:47], a[40:43], a[168:171], v[32:47]
    ds_read_b64_tr_b16 a[72:73], v17 offset:32768
    ds_read_b64_tr_b16 a[74:75], v17 offset:36864
    v_exp_f32 v61, v61
    ds_read_b64_tr_b16 a[80:81], v18 offset:32768
    v_mfma_f32_32x32x16_bf16 v[32:47], a[44:47], a[172:175], v[32:47]
    v_add_f32 v73, v73, v60
    ds_read_b64_tr_b16 a[82:83], v18 offset:36864
    v_fma_f32 v63, v63, s50, -v72
    ds_read_b64_tr_b16 a[88:89], v19 offset:32768
    v_mfma_f32_32x32x16_bf16 v[32:47], a[48:51], a[176:179], v[32:47]
    v_exp_f32 v62, v62
    ds_read_b64_tr_b16 a[90:91], v19 offset:36864
    ds_read_b64_tr_b16 a[96:97], v16 offset:33024
    v_add_f32 v73, v73, v61
    v_mfma_f32_32x32x16_bf16 v[32:47], a[52:55], a[180:183], v[32:47]
    ds_read_b64_tr_b16 a[98:99], v16 offset:37120
    v_cvt_pk_bf16_f32 v70, v60, v61
    ds_read_b64_tr_b16 a[104:105], v17 offset:33024
    v_exp_f32 v63, v63
    v_mfma_f32_32x32x16_bf16 v[32:47], a[56:59], a[184:187], v[32:47]
    ds_read_b64_tr_b16 a[106:107], v17 offset:37120
    ds_read_b64_tr_b16 a[112:113], v18 offset:33024
    v_add_f32 v73, v73, v62
    ds_read_b64_tr_b16 a[114:115], v18 offset:37120
    v_mfma_f32_32x32x16_bf16 v[32:47], a[60:63], a[188:191], v[32:47]
    v_add_f32 v73, v73, v63
    ds_read_b64_tr_b16 a[120:121], v19 offset:33024
    v_cvt_pk_bf16_f32 v71, v62, v63
    ds_read_b64_tr_b16 a[122:123], v19 offset:37120
    s_waitcnt lgkmcnt(15)
    v_mfma_f32_32x32x16_bf16 v[128:143], a[68:71], v[68:71], v[128:143]
    ds_read_b128 a[32:35], v8 offset:256
    ds_read_b128 a[36:39], v9 offset:256
    ds_read_b128 a[40:43], v10 offset:256
    ds_read_b128 a[44:47], v11 offset:256
    v_mfma_f32_32x32x16_bf16 v[144:159], a[76:79], v[68:71], v[144:159]
    s_nop 0
    v_max3_f32 v74, v32, v33, v34
    v_max3_f32 v74, v74, v35, v36
    v_max3_f32 v74, v74, v37, v38
    v_max3_f32 v74, v74, v39, v40
    v_mfma_f32_32x32x16_bf16 v[160:175], a[84:87], v[68:71], v[160:175]
    v_max3_f32 v74, v74, v41, v42
    v_max3_f32 v74, v74, v43, v44
    v_max3_f32 v74, v74, v45, v46
    v_max_f32 v74, v74, v47
    v_mfma_f32_32x32x16_bf16 v[176:191], a[92:95], v[68:71], v[176:191]
    v_mov_b32 v75, v74
    s_nop 1
    v_permlane32_swap_b32 v74, v75
    v_max_f32 v74, v74, v75
    v_mul_f32 v74, s50, v74
    v_sub_f32 v75, v74, v72
    v_mfma_f32_32x32x16_bf16 v[192:207], a[100:103], v[68:71], v[192:207]
    v_cmp_lt_f32 vcc, 0x41000000, v75
    ds_read_b128 a[48:51], v12 offset:256
    ds_read_b128 a[52:55], v13 offset:256
    ds_read_b128 a[56:59], v14 offset:256
    v_mfma_f32_32x32x16_bf16 v[208:223], a[108:111], v[68:71], v[208:223]
    ds_read_b128 a[60:63], v15 offset:256
    s_add_u32 s62, s62, 1
    s_cmp_eq_u32 s62, 6
    s_cselect_b32 s63, s64, 16384
    v_mfma_f32_32x32x16_bf16 v[224:239], a[116:119], v[68:71], v[224:239]
    s_cselect_b32 s62, 0, s62
    v_add_u32 v8, s63, v8
    v_add_u32 v9, s63, v9
    v_add_u32 v10, s63, v10
    v_mfma_f32_32x32x16_bf16 v[240:255], a[124:127], v[68:71], v[240:255]
    v_add_u32 v11, s63, v11
    v_add_u32 v12, s63, v12
    v_add_u32 v13, s63, v13
    v_add_u32 v14, s63, v14
    v_add_u32 v15, s63, v15
    s_cbranch_vccnz attn_rs_9
attn_rsb_10:
    s_waitcnt lgkmcnt(0)
    s_add_u32 s51, s51, 1
    s_cmp_lt_u32 s51, 7
    s_cbranch_scc1 attn_loop
    s_waitcnt vmcnt(0)
    s_barrier
    v_mfma_f32_32x32x16_bf16 v[48:63], a[0:3], a[128:131], 0
    v_fma_f32 v32, v32, s50, -v72
    ds_read_b64_tr_b16 a[68:69], v16 offset:40960
    v_fma_f32 v33, v33, s50, -v72
    v_exp_f32 v32, v32
    v_mfma_f32_32x32x16_bf16 v[48:63], a[4:7], a[132:135], v[48:63]
    v_fma_f32 v34, v34, s50, -v72
    v_exp_f32 v33, v33
    v_add_f32 v73, v73, v32
    v_fma_f32 v35, v35, s50, -v72
    v_mfma_f32_32x32x16_bf16 v[48:63], a[8:11], a[136:139], v[48:63]
    v_exp_f32 v34, v34
    ds_read_b64_tr_b16 a[70:71], v16 offset:45056
    v_add_f32 v73, v73, v33
    v_cvt_pk_bf16_f32 v64, v32, v33
    v_mfma_f32_32x32x16_bf16 v[48:63], a[12:15], a[140:143], v[48:63]
    v_fma_f32 v36, v36, s50, -v72
    v_exp_f32 v35, v35
    v_add_f32 v73, v73, v34
    v_fma_f32 v37, v37, s50, -v72
    v_mfma_f32_32x32x16_bf16 v[48:63], a[16:19], a[144:147], v[48:63]
    v_exp_f32 v36, v36
    ds_read_b64_tr_b16 a[76:77], v17 offset:40960
    v_add_f32 v73, v73, v35
    v_cvt_pk_bf16_f32 v65, v34, v35
    v_mfma_f32_32x32x16_bf16 v[48:63], a[20:23], a[148:151], v[48:63]
    v_fma_f32 v38, v38, s50, -v72
    v_exp_f32 v37, v37
    v_add_f32 v73, v73, v36
    v_fma_f32 v39, v39, s50, -v72
    v_mfma_f32_32x32x16_bf16 v[48:63], a[24:27], a[152:155], v[48:63]
    v_exp_f32 v38, v38
    ds_read_b64_tr_b16 a[78:79], v17 offset:45056
    v_add_f32 v73, v73, v37
    v_cvt_pk_bf16_f32 v66, v36, v37
    v_mfma_f32_32x32x16_bf16 v[48:63], a[28:31], a[156:159], v[48:63]
    v_exp_f32 v39, v39
    v_add_f32 v73, v73, v38
    v_add_f32 v73, v73, v39
    v_cvt_pk_bf16_f32 v67, v38, v39
    s_nop 1
    v_mfma_f32_32x32x16_bf16 v[128:143], a[64:67], v[64:67], v[128:143]
    v_fma_f32 v40, v40, s50, -v72
    ds_read_b64_tr_b16 a[84:85], v18 offset:40960
    ds_read_b64_tr_b16 a[86:87], v18 offset:45056
    v_fma_f32 v41, v41, s50, -v72
    v_mfma_f32_32x32x16_bf16 v[144:159], a[72:75], v[64:67], v[144:159]
    ds_read_b64_tr_b16 a[92:93], v19 offset:40960
    v_exp_f32 v40, v40
    ds_read_b64_tr_b16 a[94:95], v19 offset:45056
    v_fma_f32 v42, v42, s50, -v72
    v_mfma_f32_32x32x16_bf16 v[160:175], a[80:83], v[64:67], v[160:175]
    ds_read_b64_tr_b16 a[100:101], v16 offset:41216
    ds_read_b64_tr_b16 a[102:103], v16 offset:45312
    v_exp_f32 v41, v41
    ds_read_b64_tr_b16 a[108:109], v17 offset:41216
    v_mfma_f32_32x32x16_bf16 v[176:191], a[88:91], v[64:67], v[176:191]
    v_add_f32 v73, v73, v40
    ds_read_b64_tr_b16 a[110:111], v17 offset:45312
    v_fma_f32 v43, v43, s50, -v72
    ds_read_b64_tr_b16 a[116:117], v18 offset:41216
    v_mfma_f32_32x32x16_bf16 v[192:207], a[96:99], v[64:67], v[192:207]
    v_exp_f32 v42, v42
    ds_read_b64_tr_b16 a[118:119], v18 offset:45312
    ds_read_b64_tr_b16 a[124:125], v19 offset:41216
    v_add_f32 v73, v73, v41
    v_mfma_f32_32x32x16_bf16 v[208:223], a[104:107], v[64:67], v[208:223]
    ds_read_b64_tr_b16 a[126:127], v19 offset:45312
    v_cvt_pk_bf16_f32 v68, v40, v41
    ds_read_b128 a[0:3], v8 offset:0
    v_exp_f32 v43, v43
    v_mfma_f32_32x32x16_bf16 v[224:239], a[112:115], v[64:67], v[224:239]
    ds_read_b128 a[4:7], v9 offset:0
    ds_read_b128 a[8:11], v10 offset:0
    v_add_f32 v73, v73, v42
    ds_read_b128 a[12:15], v11 offset:0
    v_mfma_f32_32x32x16_bf16 v[240:255], a[120:123], v[64:67], v[240:255]
    v_add_f32 v73, v73, v43
    ds_read_b128 a[16:19], v12 offset:0
    v_cvt_pk_bf16_f32 v69, v42, v43
    ds_read_b128 a[20:23], v13 offset:0
    v_mfma_f32_32x32x16_bf16 v[48:63], a[32:35], a[160:163], v[48:63]
    v_fma_f32 v44, v44, s50, -v72
    ds_read_b128 a[24:27], v14 offset:0
    ds_read_b128 a[28:31], v15 offset:0
    v_fma_f32 v45, v45, s50, -v72
    v_mfma_f32_32x32x16_bf16 v[48:63], a[36:39], a[164:167], v[48:63]
    ds_read_b64_tr_b16 a[64:65], v16 offset:49152
    v_exp_f32 v44, v44
    ds_read_b64_tr_b16 a[66:67], v16 offset:53248
    v_fma_f32 v46, v46, s50, -v72
    v_mfma_f32_32x32x16_bf16 v[48:63], a[40:43], a[168:171], v[48:63]
    ds_read_b64_tr_b16 a[72:73], v17 offset:49152
    ds_read_b64_tr_b16 a[74:75], v17 offset:53248
    v_exp_f32 v45, v45
    ds_read_b64_tr_b16 a[80:81], v18 offset:49152
    v_mfma_f32_32x32x16_bf16 v[48:63], a[44:47], a[172:175], v[48:63]
    v_add_f32 v73, v73, v44
    ds_read_b64_tr_b16 a[82:83], v18 offset:53248
    v_fma_f32 v47, v47, s50, -v72
    ds_read_b64_tr_b16 a[88:89], v19 offset:49152
    v_mfma_f32_32x32x16_bf16 v[48:63], a[48:51], a[176:179], v[48:63]
    v_exp_f32 v46, v46
    ds_read_b64_tr_b16 a[90:91], v19 offset:53248
    ds_read_b64_tr_b16 a[96:97], v16 offset:49408
    v_add_f32 v73, v73, v45
    v_mfma_f32_32x32x16_bf16 v[48:63], a[52:55], a[180:183], v[48:63]
    ds_read_b64_tr_b16 a[98:99], v16 offset:53504
    v_cvt_pk_bf16_f32 v70, v44, v45
    ds_read_b64_tr_b16 a[104:105], v17 offset:49408
    v_exp_f32 v47, v47
    v_mfma_f32_32x32x16_bf16 v[48:63], a[56:59], a[184:187], v[48:63]
    ds_read_b64_tr_b16 a[106:107], v17 offset:53504
    ds_read_b64_tr_b16 a[112:113], v18 offset:49408
    v_add_f32 v73, v73, v46
    ds_read_b64_tr_b16 a[114:115], v18 offset:53504
    v_mfma_f32_32x32x16_bf16 v[48:63], a[60:63], a[188:191], v[48:63]
    v_add_f32 v73, v73, v47
    ds_read_b64_tr_b16 a[120:121], v19 offset:49408
    v_cvt_pk_bf16_f32 v71, v46, v47
    ds_read_b64_tr_b16 a[122:123], v19 offset:53504
    s_waitcnt lgkmcnt(15)
    v_mfma_f32_32x32x16_bf16 v[128:143], a[68:71], v[68:71], v[128:143]
    ds_read_b128 a[32:35], v8 offset:256
    ds_read_b128 a[36:39], v9 offset:256
    ds_read_b128 a[40:43], v10 offset:256
    ds_read_b128 a[44:47], v11 offset:256
    v_mfma_f32_32x32x16_bf16 v[144:159], a[76:79], v[68:71], v[144:159]
    s_nop 0
    v_max3_f32 v74, v48, v49, v50
    v_max3_f32 v74, v74, v51, v52
    v_max3_f32 v74, v74, v53, v54
    v_max3_f32 v74, v74, v55, v56
    v_mfma_f32_32x32x16_bf16 v[160:175], a[84:87], v[68:71], v[160:175]
    v_max3_f32 v74, v74, v57, v58
    v_max3_f32 v74, v74, v59, v60
    v_max3_f32 v74, v74, v61, v62
    v_max_f32 v74, v74, v63
    v_mfma_f32_32x32x16_bf16 v[176:191], a[92:95], v[68:71], v[176:191]
    v_mov_b32 v75, v74
    s_nop 1
    v_permlane32_swap_b32 v74, v75
    v_max_f32 v74, v74, v75
    v_mul_f32 v74, s50, v74
    v_sub_f32 v75, v74, v72
    v_mfma_f32_32x32x16_bf16 v[192:207], a[100:103], v[68:71], v[192:207]
    v_cmp_lt_f32 vcc, 0x41000000, v75
    ds_read_b128 a[48:51], v12 offset:256
    ds_read_b128 a[52:55], v13 offset:256
    ds_read_b128 a[56:59], v14 offset:256
    v_mfma_f32_32x32x16_bf16 v[208:223], a[108:111], v[68:71], v[208:223]
    ds_read_b128 a[60:63], v15 offset:256
    s_add_u32 s62, s62, 1
    s_cmp_eq_u32 s62, 6
    s_cselect_b32 s63, s64, 16384
    v_mfma_f32_32x32x16_bf16 v[224:239], a[116:119], v[68:71], v[224:239]
    s_cselect_b32 s62, 0, s62
    v_add_u32 v8, s63, v8
    v_add_u32 v9, s63, v9
    v_add_u32 v10, s63, v10
    v_mfma_f32_32x32x16_bf16 v[240:255], a[124:127], v[68:71], v[240:255]
    v_add_u32 v11, s63, v11
    v_add_u32 v12, s63, v12
    v_add_u32 v13, s63, v13
    v_add_u32 v14, s63, v14
    v_add_u32 v15, s63, v15
    s_cbranch_vccnz attn_rs_11
attn_rsb_12:
    s_waitcnt lgkmcnt(0)
    s_waitcnt vmcnt(0)
    s_barrier
    v_mfma_f32_32x32x16_bf16 v[32:47], a[0:3], a[128:131], 0
    v_fma_f32 v48, v48, s50, -v72
    ds_read_b64_tr_b16 a[68:69], v16 offset:57344
    v_fma_f32 v49, v49, s50, -v72
    v_exp_f32 v48, v48
    v_mfma_f32_32x32x16_bf16 v[32:47], a[4:7], a[132:135], v[32:47]
    v_fma_f32 v50, v50, s50, -v72
    v_exp_f32 v49, v49
    v_add_f32 v73, v73, v48
    v_fma_f32 v51, v51, s50, -v72
    v_mfma_f32_32x32x16_bf16 v[32:47], a[8:11], a[136:139], v[32:47]
    v_exp_f32 v50, v50
    ds_read_b64_tr_b16 a[70:71], v16 offset:61440
    v_add_f32 v73, v73, v49
    v_cvt_pk_bf16_f32 v64, v48, v49
    v_mfma_f32_32x32x16_bf16 v[32:47], a[12:15], a[140:143], v[32:47]
    v_fma_f32 v52, v52, s50, -v72
    v_exp_f32 v51, v51
    v_add_f32 v73, v73, v50
    v_fma_f32 v53, v53, s50, -v72
    v_mfma_f32_32x32x16_bf16 v[32:47], a[16:19], a[144:147], v[32:47]
    v_exp_f32 v52, v52
    ds_read_b64_tr_b16 a[76:77], v17 offset:57344
    v_add_f32 v73, v73, v51
    v_cvt_pk_bf16_f32 v65, v50, v51
    v_mfma_f32_32x32x16_bf16 v[32:47], a[20:23], a[148:151], v[32:47]
    v_fma_f32 v54, v54, s50, -v72
    v_exp_f32 v53, v53
    v_add_f32 v73, v73, v52
    v_fma_f32 v55, v55, s50, -v72
    v_mfma_f32_32x32x16_bf16 v[32:47], a[24:27], a[152:155], v[32:47]
    v_exp_f32 v54, v54
    ds_read_b64_tr_b16 a[78:79], v17 offset:61440
    v_add_f32 v73, v73, v53
    v_cvt_pk_bf16_f32 v66, v52, v53
    v_mfma_f32_32x32x16_bf16 v[32:47], a[28:31], a[156:159], v[32:47]
    v_exp_f32 v55, v55
    v_add_f32 v73, v73, v54
    v_add_f32 v73, v73, v55
    v_cvt_pk_bf16_f32 v67, v54, v55
    s_nop 1
    v_mfma_f32_32x32x16_bf16 v[128:143], a[64:67], v[64:67], v[128:143]
    v_fma_f32 v56, v56, s50, -v72
    ds_read_b64_tr_b16 a[84:85], v18 offset:57344
    ds_read_b64_tr_b16 a[86:87], v18 offset:61440
    v_fma_f32 v57, v57, s50, -v72
    v_mfma_f32_32x32x16_bf16 v[144:159], a[72:75], v[64:67], v[144:159]
    ds_read_b64_tr_b16 a[92:93], v19 offset:57344
    v_exp_f32 v56, v56
    ds_read_b64_tr_b16 a[94:95], v19 offset:61440
    v_fma_f32 v58, v58, s50, -v72
    v_mfma_f32_32x32x16_bf16 v[160:175], a[80:83], v[64:67], v[160:175]
    ds_read_b64_tr_b16 a[100:101], v16 offset:57600
    ds_read_b64_tr_b16 a[102:103], v16 offset:61696
    v_exp_f32 v57, v57
    ds_read_b64_tr_b16 a[108:109], v17 offset:57600
    v_mfma_f32_32x32x16_bf16 v[176:191], a[88:91], v[64:67], v[176:191]
    v_add_f32 v73, v73, v56
    ds_read_b64_tr_b16 a[110:111], v17 offset:61696
    v_fma_f32 v59, v59, s50, -v72
    ds_read_b64_tr_b16 a[116:117], v18 offset:57600
    v_mfma_f32_32x32x16_bf16 v[192:207], a[96:99], v[64:67], v[192:207]
    v_exp_f32 v58, v58
    ds_read_b64_tr_b16 a[118:119], v18 offset:61696
    ds_read_b64_tr_b16 a[124:125], v19 offset:57600
    v_add_f32 v73, v73, v57
    v_mfma_f32_32x32x16_bf16 v[208:223], a[104:107], v[64:67], v[208:223]
    ds_read_b64_tr_b16 a[126:127], v19 offset:61696
    v_cvt_pk_bf16_f32 v68, v56, v57
    ds_read_b128 a[0:3], v8 offset:0
    v_exp_f32 v59, v59
    v_mfma_f32_32x32x16_bf16 v[224:239], a[112:115], v[64:67], v[224:239]
    ds_read_b128 a[4:7], v9 offset:0
    ds_read_b128 a[8:11], v10 offset:0
    v_add_f32 v73, v73, v58
    ds_read_b128 a[12:15], v11 offset:0
    v_mfma_f32_32x32x16_bf16 v[240:255], a[120:123], v[64:67], v[240:255]
    v_add_f32 v73, v73, v59
    ds_read_b128 a[16:19], v12 offset:0
    v_cvt_pk_bf16_f32 v69, v58, v59
    ds_read_b128 a[20:23], v13 offset:0
    v_mfma_f32_32x32x16_bf16 v[32:47], a[32:35], a[160:163], v[32:47]
    v_fma_f32 v60, v60, s50, -v72
    ds_read_b128 a[24:27], v14 offset:0
    ds_read_b128 a[28:31], v15 offset:0
    v_fma_f32 v61, v61, s50, -v72
    v_mfma_f32_32x32x16_bf16 v[32:47], a[36:39], a[164:167], v[32:47]
    ds_read_b64_tr_b16 a[64:65], v16 offset:0
    v_exp_f32 v60, v60
    ds_read_b64_tr_b16 a[66:67], v16 offset:4096
    v_fma_f32 v62, v62, s50, -v72
    v_mfma_f32_32x32x16_bf16 v[32:47], a[40:43], a[168:171], v[32:47]
    ds_read_b64_tr_b16 a[72:73], v17 offset:0
    ds_read_b64_tr_b16 a[74:75], v17 offset:4096
    v_exp_f32 v61, v61
    ds_read_b64_tr_b16 a[80:81], v18 offset:0
    v_mfma_f32_32x32x16_bf16 v[32:47], a[44:47], a[172:175], v[32:47]
    v_add_f32 v73, v73, v60
    ds_read_b64_tr_b16 a[82:83], v18 offset:4096
    v_fma_f32 v63, v63, s50, -v72
    ds_read_b64_tr_b16 a[88:89], v19 offset:0
    v_mfma_f32_32x32x16_bf16 v[32:47], a[48:51], a[176:179], v[32:47]
    v_exp_f32 v62, v62
    ds_read_b64_tr_b16 a[90:91], v19 offset:4096
    ds_read_b64_tr_b16 a[96:97], v16 offset:256
    v_add_f32 v73, v73, v61
    v_mfma_f32_32x32x16_bf16 v[32:47], a[52:55], a[180:183], v[32:47]
    ds_read_b64_tr_b16 a[98:99], v16 offset:4352
    v_cvt_pk_bf16_f32 v70, v60, v61
    ds_read_b64_tr_b16 a[104:105], v17 offset:256
    v_exp_f32 v63, v63
    v_mfma_f32_32x32x16_bf16 v[32:47], a[56:59], a[184:187], v[32:47]
    ds_read_b64_tr_b16 a[106:107], v17 offset:4352
    ds_read_b64_tr_b16 a[112:113], v18 offset:256
    v_add_f32 v73, v73, v62
    ds_read_b64_tr_b16 a[114:115], v18 offset:4352
    v_mfma_f32_32x32x16_bf16 v[32:47], a[60:63], a[188:191], v[32:47]
    v_add_f32 v73, v73, v63
    ds_read_b64_tr_b16 a[120:121], v19 offset:256
    v_cvt_pk_bf16_f32 v71, v62, v63
    ds_read_b64_tr_b16 a[122:123], v19 offset:4352
    s_waitcnt lgkmcnt(15)
    v_mfma_f32_32x32x16_bf16 v[128:143], a[68:71], v[68:71], v[128:143]
    ds_read_b128 a[32:35], v8 offset:256
    ds_read_b128 a[36:39], v9 offset:256
    ds_read_b128 a[40:43], v10 offset:256
    ds_read_b128 a[44:47], v11 offset:256
    v_mfma_f32_32x32x16_bf16 v[144:159], a[76:79], v[68:71], v[144:159]
    s_nop 0
    v_max3_f32 v74, v32, v33, v34
    v_max3_f32 v74, v74, v35, v36
    v_max3_f32 v74, v74, v37, v38
    v_max3_f32 v74, v74, v39, v40
    v_mfma_f32_32x32x16_bf16 v[160:175], a[84:87], v[68:71], v[160:175]
    v_max3_f32 v74, v74, v41, v42
    v_max3_f32 v74, v74, v43, v44
    v_max3_f32 v74, v74, v45, v46
    v_max_f32 v74, v74, v47
    v_mfma_f32_32x32x16_bf16 v[176:191], a[92:95], v[68:71], v[176:191]
    v_mov_b32 v75, v74
    s_nop 1
    v_permlane32_swap_b32 v74, v75
    v_max_f32 v74, v74, v75
    v_mul_f32 v74, s50, v74
    v_sub_f32 v75, v74, v72
    v_mfma_f32_32x32x16_bf16 v[192:207], a[100:103], v[68:71], v[192:207]
    v_cmp_lt_f32 vcc, 0x41000000, v75
    ds_read_b128 a[48:51], v12 offset:256
    ds_read_b128 a[52:55], v13 offset:256
    ds_read_b128 a[56:59], v14 offset:256
    v_mfma_f32_32x32x16_bf16 v[208:223], a[108:111], v[68:71], v[208:223]
    ds_read_b128 a[60:63], v15 offset:256
    s_add_u32 s62, s62, 1
    s_cmp_eq_u32 s62, 6
    s_cselect_b32 s63, s64, 16384
    v_mfma_f32_32x32x16_bf16 v[224:239], a[116:119], v[68:71], v[224:239]
    s_cselect_b32 s62, 0, s62
    v_add_u32 v8, s63, v8
    v_add_u32 v9, s63, v9
    v_add_u32 v10, s63, v10
    v_mfma_f32_32x32x16_bf16 v[240:255], a[124:127], v[68:71], v[240:255]
    v_add_u32 v11, s63, v11
    v_add_u32 v12, s63, v12
    v_add_u32 v13, s63, v13
    v_add_u32 v14, s63, v14
    v_add_u32 v15, s63, v15
    s_cbranch_vccnz attn_rs_13
attn_rsb_14:
    s_waitcnt lgkmcnt(0)
    s_waitcnt vmcnt(0)
    s_barrier
    v_mfma_f32_32x32x16_bf16 v[48:63], a[0:3], a[128:131], 0
    v_fma_f32 v32, v32, s50, -v72
    ds_read_b64_tr_b16 a[68:69], v16 offset:8192
    v_fma_f32 v33, v33, s50, -v72
    v_exp_f32 v32, v32
    v_mfma_f32_32x32x16_bf16 v[48:63], a[4:7], a[132:135], v[48:63]
    v_fma_f32 v34, v34, s50, -v72
    v_exp_f32 v33, v33
    v_add_f32 v73, v73, v32
    v_fma_f32 v35, v35, s50, -v72
    v_mfma_f32_32x32x16_bf16 v[48:63], a[8:11], a[136:139], v[48:63]
    v_exp_f32 v34, v34
    ds_read_b64_tr_b16 a[70:71], v16 offset:12288
    v_add_f32 v73, v73, v33
    v_cvt_pk_bf16_f32 v64, v32, v33
    v_mfma_f32_32x32x16_bf16 v[48:63], a[12:15], a[140:143], v[48:63]
    v_fma_f32 v36, v36, s50, -v72
    v_exp_f32 v35, v35
    v_add_f32 v73, v73, v34
    v_fma_f32 v37, v37, s50, -v72
    v_mfma_f32_32x32x16_bf16 v[48:63], a[16:19], a[144:147], v[48:63]
    v_exp_f32 v36, v36
    ds_read_b64_tr_b16 a[76:77], v17 offset:8192
    v_add_f32 v73, v73, v35
    v_cvt_pk_bf16_f32 v65, v34, v35
    v_mfma_f32_32x32x16_bf16 v[48:63], a[20:23], a[148:151], v[48:63]
    v_fma_f32 v38, v38, s50, -v72
    v_exp_f32 v37, v37
    v_add_f32 v73, v73, v36
    v_fma_f32 v39, v39, s50, -v72
    v_mfma_f32_32x32x16_bf16 v[48:63], a[24:27], a[152:155], v[48:63]
    v_exp_f32 v38, v38
    ds_read_b64_tr_b16 a[78:79], v17 offset:12288
    v_add_f32 v73, v73, v37
    v_cvt_pk_bf16_f32 v66, v36, v37
    v_mfma_f32_32x32x16_bf16 v[48:63], a[28:31], a[156:159], v[48:63]
    v_exp_f32 v39, v39
    v_add_f32 v73, v73, v38
    v_add_f32 v73, v73, v39
    v_cvt_pk_bf16_f32 v67, v38, v39
    s_nop 1
    v_mfma_f32_32x32x16_bf16 v[128:143], a[64:67], v[64:67], v[128:143]
    v_fma_f32 v40, v40, s50, -v72
    ds_read_b64_tr_b16 a[84:85], v18 offset:8192
    v_fma_f32 v41, v41, s50, -v72
    v_mfma_f32_32x32x16_bf16 v[144:159], a[72:75], v[64:67], v[144:159]
    ds_read_b64_tr_b16 a[86:87], v18 offset:12288
    v_exp_f32 v40, v40
    ds_read_b64_tr_b16 a[92:93], v19 offset:8192
    v_mfma_f32_32x32x16_bf16 v[160:175], a[80:83], v[64:67], v[160:175]
    v_fma_f32 v42, v42, s50, -v72
    ds_read_b64_tr_b16 a[94:95], v19 offset:12288
    v_exp_f32 v41, v41
    v_mfma_f32_32x32x16_bf16 v[176:191], a[88:91], v[64:67], v[176:191]
    ds_read_b64_tr_b16 a[100:101], v16 offset:8448
    v_add_f32 v73, v73, v40
    ds_read_b64_tr_b16 a[102:103], v16 offset:12544
    v_fma_f32 v43, v43, s50, -v72
    v_mfma_f32_32x32x16_bf16 v[192:207], a[96:99], v[64:67], v[192:207]
    v_exp_f32 v42, v42
    ds_read_b64_tr_b16 a[108:109], v17 offset:8448
    v_add_f32 v73, v73, v41
    v_mfma_f32_32x32x16_bf16 v[208:223], a[104:107], v[64:67], v[208:223]
    ds_read_b64_tr_b16 a[110:111], v17 offset:12544
    v_cvt_pk_bf16_f32 v68, v40, v41
    ds_read_b64_tr_b16 a[116:117], v18 offset:8448
    v_mfma_f32_32x32x16_bf16 v[224:239], a[112:115], v[64:67], v[224:239]
    v_exp_f32 v43, v43
    ds_read_b64_tr_b16 a[118:119], v18 offset:12544
    v_add_f32 v73, v73, v42
    v_mfma_f32_32x32x16_bf16 v[240:255], a[120:123], v[64:67], v[240:255]
    ds_read_b64_tr_b16 a[124:125], v19 offset:8448
    v_add_f32 v73, v73, v43
    ds_read_b64_tr_b16 a[126:127], v19 offset:12544
    v_cvt_pk_bf16_f32 v69, v42, v43
    v_mfma_f32_32x32x16_bf16 v[48:63], a[32:35], a[160:163], v[48:63]
    v_fma_f32 v44, v44, s50, -v72
    ds_read_b64_tr_b16 a[64:65], v16 offset:16384
    ds_read_b64_tr_b16 a[66:67], v16 offset:20480
    v_mfma_f32_32x32x16_bf16 v[48:63], a[36:39], a[164:167], v[48:63]
    v_fma_f32 v45, v45, s50, -v72
    ds_read_b64_tr_b16 a[72:73], v17 offset:16384
    v_exp_f32 v44, v44
    ds_read_b64_tr_b16 a[74:75], v17 offset:20480
    v_mfma_f32_32x32x16_bf16 v[48:63], a[40:43], a[168:171], v[48:63]
    v_fma_f32 v46, v46, s50, -v72
    ds_read_b64_tr_b16 a[80:81], v18 offset:16384
    v_exp_f32 v45, v45
    ds_read_b64_tr_b16 a[82:83], v18 offset:20480
    v_mfma_f32_32x32x16_bf16 v[48:63], a[44:47], a[172:175], v[48:63]
    v_add_f32 v73, v73, v44
    ds_read_b64_tr_b16 a[88:89], v19 offset:16384
    v_fma_f32 v47, v47, s50, -v72
    ds_read_b64_tr_b16 a[90:91], v19 offset:20480
    v_mfma_f32_32x32x16_bf16 v[48:63], a[48:51], a[176:179], v[48:63]
    v_exp_f32 v46, v46
    ds_read_b64_tr_b16 a[96:97], v16 offset:16640
    ds_read_b64_tr_b16 a[98:99], v16 offset:20736
    v_mfma_f32_32x32x16_bf16 v[48:63], a[52:55], a[180:183], v[48:63]
    v_add_f32 v73, v73, v45
    ds_read_b64_tr_b16 a[104:105], v17 offset:16640
    v_cvt_pk_bf16_f32 v70, v44, v45
    ds_read_b64_tr_b16 a[106:107], v17 offset:20736
    v_mfma_f32_32x32x16_bf16 v[48:63], a[56:59], a[184:187], v[48:63]
    v_exp_f32 v47, v47
    ds_read_b64_tr_b16 a[112:113], v18 offset:16640
    v_add_f32 v73, v73, v46
    ds_read_b64_tr_b16 a[114:115], v18 offset:20736
    v_mfma_f32_32x32x16_bf16 v[48:63], a[60:63], a[188:191], v[48:63]
    v_add_f32 v73, v73, v47
    ds_read_b64_tr_b16 a[120:121], v19 offset:16640
    v_cvt_pk_bf16_f32 v71, v46, v47
    ds_read_b64_tr_b16 a[122:123], v19 offset:20736
    s_waitcnt lgkmcnt(15)
    v_mfma_f32_32x32x16_bf16 v[128:143], a[68:71], v[68:71], v[128:143]
    s_nop 5
    v_max3_f32 v74, v48, v49, v50
    v_mfma_f32_32x32x16_bf16 v[144:159], a[76:79], v[68:71], v[144:159]
    v_max3_f32 v74, v74, v51, v52
    v_max3_f32 v74, v74, v53, v54
    v_mfma_f32_32x32x16_bf16 v[160:175], a[84:87], v[68:71], v[160:175]
    v_max3_f32 v74, v74, v55, v56
    v_max3_f32 v74, v74, v57, v58
    v_mfma_f32_32x32x16_bf16 v[176:191], a[92:95], v[68:71], v[176:191]
    v_max3_f32 v74, v74, v59, v60
    v_max3_f32 v74, v74, v61, v62
    v_mfma_f32_32x32x16_bf16 v[192:207], a[100:103], v[68:71], v[192:207]
    v_max_f32 v74, v74, v63
    v_mfma_f32_32x32x16_bf16 v[208:223], a[108:111], v[68:71], v[208:223]
    v_mov_b32 v75, v74
    s_nop 1
    v_permlane32_swap_b32 v74, v75
    v_mfma_f32_32x32x16_bf16 v[224:239], a[116:119], v[68:71], v[224:239]
    v_max_f32 v74, v74, v75
    v_mul_f32 v74, s50, v74
    v_mfma_f32_32x32x16_bf16 v[240:255], a[124:127], v[68:71], v[240:255]
    v_sub_f32 v75, v74, v72
    v_cmp_lt_f32 vcc, 0x41000000, v75
    s_nop 3
    s_cbranch_vccnz attn_rs_15
attn_rsb_16:
    s_waitcnt lgkmcnt(0)
    s_waitcnt vmcnt(0)
    s_barrier
    v_fma_f32 v48, v48, s50, -v72
    ds_read_b64_tr_b16 a[68:69], v16 offset:24576
    v_fma_f32 v49, v49, s50, -v72
    v_exp_f32 v48, v48
    v_fma_f32 v50, v50, s50, -v72
    v_exp_f32 v49, v49
    v_add_f32 v73, v73, v48
    v_fma_f32 v51, v51, s50, -v72
    v_exp_f32 v50, v50
    ds_read_b64_tr_b16 a[70:71], v16 offset:28672
    v_add_f32 v73, v73, v49
    v_cvt_pk_bf16_f32 v64, v48, v49
    v_fma_f32 v52, v52, s50, -v72
    v_exp_f32 v51, v51
    v_add_f32 v73, v73, v50
    v_fma_f32 v53, v53, s50, -v72
    v_exp_f32 v52, v52
    ds_read_b64_tr_b16 a[76:77], v17 offset:24576
    v_add_f32 v73, v73, v51
    v_cvt_pk_bf16_f32 v65, v50, v51
    v_fma_f32 v54, v54, s50, -v72
    v_exp_f32 v53, v53
    v_add_f32 v73, v73, v52
    v_fma_f32 v55, v55, s50, -v72
    v_exp_f32 v54, v54
    ds_read_b64_tr_b16 a[78:79], v17 offset:28672
    v_add_f32 v73, v73, v53
    v_cvt_pk_bf16_f32 v66, v52, v53
    v_exp_f32 v55, v55
    v_add_f32 v73, v73, v54
    v_add_f32 v73, v73, v55
    v_cvt_pk_bf16_f32 v67, v54, v55
    s_nop 1
    v_mfma_f32_32x32x16_bf16 v[128:143], a[64:67], v[64:67], v[128:143]
    v_fma_f32 v56, v56, s50, -v72
    ds_read_b64_tr_b16 a[84:85], v18 offset:24576
    v_fma_f32 v57, v57, s50, -v72
    v_mfma_f32_32x32x16_bf16 v[144:159], a[72:75], v[64:67], v[144:159]
    ds_read_b64_tr_b16 a[86:87], v18 offset:28672
    v_exp_f32 v56, v56
    ds_read_b64_tr_b16 a[92:93], v19 offset:24576
    v_mfma_f32_32x32x16_bf16 v[160:175], a[80:83], v[64:67], v[160:175]
    v_fma_f32 v58, v58, s50, -v72
    ds_read_b64_tr_b16 a[94:95], v19 offset:28672
    v_exp_f32 v57, v57
    v_mfma_f32_32x32x16_bf16 v[176:191], a[88:91], v[64:67], v[176:191]
    ds_read_b64_tr_b16 a[100:101], v16 offset:24832
    v_add_f32 v73, v73, v56
    ds_read_b64_tr_b16 a[102:103], v16 offset:28928
    v_fma_f32 v59, v59, s50, -v72
    v_mfma_f32_32x32x16_bf16 v[192:207], a[96:99], v[64:67], v[192:207]
    v_exp_f32 v58, v58
    ds_read_b64_tr_b16 a[108:109], v17 offset:24832
    v_add_f32 v73, v73, v57
    v_mfma_f32_32x32x16_bf16 v[208:223], a[104:107], v[64:67], v[208:223]
    ds_read_b64_tr_b16 a[110:111], v17 offset:28928
    v_cvt_pk_bf16_f32 v68, v56, v57
    ds_read_b64_tr_b16 a[116:117], v18 offset:24832
    v_mfma_f32_32x32x16_bf16 v[224:239], a[112:115], v[64:67], v[224:239]
    v_exp_f32 v59, v59
    ds_read_b64_tr_b16 a[118:119], v18 offset:28928
    v_add_f32 v73, v73, v58
    v_mfma_f32_32x32x16_bf16 v[240:255], a[120:123], v[64:67], v[240:255]
    ds_read_b64_tr_b16 a[124:125], v19 offset:24832
    v_add_f32 v73, v73, v59
    ds_read_b64_tr_b16 a[126:127], v19 offset:28928
    v_cvt_pk_bf16_f32 v69, v58, v59
    v_fma_f32 v60, v60, s50, -v72
    v_fma_f32 v61, v61, s50, -v72
    v_exp_f32 v60, v60
    v_fma_f32 v62, v62, s50, -v72
    v_exp_f32 v61, v61
    v_add_f32 v73, v73, v60
    v_fma_f32 v63, v63, s50, -v72
    v_exp_f32 v62, v62
    v_add_f32 v73, v73, v61
    v_cvt_pk_bf16_f32 v70, v60, v61
    v_exp_f32 v63, v63
    v_add_f32 v73, v73, v62
    v_add_f32 v73, v73, v63
    v_cvt_pk_bf16_f32 v71, v62, v63
    s_waitcnt lgkmcnt(14)
    s_nop 0
    v_mfma_f32_32x32x16_bf16 v[128:143], a[68:71], v[68:71], v[128:143]
    s_waitcnt lgkmcnt(12)
    v_mfma_f32_32x32x16_bf16 v[144:159], a[76:79], v[68:71], v[144:159]
    s_waitcnt lgkmcnt(10)
    v_mfma_f32_32x32x16_bf16 v[160:175], a[84:87], v[68:71], v[160:175]
    s_waitcnt lgkmcnt(8)
    v_mfma_f32_32x32x16_bf16 v[176:191], a[92:95], v[68:71], v[176:191]
    s_waitcnt lgkmcnt(6)
    v_mfma_f32_32x32x16_bf16 v[192:207], a[100:103], v[68:71], v[192:207]
    s_waitcnt lgkmcnt(4)
    v_mfma_f32_32x32x16_bf16 v[208:223], a[108:111], v[68:71], v[208:223]
    s_waitcnt lgkmcnt(2)
    v_mfma_f32_32x32x16_bf16 v[224:239], a[116:119], v[68:71], v[224:239]
    s_waitcnt lgkmcnt(0)
    v_mfma_f32_32x32x16_bf16 v[240:255], a[124:127], v[68:71], v[240:255]
    s_waitcnt lgkmcnt(0)
    s_nop 15
    v_mov_b32 v75, v73
    s_nop 1
    v_permlane32_swap_b32 v73, v75
    v_add_f32 v73, v73, v75
    v_rcp_f32 v73, v73
    s_nop 0
    v_mul_f32 v128, v128, v73
    v_mul_f32 v129, v129, v73
    v_mul_f32 v130, v130, v73
    v_mul_f32 v131, v131, v73
    v_mul_f32 v132, v132, v73
    v_mul_f32 v133, v133, v73
    v_mul_f32 v134, v134, v73
    v_mul_f32 v135, v135, v73
    v_mul_f32 v136, v136, v73
    v_mul_f32 v137, v137, v73
    v_mul_f32 v138, v138, v73
    v_mul_f32 v139, v139, v73
    v_mul_f32 v140, v140, v73
    v_mul_f32 v141, v141, v73
    v_mul_f32 v142, v142, v73
    v_mul_f32 v143, v143, v73
    v_cvt_pk_bf16_f32 v76, v128, v129
    v_cvt_pk_bf16_f32 v77, v130, v131
    v_cvt_pk_bf16_f32 v78, v132, v133
    v_cvt_pk_bf16_f32 v79, v134, v135
    v_accvgpr_write_b32 a128, v76
    v_accvgpr_write_b32 a129, v77
    v_accvgpr_write_b32 a130, v78
    v_accvgpr_write_b32 a131, v79
    v_cvt_pk_bf16_f32 v76, v136, v137
    v_cvt_pk_bf16_f32 v77, v138, v139
    v_cvt_pk_bf16_f32 v78, v140, v141
    v_cvt_pk_bf16_f32 v79, v142, v143
    v_accvgpr_write_b32 a132, v76
    v_accvgpr_write_b32 a133, v77
    v_accvgpr_write_b32 a134, v78
    v_accvgpr_write_b32 a135, v79
    v_mul_f32 v144, v144, v73
    v_mul_f32 v145, v145, v73
    v_mul_f32 v146, v146, v73
    v_mul_f32 v147, v147, v73
    v_mul_f32 v148, v148, v73
    v_mul_f32 v149, v149, v73
    v_mul_f32 v150, v150, v73
    v_mul_f32 v151, v151, v73
    v_mul_f32 v152, v152, v73
    v_mul_f32 v153, v153, v73
    v_mul_f32 v154, v154, v73
    v_mul_f32 v155, v155, v73
    v_mul_f32 v156, v156, v73
    v_mul_f32 v157, v157, v73
    v_mul_f32 v158, v158, v73
    v_mul_f32 v159, v159, v73
    v_cvt_pk_bf16_f32 v76, v144, v145
    v_cvt_pk_bf16_f32 v77, v146, v147
    v_cvt_pk_bf16_f32 v78, v148, v149
    v_cvt_pk_bf16_f32 v79, v150, v151
    v_accvgpr_write_b32 a136, v76
    v_accvgpr_write_b32 a137, v77
    v_accvgpr_write_b32 a138, v78
    v_accvgpr_write_b32 a139, v79
    v_cvt_pk_bf16_f32 v76, v152, v153
    v_cvt_pk_bf16_f32 v77, v154, v155
    v_cvt_pk_bf16_f32 v78, v156, v157
    v_cvt_pk_bf16_f32 v79, v158, v159
    v_accvgpr_write_b32 a140, v76
    v_accvgpr_write_b32 a141, v77
    v_accvgpr_write_b32 a142, v78
    v_accvgpr_write_b32 a143, v79
    v_mul_f32 v160, v160, v73
    v_mul_f32 v161, v161, v73
    v_mul_f32 v162, v162, v73
    v_mul_f32 v163, v163, v73
    v_mul_f32 v164, v164, v73
    v_mul_f32 v165, v165, v73
    v_mul_f32 v166, v166, v73
    v_mul_f32 v167, v167, v73
    v_mul_f32 v168, v168, v73
    v_mul_f32 v169, v169, v73
    v_mul_f32 v170, v170, v73
    v_mul_f32 v171, v171, v73
    v_mul_f32 v172, v172, v73
    v_mul_f32 v173, v173, v73
    v_mul_f32 v174, v174, v73
    v_mul_f32 v175, v175, v73
    v_cvt_pk_bf16_f32 v76, v160, v161
    v_cvt_pk_bf16_f32 v77, v162, v163
    v_cvt_pk_bf16_f32 v78, v164, v165
    v_cvt_pk_bf16_f32 v79, v166, v167
    v_accvgpr_write_b32 a144, v76
    v_accvgpr_write_b32 a145, v77
    v_accvgpr_write_b32 a146, v78
    v_accvgpr_write_b32 a147, v79
    v_cvt_pk_bf16_f32 v76, v168, v169
    v_cvt_pk_bf16_f32 v77, v170, v171
    v_cvt_pk_bf16_f32 v78, v172, v173
    v_cvt_pk_bf16_f32 v79, v174, v175
    v_accvgpr_write_b32 a148, v76
    v_accvgpr_write_b32 a149, v77
    v_accvgpr_write_b32 a150, v78
    v_accvgpr_write_b32 a151, v79
    v_mul_f32 v176, v176, v73
    v_mul_f32 v177, v177, v73
    v_mul_f32 v178, v178, v73
    v_mul_f32 v179, v179, v73
    v_mul_f32 v180, v180, v73
    v_mul_f32 v181, v181, v73
    v_mul_f32 v182, v182, v73
    v_mul_f32 v183, v183, v73
    v_mul_f32 v184, v184, v73
    v_mul_f32 v185, v185, v73
    v_mul_f32 v186, v186, v73
    v_mul_f32 v187, v187, v73
    v_mul_f32 v188, v188, v73
    v_mul_f32 v189, v189, v73
    v_mul_f32 v190, v190, v73
    v_mul_f32 v191, v191, v73
    v_cvt_pk_bf16_f32 v76, v176, v177
    v_cvt_pk_bf16_f32 v77, v178, v179
    v_cvt_pk_bf16_f32 v78, v180, v181
    v_cvt_pk_bf16_f32 v79, v182, v183
    v_accvgpr_write_b32 a152, v76
    v_accvgpr_write_b32 a153, v77
    v_accvgpr_write_b32 a154, v78
    v_accvgpr_write_b32 a155, v79
    v_cvt_pk_bf16_f32 v76, v184, v185
    v_cvt_pk_bf16_f32 v77, v186, v187
    v_cvt_pk_bf16_f32 v78, v188, v189
    v_cvt_pk_bf16_f32 v79, v190, v191
    v_accvgpr_write_b32 a156, v76
    v_accvgpr_write_b32 a157, v77
    v_accvgpr_write_b32 a158, v78
    v_accvgpr_write_b32 a159, v79
    v_mul_f32 v192, v192, v73
    v_mul_f32 v193, v193, v73
    v_mul_f32 v194, v194, v73
    v_mul_f32 v195, v195, v73
    v_mul_f32 v196, v196, v73
    v_mul_f32 v197, v197, v73
    v_mul_f32 v198, v198, v73
    v_mul_f32 v199, v199, v73
    v_mul_f32 v200, v200, v73
    v_mul_f32 v201, v201, v73
    v_mul_f32 v202, v202, v73
    v_mul_f32 v203, v203, v73
    v_mul_f32 v204, v204, v73
    v_mul_f32 v205, v205, v73
    v_mul_f32 v206, v206, v73
    v_mul_f32 v207, v207, v73
    v_cvt_pk_bf16_f32 v76, v192, v193
    v_cvt_pk_bf16_f32 v77, v194, v195
    v_cvt_pk_bf16_f32 v78, v196, v197
    v_cvt_pk_bf16_f32 v79, v198, v199
    v_accvgpr_write_b32 a160, v76
    v_accvgpr_write_b32 a161, v77
    v_accvgpr_write_b32 a162, v78
    v_accvgpr_write_b32 a163, v79
    v_cvt_pk_bf16_f32 v76, v200, v201
    v_cvt_pk_bf16_f32 v77, v202, v203
    v_cvt_pk_bf16_f32 v78, v204, v205
    v_cvt_pk_bf16_f32 v79, v206, v207
    v_accvgpr_write_b32 a164, v76
    v_accvgpr_write_b32 a165, v77
    v_accvgpr_write_b32 a166, v78
    v_accvgpr_write_b32 a167, v79
    v_mul_f32 v208, v208, v73
    v_mul_f32 v209, v209, v73
    v_mul_f32 v210, v210, v73
    v_mul_f32 v211, v211, v73
    v_mul_f32 v212, v212, v73
    v_mul_f32 v213, v213, v73
    v_mul_f32 v214, v214, v73
    v_mul_f32 v215, v215, v73
    v_mul_f32 v216, v216, v73
    v_mul_f32 v217, v217, v73
    v_mul_f32 v218, v218, v73
    v_mul_f32 v219, v219, v73
    v_mul_f32 v220, v220, v73
    v_mul_f32 v221, v221, v73
    v_mul_f32 v222, v222, v73
    v_mul_f32 v223, v223, v73
    v_cvt_pk_bf16_f32 v76, v208, v209
    v_cvt_pk_bf16_f32 v77, v210, v211
    v_cvt_pk_bf16_f32 v78, v212, v213
    v_cvt_pk_bf16_f32 v79, v214, v215
    v_accvgpr_write_b32 a168, v76
    v_accvgpr_write_b32 a169, v77
    v_accvgpr_write_b32 a170, v78
    v_accvgpr_write_b32 a171, v79
    v_cvt_pk_bf16_f32 v76, v216, v217
    v_cvt_pk_bf16_f32 v77, v218, v219
    v_cvt_pk_bf16_f32 v78, v220, v221
    v_cvt_pk_bf16_f32 v79, v222, v223
    v_accvgpr_write_b32 a172, v76
    v_accvgpr_write_b32 a173, v77
    v_accvgpr_write_b32 a174, v78
    v_accvgpr_write_b32 a175, v79
    v_mul_f32 v224, v224, v73
    v_mul_f32 v225, v225, v73
    v_mul_f32 v226, v226, v73
    v_mul_f32 v227, v227, v73
    v_mul_f32 v228, v228, v73
    v_mul_f32 v229, v229, v73
    v_mul_f32 v230, v230, v73
    v_mul_f32 v231, v231, v73
    v_mul_f32 v232, v232, v73
    v_mul_f32 v233, v233, v73
    v_mul_f32 v234, v234, v73
    v_mul_f32 v235, v235, v73
    v_mul_f32 v236, v236, v73
    v_mul_f32 v237, v237, v73
    v_mul_f32 v238, v238, v73
    v_mul_f32 v239, v239, v73
    v_cvt_pk_bf16_f32 v76, v224, v225
    v_cvt_pk_bf16_f32 v77, v226, v227
    v_cvt_pk_bf16_f32 v78, v228, v229
    v_cvt_pk_bf16_f32 v79, v230, v231
    v_accvgpr_write_b32 a176, v76
    v_accvgpr_write_b32 a177, v77
    v_accvgpr_write_b32 a178, v78
    v_accvgpr_write_b32 a179, v79
    v_cvt_pk_bf16_f32 v76, v232, v233
    v_cvt_pk_bf16_f32 v77, v234, v235
    v_cvt_pk_bf16_f32 v78, v236, v237
    v_cvt_pk_bf16_f32 v79, v238, v239
    v_accvgpr_write_b32 a180, v76
    v_accvgpr_write_b32 a181, v77
    v_accvgpr_write_b32 a182, v78
    v_accvgpr_write_b32 a183, v79
    v_mul_f32 v240, v240, v73
    v_mul_f32 v241, v241, v73
    v_mul_f32 v242, v242, v73
    v_mul_f32 v243, v243, v73
    v_mul_f32 v244, v244, v73
    v_mul_f32 v245, v245, v73
    v_mul_f32 v246, v246, v73
    v_mul_f32 v247, v247, v73
    v_mul_f32 v248, v248, v73
    v_mul_f32 v249, v249, v73
    v_mul_f32 v250, v250, v73
    v_mul_f32 v251, v251, v73
    v_mul_f32 v252, v252, v73
    v_mul_f32 v253, v253, v73
    v_mul_f32 v254, v254, v73
    v_mul_f32 v255, v255, v73
    v_cvt_pk_bf16_f32 v76, v240, v241
    v_cvt_pk_bf16_f32 v77, v242, v243
    v_cvt_pk_bf16_f32 v78, v244, v245
    v_cvt_pk_bf16_f32 v79, v246, v247
    v_accvgpr_write_b32 a184, v76
    v_accvgpr_write_b32 a185, v77
    v_accvgpr_write_b32 a186, v78
    v_accvgpr_write_b32 a187, v79
    v_cvt_pk_bf16_f32 v76, v248, v249
    v_cvt_pk_bf16_f32 v77, v250, v251
    v_cvt_pk_bf16_f32 v78, v252, v253
    v_cvt_pk_bf16_f32 v79, v254, v255
    v_accvgpr_write_b32 a188, v76
    v_accvgpr_write_b32 a189, v77
    v_accvgpr_write_b32 a190, v78
    v_accvgpr_write_b32 a191, v79
    v_lshl_add_u32 v24, v2, 3, v27
    s_mov_b32 s46, 896
    v_mul_lo_u32 v24, v24, s46
    v_lshl_add_u32 v24, v29, 3, v24
    v_lshrrev_b32 v25, 1, v27
    v_lshlrev_b32 v25, 6, v25
    v_add_u32 v8, v24, v25
    v_sub_u32 v9, v24, v25
    s_mul_i32 s45, s43, 48
    s_mul_i32 s46, s42, 6
    s_add_u32 s45, s45, s46
    s_mul_i32 s46, s41, 3
    s_add_u32 s45, s45, s46
    s_add_u32 s45, s45, s44
    s_mul_i32 s45, s45, 28672
    v_lshlrev_b32 v12, 4, v1
    v_add_u32 v12, s45, v12
    v_add_u32 v10, 57344, v8
    v_add_u32 v11, 57344, v9
    s_barrier
    ds_read_b64_tr_b16 a[0:1], v10 offset:0
    ds_read_b64_tr_b16 a[2:3], v10 offset:3584
    ds_read_b64_tr_b16 a[4:5], v10 offset:14336
    ds_read_b64_tr_b16 a[6:7], v10 offset:17920
    ds_read_b64_tr_b16 a[8:9], v11 offset:64
    ds_read_b64_tr_b16 a[10:11], v11 offset:3648
    ds_read_b64_tr_b16 a[12:13], v11 offset:14400
    ds_read_b64_tr_b16 a[14:15], v11 offset:17984
    ds_read_b64_tr_b16 a[16:17], v10 offset:128
    ds_read_b64_tr_b16 a[18:19], v10 offset:3712
    ds_read_b64_tr_b16 a[20:21], v10 offset:14464
    ds_read_b64_tr_b16 a[22:23], v10 offset:18048
    ds_read_b64_tr_b16 a[24:25], v11 offset:192
    ds_read_b64_tr_b16 a[26:27], v11 offset:3776
    ds_read_b64_tr_b16 a[28:29], v11 offset:14528
    ds_read_b64_tr_b16 a[30:31], v11 offset:18112
    ds_read_b64_tr_b16 a[32:33], v10 offset:256
    ds_read_b64_tr_b16 a[34:35], v10 offset:3840
    ds_read_b64_tr_b16 a[36:37], v10 offset:14592
    ds_read_b64_tr_b16 a[38:39], v10 offset:18176
    ds_read_b64_tr_b16 a[40:41], v11 offset:320
    ds_read_b64_tr_b16 a[42:43], v11 offset:3904
    ds_read_b64_tr_b16 a[44:45], v11 offset:14656
    ds_read_b64_tr_b16 a[46:47], v11 offset:18240
    ds_read_b64_tr_b16 a[48:49], v10 offset:384
    ds_read_b64_tr_b16 a[50:51], v10 offset:3968
    ds_read_b64_tr_b16 a[52:53], v10 offset:14720
    ds_read_b64_tr_b16 a[54:55], v10 offset:18304
    v_add_u32 v13, 0, v8
    v_add_u32 v14, 0, v9
    s_waitcnt lgkmcnt(15)
    v_mfma_f32_32x32x16_bf16 v[32:47], a[0:3], a[128:131], 0
    ds_read_b64_tr_b16 a[64:65], v11 offset:448
    ds_read_b64_tr_b16 a[66:67], v11 offset:4032
    v_mfma_f32_32x32x16_bf16 v[48:63], a[8:11], a[128:131], 0
    ds_read_b64_tr_b16 a[68:69], v11 offset:14784
    ds_read_b64_tr_b16 a[70:71], v11 offset:18368
    v_mfma_f32_32x32x16_bf16 v[64:79], a[16:19], a[128:131], 0
    ds_read_b64_tr_b16 a[72:73], v10 offset:512
    ds_read_b64_tr_b16 a[74:75], v10 offset:4096
    s_waitcnt lgkmcnt(15)
    v_mfma_f32_32x32x16_bf16 v[80:95], a[24:27], a[128:131], 0
    ds_read_b64_tr_b16 a[76:77], v10 offset:14848
    ds_read_b64_tr_b16 a[78:79], v10 offset:18432
    v_mfma_f32_32x32x16_bf16 v[96:111], a[32:35], a[128:131], 0
    ds_read_b64_tr_b16 a[80:81], v11 offset:576
    ds_read_b64_tr_b16 a[82:83], v11 offset:4160
    s_waitcnt lgkmcnt(15)
    v_mfma_f32_32x32x16_bf16 v[112:127], a[40:43], a[128:131], 0
    ds_read_b64_tr_b16 a[84:85], v11 offset:14912
    ds_read_b64_tr_b16 a[86:87], v11 offset:18496
    s_waitcnt lgkmcnt(14)
    v_mfma_f32_32x32x16_bf16 v[128:143], a[48:51], a[128:131], 0
    ds_read_b64_tr_b16 a[88:89], v10 offset:640
    ds_read_b64_tr_b16 a[90:91], v10 offset:4224
    v_mfma_f32_32x32x16_bf16 v[32:47], a[4:7], a[132:135], v[32:47]
    ds_read_b64_tr_b16 a[92:93], v10 offset:14976
    ds_read_b64_tr_b16 a[94:95], v10 offset:18560
    v_mfma_f32_32x32x16_bf16 v[48:63], a[12:15], a[132:135], v[48:63]
    ds_read_b64_tr_b16 a[96:97], v11 offset:704
    ds_read_b64_tr_b16 a[98:99], v11 offset:4288
    v_mfma_f32_32x32x16_bf16 v[64:79], a[20:23], a[132:135], v[64:79]
    ds_read_b64_tr_b16 a[100:101], v11 offset:15040
    ds_read_b64_tr_b16 a[102:103], v11 offset:18624
    v_mfma_f32_32x32x16_bf16 v[80:95], a[28:31], a[132:135], v[80:95]
    ds_read_b64_tr_b16 a[104:105], v10 offset:768
    ds_read_b64_tr_b16 a[106:107], v10 offset:4352
    v_mfma_f32_32x32x16_bf16 v[96:111], a[36:39], a[132:135], v[96:111]
    ds_read_b64_tr_b16 a[108:109], v10 offset:15104
    ds_read_b64_tr_b16 a[110:111], v10 offset:18688
    v_mfma_f32_32x32x16_bf16 v[112:127], a[44:47], a[132:135], v[112:127]
    ds_read_b64_tr_b16 a[112:113], v11 offset:832
    ds_read_b64_tr_b16 a[114:115], v11 offset:4416
    s_waitcnt lgkmcnt(15)
    v_mfma_f32_32x32x16_bf16 v[128:143], a[52:55], a[132:135], v[128:143]
    ds_read_b64_tr_b16 a[116:117], v11 offset:15168
    ds_read_b64_tr_b16 a[118:119], v11 offset:18752
    v_mfma_f32_32x32x16_bf16 v[144:159], a[64:67], a[128:131], 0
    ds_read_b64_tr_b16 a[0:1], v13 offset:0
    ds_read_b64_tr_b16 a[2:3], v13 offset:3584
    v_mfma_f32_32x32x16_bf16 v[160:175], a[72:75], a[128:131], 0
    ds_read_b64_tr_b16 a[4:5], v13 offset:14336
    ds_read_b64_tr_b16 a[6:7], v13 offset:17920
    v_mfma_f32_32x32x16_bf16 v[176:191], a[80:83], a[128:131], 0
    ds_read_b64_tr_b16 a[8:9], v14 offset:64
    ds_read_b64_tr_b16 a[10:11], v14 offset:3648
    s_waitcnt lgkmcnt(15)
    v_mfma_f32_32x32x16_bf16 v[192:207], a[88:91], a[128:131], 0
    ds_read_b64_tr_b16 a[12:13], v14 offset:14400
    ds_read_b64_tr_b16 a[14:15], v14 offset:17984
    v_mfma_f32_32x32x16_bf16 v[208:223], a[96:99], a[128:131], 0
    ds_read_b64_tr_b16 a[16:17], v13 offset:128
    ds_read_b64_tr_b16 a[18:19], v13 offset:3712
    s_waitcnt lgkmcnt(15)
    v_mfma_f32_32x32x16_bf16 v[224:239], a[104:107], a[128:131], 0
    ds_read_b64_tr_b16 a[20:21], v13 offset:14464
    ds_read_b64_tr_b16 a[22:23], v13 offset:18048
    s_waitcnt lgkmcnt(14)
    v_mfma_f32_32x32x16_bf16 v[240:255], a[112:115], a[128:131], 0
    ds_read_b64_tr_b16 a[24:25], v14 offset:192
    ds_read_b64_tr_b16 a[26:27], v14 offset:3776
    v_mfma_f32_32x32x16_bf16 v[144:159], a[68:71], a[132:135], v[144:159]
    ds_read_b64_tr_b16 a[28:29], v14 offset:14528
    ds_read_b64_tr_b16 a[30:31], v14 offset:18112
    v_mfma_f32_32x32x16_bf16 v[160:175], a[76:79], a[132:135], v[160:175]
    ds_read_b64_tr_b16 a[32:33], v13 offset:256
    ds_read_b64_tr_b16 a[34:35], v13 offset:3840
    v_mfma_f32_32x32x16_bf16 v[176:191], a[84:87], a[132:135], v[176:191]
    ds_read_b64_tr_b16 a[36:37], v13 offset:14592
    ds_read_b64_tr_b16 a[38:39], v13 offset:18176
    v_mfma_f32_32x32x16_bf16 v[192:207], a[92:95], a[132:135], v[192:207]
    ds_read_b64_tr_b16 a[40:41], v14 offset:320
    ds_read_b64_tr_b16 a[42:43], v14 offset:3904
    v_mfma_f32_32x32x16_bf16 v[208:223], a[100:103], a[132:135], v[208:223]
    ds_read_b64_tr_b16 a[44:45], v14 offset:14656
    ds_read_b64_tr_b16 a[46:47], v14 offset:18240
    v_mfma_f32_32x32x16_bf16 v[224:239], a[108:111], a[132:135], v[224:239]
    ds_read_b64_tr_b16 a[48:49], v13 offset:384
    ds_read_b64_tr_b16 a[50:51], v13 offset:3968
    s_waitcnt lgkmcnt(15)
    v_mfma_f32_32x32x16_bf16 v[240:255], a[116:119], a[132:135], v[240:255]
    ds_read_b64_tr_b16 a[52:53], v13 offset:14720
    ds_read_b64_tr_b16 a[54:55], v13 offset:18304
    s_waitcnt lgkmcnt(0)
    s_barrier
    v_add_u32 v10, 28672, v8
    v_add_u32 v11, 28672, v9
    v_mfma_f32_32x32x16_bf16 v[32:47], a[0:3], a[136:139], v[32:47]
    ds_read_b64_tr_b16 a[64:65], v14 offset:448
    ds_read_b64_tr_b16 a[66:67], v14 offset:4032
    v_mfma_f32_32x32x16_bf16 v[48:63], a[8:11], a[136:139], v[48:63]
    ds_read_b64_tr_b16 a[68:69], v14 offset:14784
    ds_read_b64_tr_b16 a[70:71], v14 offset:18368
    v_mfma_f32_32x32x16_bf16 v[64:79], a[16:19], a[136:139], v[64:79]
    ds_read_b64_tr_b16 a[72:73], v13 offset:512
    ds_read_b64_tr_b16 a[74:75], v13 offset:4096
    v_mfma_f32_32x32x16_bf16 v[80:95], a[24:27], a[136:139], v[80:95]
    ds_read_b64_tr_b16 a[76:77], v13 offset:14848
    ds_read_b64_tr_b16 a[78:79], v13 offset:18432
    v_mfma_f32_32x32x16_bf16 v[96:111], a[32:35], a[136:139], v[96:111]
    ds_read_b64_tr_b16 a[80:81], v14 offset:576
    ds_read_b64_tr_b16 a[82:83], v14 offset:4160
    v_mfma_f32_32x32x16_bf16 v[112:127], a[40:43], a[136:139], v[112:127]
    ds_read_b64_tr_b16 a[84:85], v14 offset:14912
    ds_read_b64_tr_b16 a[86:87], v14 offset:18496
    v_mfma_f32_32x32x16_bf16 v[128:143], a[48:51], a[136:139], v[128:143]
    ds_read_b64_tr_b16 a[88:89], v13 offset:640
    ds_read_b64_tr_b16 a[90:91], v13 offset:4224
    v_mfma_f32_32x32x16_bf16 v[32:47], a[4:7], a[140:143], v[32:47]
    ds_read_b64_tr_b16 a[92:93], v13 offset:14976
    ds_read_b64_tr_b16 a[94:95], v13 offset:18560
    v_mfma_f32_32x32x16_bf16 v[48:63], a[12:15], a[140:143], v[48:63]
    ds_read_b64_tr_b16 a[96:97], v14 offset:704
    ds_read_b64_tr_b16 a[98:99], v14 offset:4288
    v_mfma_f32_32x32x16_bf16 v[64:79], a[20:23], a[140:143], v[64:79]
    ds_read_b64_tr_b16 a[100:101], v14 offset:15040
    ds_read_b64_tr_b16 a[102:103], v14 offset:18624
    v_mfma_f32_32x32x16_bf16 v[80:95], a[28:31], a[140:143], v[80:95]
    ds_read_b64_tr_b16 a[104:105], v13 offset:768
    ds_read_b64_tr_b16 a[106:107], v13 offset:4352
    v_mfma_f32_32x32x16_bf16 v[96:111], a[36:39], a[140:143], v[96:111]
    ds_read_b64_tr_b16 a[108:109], v13 offset:15104
    ds_read_b64_tr_b16 a[110:111], v13 offset:18688
    v_mfma_f32_32x32x16_bf16 v[112:127], a[44:47], a[140:143], v[112:127]
    ds_read_b64_tr_b16 a[112:113], v14 offset:832
    ds_read_b64_tr_b16 a[114:115], v14 offset:4416
    v_mfma_f32_32x32x16_bf16 v[128:143], a[52:55], a[140:143], v[128:143]
    ds_read_b64_tr_b16 a[116:117], v14 offset:15168
    ds_read_b64_tr_b16 a[118:119], v14 offset:18752
    s_waitcnt lgkmcnt(15)
    v_mfma_f32_32x32x16_bf16 v[144:159], a[64:67], a[136:139], v[144:159]
    ds_read_b64_tr_b16 a[0:1], v10 offset:0
    ds_read_b64_tr_b16 a[2:3], v10 offset:3584
    v_mfma_f32_32x32x16_bf16 v[160:175], a[72:75], a[136:139], v[160:175]
    ds_read_b64_tr_b16 a[4:5], v10 offset:14336
    ds_read_b64_tr_b16 a[6:7], v10 offset:17920
    v_mfma_f32_32x32x16_bf16 v[176:191], a[80:83], a[136:139], v[176:191]
    ds_read_b64_tr_b16 a[8:9], v11 offset:64
    ds_read_b64_tr_b16 a[10:11], v11 offset:3648
    s_waitcnt lgkmcnt(15)
    v_mfma_f32_32x32x16_bf16 v[192:207], a[88:91], a[136:139], v[192:207]
    ds_read_b64_tr_b16 a[12:13], v11 offset:14400
    ds_read_b64_tr_b16 a[14:15], v11 offset:17984
    v_mfma_f32_32x32x16_bf16 v[208:223], a[96:99], a[136:139], v[208:223]
    ds_read_b64_tr_b16 a[16:17], v10 offset:128
    ds_read_b64_tr_b16 a[18:19], v10 offset:3712
    s_waitcnt lgkmcnt(15)
    v_mfma_f32_32x32x16_bf16 v[224:239], a[104:107], a[136:139], v[224:239]
    ds_read_b64_tr_b16 a[20:21], v10 offset:14464
    ds_read_b64_tr_b16 a[22:23], v10 offset:18048
    s_waitcnt lgkmcnt(14)
    v_mfma_f32_32x32x16_bf16 v[240:255], a[112:115], a[136:139], v[240:255]
    ds_read_b64_tr_b16 a[24:25], v11 offset:192
    ds_read_b64_tr_b16 a[26:27], v11 offset:3776
    v_mfma_f32_32x32x16_bf16 v[144:159], a[68:71], a[140:143], v[144:159]
    ds_read_b64_tr_b16 a[28:29], v11 offset:14528
    ds_read_b64_tr_b16 a[30:31], v11 offset:18112
    v_mfma_f32_32x32x16_bf16 v[160:175], a[76:79], a[140:143], v[160:175]
    ds_read_b64_tr_b16 a[32:33], v10 offset:256
    ds_read_b64_tr_b16 a[34:35], v10 offset:3840
    v_mfma_f32_32x32x16_bf16 v[176:191], a[84:87], a[140:143], v[176:191]
    ds_read_b64_tr_b16 a[36:37], v10 offset:14592
    ds_read_b64_tr_b16 a[38:39], v10 offset:18176
    v_mfma_f32_32x32x16_bf16 v[192:207], a[92:95], a[140:143], v[192:207]
    ds_read_b64_tr_b16 a[40:41], v11 offset:320
    ds_read_b64_tr_b16 a[42:43], v11 offset:3904
    v_mfma_f32_32x32x16_bf16 v[208:223], a[100:103], a[140:143], v[208:223]
    ds_read_b64_tr_b16 a[44:45], v11 offset:14656
    ds_read_b64_tr_b16 a[46:47], v11 offset:18240
    v_mfma_f32_32x32x16_bf16 v[224:239], a[108:111], a[140:143], v[224:239]
    ds_read_b64_tr_b16 a[48:49], v10 offset:384
    ds_read_b64_tr_b16 a[50:51], v10 offset:3968
    s_waitcnt lgkmcnt(15)
    v_mfma_f32_32x32x16_bf16 v[240:255], a[116:119], a[140:143], v[240:255]
    ds_read_b64_tr_b16 a[52:53], v10 offset:14720
    ds_read_b64_tr_b16 a[54:55], v10 offset:18304
    s_waitcnt lgkmcnt(0)
    s_barrier
    v_add_u32 v13, 98304, v8
    v_add_u32 v14, 98304, v9
    v_mfma_f32_32x32x16_bf16 v[32:47], a[0:3], a[144:147], v[32:47]
    ds_read_b64_tr_b16 a[64:65], v11 offset:448
    ds_read_b64_tr_b16 a[66:67], v11 offset:4032
    v_mfma_f32_32x32x16_bf16 v[48:63], a[8:11], a[144:147], v[48:63]
    ds_read_b64_tr_b16 a[68:69], v11 offset:14784
    ds_read_b64_tr_b16 a[70:71], v11 offset:18368
    v_mfma_f32_32x32x16_bf16 v[64:79], a[16:19], a[144:147], v[64:79]
    ds_read_b64_tr_b16 a[72:73], v10 offset:512
    ds_read_b64_tr_b16 a[74:75], v10 offset:4096
    v_mfma_f32_32x32x16_bf16 v[80:95], a[24:27], a[144:147], v[80:95]
    ds_read_b64_tr_b16 a[76:77], v10 offset:14848
    ds_read_b64_tr_b16 a[78:79], v10 offset:18432
    v_mfma_f32_32x32x16_bf16 v[96:111], a[32:35], a[144:147], v[96:111]
    ds_read_b64_tr_b16 a[80:81], v11 offset:576
    ds_read_b64_tr_b16 a[82:83], v11 offset:4160
    v_mfma_f32_32x32x16_bf16 v[112:127], a[40:43], a[144:147], v[112:127]
    ds_read_b64_tr_b16 a[84:85], v11 offset:14912
    ds_read_b64_tr_b16 a[86:87], v11 offset:18496
    v_mfma_f32_32x32x16_bf16 v[128:143], a[48:51], a[144:147], v[128:143]
    ds_read_b64_tr_b16 a[88:89], v10 offset:640
    ds_read_b64_tr_b16 a[90:91], v10 offset:4224
    v_mfma_f32_32x32x16_bf16 v[32:47], a[4:7], a[148:151], v[32:47]
    ds_read_b64_tr_b16 a[92:93], v10 offset:14976
    ds_read_b64_tr_b16 a[94:95], v10 offset:18560
    v_mfma_f32_32x32x16_bf16 v[48:63], a[12:15], a[148:151], v[48:63]
    ds_read_b64_tr_b16 a[96:97], v11 offset:704
    ds_read_b64_tr_b16 a[98:99], v11 offset:4288
    v_mfma_f32_32x32x16_bf16 v[64:79], a[20:23], a[148:151], v[64:79]
    ds_read_b64_tr_b16 a[100:101], v11 offset:15040
    ds_read_b64_tr_b16 a[102:103], v11 offset:18624
    v_mfma_f32_32x32x16_bf16 v[80:95], a[28:31], a[148:151], v[80:95]
    ds_read_b64_tr_b16 a[104:105], v10 offset:768
    ds_read_b64_tr_b16 a[106:107], v10 offset:4352
    v_mfma_f32_32x32x16_bf16 v[96:111], a[36:39], a[148:151], v[96:111]
    ds_read_b64_tr_b16 a[108:109], v10 offset:15104
    ds_read_b64_tr_b16 a[110:111], v10 offset:18688
    v_mfma_f32_32x32x16_bf16 v[112:127], a[44:47], a[148:151], v[112:127]
    ds_read_b64_tr_b16 a[112:113], v11 offset:832
    ds_read_b64_tr_b16 a[114:115], v11 offset:4416
    v_mfma_f32_32x32x16_bf16 v[128:143], a[52:55], a[148:151], v[128:143]
    ds_read_b64_tr_b16 a[116:117], v11 offset:15168
    ds_read_b64_tr_b16 a[118:119], v11 offset:18752
    s_waitcnt lgkmcnt(15)
    v_mfma_f32_32x32x16_bf16 v[144:159], a[64:67], a[144:147], v[144:159]
    ds_read_b64_tr_b16 a[0:1], v13 offset:0
    ds_read_b64_tr_b16 a[2:3], v13 offset:3584
    v_mfma_f32_32x32x16_bf16 v[160:175], a[72:75], a[144:147], v[160:175]
    ds_read_b64_tr_b16 a[4:5], v13 offset:14336
    ds_read_b64_tr_b16 a[6:7], v13 offset:17920
    v_mfma_f32_32x32x16_bf16 v[176:191], a[80:83], a[144:147], v[176:191]
    ds_read_b64_tr_b16 a[8:9], v14 offset:64
    ds_read_b64_tr_b16 a[10:11], v14 offset:3648
    s_waitcnt lgkmcnt(15)
    v_mfma_f32_32x32x16_bf16 v[192:207], a[88:91], a[144:147], v[192:207]
    ds_read_b64_tr_b16 a[12:13], v14 offset:14400
    ds_read_b64_tr_b16 a[14:15], v14 offset:17984
    v_mfma_f32_32x32x16_bf16 v[208:223], a[96:99], a[144:147], v[208:223]
    ds_read_b64_tr_b16 a[16:17], v13 offset:128
    ds_read_b64_tr_b16 a[18:19], v13 offset:3712
    s_waitcnt lgkmcnt(15)
    v_mfma_f32_32x32x16_bf16 v[224:239], a[104:107], a[144:147], v[224:239]
    ds_read_b64_tr_b16 a[20:21], v13 offset:14464
    ds_read_b64_tr_b16 a[22:23], v13 offset:18048
    s_waitcnt lgkmcnt(14)
    v_mfma_f32_32x32x16_bf16 v[240:255], a[112:115], a[144:147], v[240:255]
    ds_read_b64_tr_b16 a[24:25], v14 offset:192
    ds_read_b64_tr_b16 a[26:27], v14 offset:3776
    v_mfma_f32_32x32x16_bf16 v[144:159], a[68:71], a[148:151], v[144:159]
    ds_read_b64_tr_b16 a[28:29], v14 offset:14528
    ds_read_b64_tr_b16 a[30:31], v14 offset:18112
    v_mfma_f32_32x32x16_bf16 v[160:175], a[76:79], a[148:151], v[160:175]
    ds_read_b64_tr_b16 a[32:33], v13 offset:256
    ds_read_b64_tr_b16 a[34:35], v13 offset:3840
    v_mfma_f32_32x32x16_bf16 v[176:191], a[84:87], a[148:151], v[176:191]
    ds_read_b64_tr_b16 a[36:37], v13 offset:14592
    ds_read_b64_tr_b16 a[38:39], v13 offset:18176
    v_mfma_f32_32x32x16_bf16 v[192:207], a[92:95], a[148:151], v[192:207]
    ds_read_b64_tr_b16 a[40:41], v14 offset:320
    ds_read_b64_tr_b16 a[42:43], v14 offset:3904
    v_mfma_f32_32x32x16_bf16 v[208:223], a[100:103], a[148:151], v[208:223]
    ds_read_b64_tr_b16 a[44:45], v14 offset:14656
    ds_read_b64_tr_b16 a[46:47], v14 offset:18240
    v_mfma_f32_32x32x16_bf16 v[224:239], a[108:111], a[148:151], v[224:239]
    ds_read_b64_tr_b16 a[48:49], v13 offset:384
    ds_read_b64_tr_b16 a[50:51], v13 offset:3968
    s_waitcnt lgkmcnt(15)
    v_mfma_f32_32x32x16_bf16 v[240:255], a[116:119], a[148:151], v[240:255]
    ds_read_b64_tr_b16 a[52:53], v13 offset:14720
    ds_read_b64_tr_b16 a[54:55], v13 offset:18304
    s_waitcnt lgkmcnt(0)
    s_barrier
    v_add_u32 v10, 126976, v8
    v_add_u32 v11, 126976, v9
    v_mfma_f32_32x32x16_bf16 v[32:47], a[0:3], a[152:155], v[32:47]
    ds_read_b64_tr_b16 a[64:65], v14 offset:448
    ds_read_b64_tr_b16 a[66:67], v14 offset:4032
    v_mfma_f32_32x32x16_bf16 v[48:63], a[8:11], a[152:155], v[48:63]
    ds_read_b64_tr_b16 a[68:69], v14 offset:14784
    ds_read_b64_tr_b16 a[70:71], v14 offset:18368
    v_mfma_f32_32x32x16_bf16 v[64:79], a[16:19], a[152:155], v[64:79]
    ds_read_b64_tr_b16 a[72:73], v13 offset:512
    ds_read_b64_tr_b16 a[74:75], v13 offset:4096
    v_mfma_f32_32x32x16_bf16 v[80:95], a[24:27], a[152:155], v[80:95]
    ds_read_b64_tr_b16 a[76:77], v13 offset:14848
    ds_read_b64_tr_b16 a[78:79], v13 offset:18432
    v_mfma_f32_32x32x16_bf16 v[96:111], a[32:35], a[152:155], v[96:111]
    ds_read_b64_tr_b16 a[80:81], v14 offset:576
    ds_read_b64_tr_b16 a[82:83], v14 offset:4160
    v_mfma_f32_32x32x16_bf16 v[112:127], a[40:43], a[152:155], v[112:127]
    ds_read_b64_tr_b16 a[84:85], v14 offset:14912
    ds_read_b64_tr_b16 a[86:87], v14 offset:18496
    v_mfma_f32_32x32x16_bf16 v[128:143], a[48:51], a[152:155], v[128:143]
    ds_read_b64_tr_b16 a[88:89], v13 offset:640
    ds_read_b64_tr_b16 a[90:91], v13 offset:4224
    v_mfma_f32_32x32x16_bf16 v[32:47], a[4:7], a[156:159], v[32:47]
    ds_read_b64_tr_b16 a[92:93], v13 offset:14976
    ds_read_b64_tr_b16 a[94:95], v13 offset:18560
    v_mfma_f32_32x32x16_bf16 v[48:63], a[12:15], a[156:159], v[48:63]
    ds_read_b64_tr_b16 a[96:97], v14 offset:704
    ds_read_b64_tr_b16 a[98:99], v14 offset:4288
    v_mfma_f32_32x32x16_bf16 v[64:79], a[20:23], a[156:159], v[64:79]
    ds_read_b64_tr_b16 a[100:101], v14 offset:15040
    ds_read_b64_tr_b16 a[102:103], v14 offset:18624
    v_mfma_f32_32x32x16_bf16 v[80:95], a[28:31], a[156:159], v[80:95]
    ds_read_b64_tr_b16 a[104:105], v13 offset:768
    ds_read_b64_tr_b16 a[106:107], v13 offset:4352
    v_mfma_f32_32x32x16_bf16 v[96:111], a[36:39], a[156:159], v[96:111]
    ds_read_b64_tr_b16 a[108:109], v13 offset:15104
    ds_read_b64_tr_b16 a[110:111], v13 offset:18688
    v_mfma_f32_32x32x16_bf16 v[112:127], a[44:47], a[156:159], v[112:127]
    ds_read_b64_tr_b16 a[112:113], v14 offset:832
    ds_read_b64_tr_b16 a[114:115], v14 offset:4416
    v_mfma_f32_32x32x16_bf16 v[128:143], a[52:55], a[156:159], v[128:143]
    ds_read_b64_tr_b16 a[116:117], v14 offset:15168
    ds_read_b64_tr_b16 a[118:119], v14 offset:18752
    s_waitcnt lgkmcnt(15)
    v_mfma_f32_32x32x16_bf16 v[144:159], a[64:67], a[152:155], v[144:159]
    ds_read_b64_tr_b16 a[0:1], v10 offset:0
    ds_read_b64_tr_b16 a[2:3], v10 offset:3584
    v_mfma_f32_32x32x16_bf16 v[160:175], a[72:75], a[152:155], v[160:175]
    ds_read_b64_tr_b16 a[4:5], v10 offset:14336
    ds_read_b64_tr_b16 a[6:7], v10 offset:17920
    v_mfma_f32_32x32x16_bf16 v[176:191], a[80:83], a[152:155], v[176:191]
    ds_read_b64_tr_b16 a[8:9], v11 offset:64
    ds_read_b64_tr_b16 a[10:11], v11 offset:3648
    s_waitcnt lgkmcnt(15)
    v_mfma_f32_32x32x16_bf16 v[192:207], a[88:91], a[152:155], v[192:207]
    ds_read_b64_tr_b16 a[12:13], v11 offset:14400
    ds_read_b64_tr_b16 a[14:15], v11 offset:17984
    v_mfma_f32_32x32x16_bf16 v[208:223], a[96:99], a[152:155], v[208:223]
    ds_read_b64_tr_b16 a[16:17], v10 offset:128
    ds_read_b64_tr_b16 a[18:19], v10 offset:3712
    s_waitcnt lgkmcnt(15)
    v_mfma_f32_32x32x16_bf16 v[224:239], a[104:107], a[152:155], v[224:239]
    ds_read_b64_tr_b16 a[20:21], v10 offset:14464
    ds_read_b64_tr_b16 a[22:23], v10 offset:18048
    s_waitcnt lgkmcnt(14)
    v_mfma_f32_32x32x16_bf16 v[240:255], a[112:115], a[152:155], v[240:255]
    ds_read_b64_tr_b16 a[24:25], v11 offset:192
    ds_read_b64_tr_b16 a[26:27], v11 offset:3776
    v_mfma_f32_32x32x16_bf16 v[144:159], a[68:71], a[156:159], v[144:159]
    ds_read_b64_tr_b16 a[28:29], v11 offset:14528
    ds_read_b64_tr_b16 a[30:31], v11 offset:18112
    v_mfma_f32_32x32x16_bf16 v[160:175], a[76:79], a[156:159], v[160:175]
    ds_read_b64_tr_b16 a[32:33], v10 offset:256
    ds_read_b64_tr_b16 a[34:35], v10 offset:3840
    v_mfma_f32_32x32x16_bf16 v[176:191], a[84:87], a[156:159], v[176:191]
    ds_read_b64_tr_b16 a[36:37], v10 offset:14592
    ds_read_b64_tr_b16 a[38:39], v10 offset:18176
    v_mfma_f32_32x32x16_bf16 v[192:207], a[92:95], a[156:159], v[192:207]
    ds_read_b64_tr_b16 a[40:41], v11 offset:320
    ds_read_b64_tr_b16 a[42:43], v11 offset:3904
    v_mfma_f32_32x32x16_bf16 v[208:223], a[100:103], a[156:159], v[208:223]
    ds_read_b64_tr_b16 a[44:45], v11 offset:14656
    ds_read_b64_tr_b16 a[46:47], v11 offset:18240
    v_mfma_f32_32x32x16_bf16 v[224:239], a[108:111], a[156:159], v[224:239]
    ds_read_b64_tr_b16 a[48:49], v10 offset:384
    ds_read_b64_tr_b16 a[50:51], v10 offset:3968
    s_waitcnt lgkmcnt(15)
    v_mfma_f32_32x32x16_bf16 v[240:255], a[116:119], a[156:159], v[240:255]
    ds_read_b64_tr_b16 a[52:53], v10 offset:14720
    ds_read_b64_tr_b16 a[54:55], v10 offset:18304
    s_waitcnt lgkmcnt(0)
    s_barrier
    v_add_u32 v13, 57344, v8
    v_add_u32 v14, 57344, v9
    v_mfma_f32_32x32x16_bf16 v[32:47], a[0:3], a[160:163], v[32:47]
    ds_read_b64_tr_b16 a[64:65], v11 offset:448
    ds_read_b64_tr_b16 a[66:67], v11 offset:4032
    v_mfma_f32_32x32x16_bf16 v[48:63], a[8:11], a[160:163], v[48:63]
    ds_read_b64_tr_b16 a[68:69], v11 offset:14784
    ds_read_b64_tr_b16 a[70:71], v11 offset:18368
    v_mfma_f32_32x32x16_bf16 v[64:79], a[16:19], a[160:163], v[64:79]
    ds_read_b64_tr_b16 a[72:73], v10 offset:512
    ds_read_b64_tr_b16 a[74:75], v10 offset:4096
    v_mfma_f32_32x32x16_bf16 v[80:95], a[24:27], a[160:163], v[80:95]
    ds_read_b64_tr_b16 a[76:77], v10 offset:14848
    ds_read_b64_tr_b16 a[78:79], v10 offset:18432
    v_mfma_f32_32x32x16_bf16 v[96:111], a[32:35], a[160:163], v[96:111]
    ds_read_b64_tr_b16 a[80:81], v11 offset:576
    ds_read_b64_tr_b16 a[82:83], v11 offset:4160
    v_mfma_f32_32x32x16_bf16 v[112:127], a[40:43], a[160:163], v[112:127]
    ds_read_b64_tr_b16 a[84:85], v11 offset:14912
    ds_read_b64_tr_b16 a[86:87], v11 offset:18496
    v_mfma_f32_32x32x16_bf16 v[128:143], a[48:51], a[160:163], v[128:143]
    ds_read_b64_tr_b16 a[88:89], v10 offset:640
    ds_read_b64_tr_b16 a[90:91], v10 offset:4224
    v_mfma_f32_32x32x16_bf16 v[32:47], a[4:7], a[164:167], v[32:47]
    ds_read_b64_tr_b16 a[92:93], v10 offset:14976
    ds_read_b64_tr_b16 a[94:95], v10 offset:18560
    v_mfma_f32_32x32x16_bf16 v[48:63], a[12:15], a[164:167], v[48:63]
    ds_read_b64_tr_b16 a[96:97], v11 offset:704
    ds_read_b64_tr_b16 a[98:99], v11 offset:4288
    v_mfma_f32_32x32x16_bf16 v[64:79], a[20:23], a[164:167], v[64:79]
    ds_read_b64_tr_b16 a[100:101], v11 offset:15040
    ds_read_b64_tr_b16 a[102:103], v11 offset:18624
    v_mfma_f32_32x32x16_bf16 v[80:95], a[28:31], a[164:167], v[80:95]
    ds_read_b64_tr_b16 a[104:105], v10 offset:768
    ds_read_b64_tr_b16 a[106:107], v10 offset:4352
    v_mfma_f32_32x32x16_bf16 v[96:111], a[36:39], a[164:167], v[96:111]
    ds_read_b64_tr_b16 a[108:109], v10 offset:15104
    ds_read_b64_tr_b16 a[110:111], v10 offset:18688
    v_mfma_f32_32x32x16_bf16 v[112:127], a[44:47], a[164:167], v[112:127]
    ds_read_b64_tr_b16 a[112:113], v11 offset:832
    ds_read_b64_tr_b16 a[114:115], v11 offset:4416
    v_mfma_f32_32x32x16_bf16 v[128:143], a[52:55], a[164:167], v[128:143]
    ds_read_b64_tr_b16 a[116:117], v11 offset:15168
    ds_read_b64_tr_b16 a[118:119], v11 offset:18752
    s_waitcnt lgkmcnt(15)
    v_mfma_f32_32x32x16_bf16 v[144:159], a[64:67], a[160:163], v[144:159]
    ds_read_b64_tr_b16 a[0:1], v13 offset:0
    ds_read_b64_tr_b16 a[2:3], v13 offset:3584
    v_mfma_f32_32x32x16_bf16 v[160:175], a[72:75], a[160:163], v[160:175]
    ds_read_b64_tr_b16 a[4:5], v13 offset:14336
    ds_read_b64_tr_b16 a[6:7], v13 offset:17920
    v_mfma_f32_32x32x16_bf16 v[176:191], a[80:83], a[160:163], v[176:191]
    ds_read_b64_tr_b16 a[8:9], v14 offset:64
    ds_read_b64_tr_b16 a[10:11], v14 offset:3648
    s_waitcnt lgkmcnt(15)
    v_mfma_f32_32x32x16_bf16 v[192:207], a[88:91], a[160:163], v[192:207]
    ds_read_b64_tr_b16 a[12:13], v14 offset:14400
    ds_read_b64_tr_b16 a[14:15], v14 offset:17984
    v_mfma_f32_32x32x16_bf16 v[208:223], a[96:99], a[160:163], v[208:223]
    ds_read_b64_tr_b16 a[16:17], v13 offset:128
    ds_read_b64_tr_b16 a[18:19], v13 offset:3712
    s_waitcnt lgkmcnt(15)
    v_mfma_f32_32x32x16_bf16 v[224:239], a[104:107], a[160:163], v[224:239]
    ds_read_b64_tr_b16 a[20:21], v13 offset:14464
    ds_read_b64_tr_b16 a[22:23], v13 offset:18048
    s_waitcnt lgkmcnt(14)
    v_mfma_f32_32x32x16_bf16 v[240:255], a[112:115], a[160:163], v[240:255]
    ds_read_b64_tr_b16 a[24:25], v14 offset:192
    ds_read_b64_tr_b16 a[26:27], v14 offset:3776
    v_mfma_f32_32x32x16_bf16 v[144:159], a[68:71], a[164:167], v[144:159]
    ds_read_b64_tr_b16 a[28:29], v14 offset:14528
    ds_read_b64_tr_b16 a[30:31], v14 offset:18112
    v_mfma_f32_32x32x16_bf16 v[160:175], a[76:79], a[164:167], v[160:175]
    ds_read_b64_tr_b16 a[32:33], v13 offset:256
    ds_read_b64_tr_b16 a[34:35], v13 offset:3840
    v_mfma_f32_32x32x16_bf16 v[176:191], a[84:87], a[164:167], v[176:191]
    ds_read_b64_tr_b16 a[36:37], v13 offset:14592
    ds_read_b64_tr_b16 a[38:39], v13 offset:18176
    v_mfma_f32_32x32x16_bf16 v[192:207], a[92:95], a[164:167], v[192:207]
    ds_read_b64_tr_b16 a[40:41], v14 offset:320
    ds_read_b64_tr_b16 a[42:43], v14 offset:3904
    v_mfma_f32_32x32x16_bf16 v[208:223], a[100:103], a[164:167], v[208:223]
    ds_read_b64_tr_b16 a[44:45], v14 offset:14656
    ds_read_b64_tr_b16 a[46:47], v14 offset:18240
    v_mfma_f32_32x32x16_bf16 v[224:239], a[108:111], a[164:167], v[224:239]
    ds_read_b64_tr_b16 a[48:49], v13 offset:384
    ds_read_b64_tr_b16 a[50:51], v13 offset:3968
    s_waitcnt lgkmcnt(15)
    v_mfma_f32_32x32x16_bf16 v[240:255], a[116:119], a[164:167], v[240:255]
    ds_read_b64_tr_b16 a[52:53], v13 offset:14720
    ds_read_b64_tr_b16 a[54:55], v13 offset:18304
    s_waitcnt lgkmcnt(0)
    s_barrier
    v_add_u32 v10, 0, v8
    v_add_u32 v11, 0, v9
    v_mfma_f32_32x32x16_bf16 v[32:47], a[0:3], a[168:171], v[32:47]
    ds_read_b64_tr_b16 a[64:65], v14 offset:448
    ds_read_b64_tr_b16 a[66:67], v14 offset:4032
    v_mfma_f32_32x32x16_bf16 v[48:63], a[8:11], a[168:171], v[48:63]
    ds_read_b64_tr_b16 a[68:69], v14 offset:14784
    ds_read_b64_tr_b16 a[70:71], v14 offset:18368
    v_mfma_f32_32x32x16_bf16 v[64:79], a[16:19], a[168:171], v[64:79]
    ds_read_b64_tr_b16 a[72:73], v13 offset:512
    ds_read_b64_tr_b16 a[74:75], v13 offset:4096
    v_mfma_f32_32x32x16_bf16 v[80:95], a[24:27], a[168:171], v[80:95]
    ds_read_b64_tr_b16 a[76:77], v13 offset:14848
    ds_read_b64_tr_b16 a[78:79], v13 offset:18432
    v_mfma_f32_32x32x16_bf16 v[96:111], a[32:35], a[168:171], v[96:111]
    ds_read_b64_tr_b16 a[80:81], v14 offset:576
    ds_read_b64_tr_b16 a[82:83], v14 offset:4160
    v_mfma_f32_32x32x16_bf16 v[112:127], a[40:43], a[168:171], v[112:127]
    ds_read_b64_tr_b16 a[84:85], v14 offset:14912
    ds_read_b64_tr_b16 a[86:87], v14 offset:18496
    v_mfma_f32_32x32x16_bf16 v[128:143], a[48:51], a[168:171], v[128:143]
    ds_read_b64_tr_b16 a[88:89], v13 offset:640
    ds_read_b64_tr_b16 a[90:91], v13 offset:4224
    v_mfma_f32_32x32x16_bf16 v[32:47], a[4:7], a[172:175], v[32:47]
    ds_read_b64_tr_b16 a[92:93], v13 offset:14976
    ds_read_b64_tr_b16 a[94:95], v13 offset:18560
    v_mfma_f32_32x32x16_bf16 v[48:63], a[12:15], a[172:175], v[48:63]
    ds_read_b64_tr_b16 a[96:97], v14 offset:704
    ds_read_b64_tr_b16 a[98:99], v14 offset:4288
    v_mfma_f32_32x32x16_bf16 v[64:79], a[20:23], a[172:175], v[64:79]
    ds_read_b64_tr_b16 a[100:101], v14 offset:15040
    ds_read_b64_tr_b16 a[102:103], v14 offset:18624
    v_mfma_f32_32x32x16_bf16 v[80:95], a[28:31], a[172:175], v[80:95]
    ds_read_b64_tr_b16 a[104:105], v13 offset:768
    ds_read_b64_tr_b16 a[106:107], v13 offset:4352
    v_mfma_f32_32x32x16_bf16 v[96:111], a[36:39], a[172:175], v[96:111]
    ds_read_b64_tr_b16 a[108:109], v13 offset:15104
    ds_read_b64_tr_b16 a[110:111], v13 offset:18688
    v_mfma_f32_32x32x16_bf16 v[112:127], a[44:47], a[172:175], v[112:127]
    ds_read_b64_tr_b16 a[112:113], v14 offset:832
    ds_read_b64_tr_b16 a[114:115], v14 offset:4416
    v_mfma_f32_32x32x16_bf16 v[128:143], a[52:55], a[172:175], v[128:143]
    ds_read_b64_tr_b16 a[116:117], v14 offset:15168
    ds_read_b64_tr_b16 a[118:119], v14 offset:18752
    s_waitcnt lgkmcnt(15)
    v_mfma_f32_32x32x16_bf16 v[144:159], a[64:67], a[168:171], v[144:159]
    ds_read_b64_tr_b16 a[0:1], v10 offset:0
    ds_read_b64_tr_b16 a[2:3], v10 offset:3584
    v_mfma_f32_32x32x16_bf16 v[160:175], a[72:75], a[168:171], v[160:175]
    ds_read_b64_tr_b16 a[4:5], v10 offset:14336
    ds_read_b64_tr_b16 a[6:7], v10 offset:17920
    v_mfma_f32_32x32x16_bf16 v[176:191], a[80:83], a[168:171], v[176:191]
    ds_read_b64_tr_b16 a[8:9], v11 offset:64
    ds_read_b64_tr_b16 a[10:11], v11 offset:3648
    s_waitcnt lgkmcnt(15)
    v_mfma_f32_32x32x16_bf16 v[192:207], a[88:91], a[168:171], v[192:207]
    ds_read_b64_tr_b16 a[12:13], v11 offset:14400
    ds_read_b64_tr_b16 a[14:15], v11 offset:17984
    v_mfma_f32_32x32x16_bf16 v[208:223], a[96:99], a[168:171], v[208:223]
    ds_read_b64_tr_b16 a[16:17], v10 offset:128
    ds_read_b64_tr_b16 a[18:19], v10 offset:3712
    s_waitcnt lgkmcnt(15)
    v_mfma_f32_32x32x16_bf16 v[224:239], a[104:107], a[168:171], v[224:239]
    ds_read_b64_tr_b16 a[20:21], v10 offset:14464
    ds_read_b64_tr_b16 a[22:23], v10 offset:18048
    s_waitcnt lgkmcnt(14)
    v_mfma_f32_32x32x16_bf16 v[240:255], a[112:115], a[168:171], v[240:255]
    ds_read_b64_tr_b16 a[24:25], v11 offset:192
    ds_read_b64_tr_b16 a[26:27], v11 offset:3776
    v_mfma_f32_32x32x16_bf16 v[144:159], a[68:71], a[172:175], v[144:159]
    ds_read_b64_tr_b16 a[28:29], v11 offset:14528
    ds_read_b64_tr_b16 a[30:31], v11 offset:18112
    v_mfma_f32_32x32x16_bf16 v[160:175], a[76:79], a[172:175], v[160:175]
    ds_read_b64_tr_b16 a[32:33], v10 offset:256
    ds_read_b64_tr_b16 a[34:35], v10 offset:3840
    v_mfma_f32_32x32x16_bf16 v[176:191], a[84:87], a[172:175], v[176:191]
    ds_read_b64_tr_b16 a[36:37], v10 offset:14592
    ds_read_b64_tr_b16 a[38:39], v10 offset:18176
    v_mfma_f32_32x32x16_bf16 v[192:207], a[92:95], a[172:175], v[192:207]
    ds_read_b64_tr_b16 a[40:41], v11 offset:320
    ds_read_b64_tr_b16 a[42:43], v11 offset:3904
    v_mfma_f32_32x32x16_bf16 v[208:223], a[100:103], a[172:175], v[208:223]
    ds_read_b64_tr_b16 a[44:45], v11 offset:14656
    ds_read_b64_tr_b16 a[46:47], v11 offset:18240
    v_mfma_f32_32x32x16_bf16 v[224:239], a[108:111], a[172:175], v[224:239]
    ds_read_b64_tr_b16 a[48:49], v10 offset:384
    ds_read_b64_tr_b16 a[50:51], v10 offset:3968
    s_waitcnt lgkmcnt(15)
    v_mfma_f32_32x32x16_bf16 v[240:255], a[116:119], a[172:175], v[240:255]
    ds_read_b64_tr_b16 a[52:53], v10 offset:14720
    ds_read_b64_tr_b16 a[54:55], v10 offset:18304
    s_waitcnt lgkmcnt(0)
    s_barrier
    v_add_u32 v13, 28672, v8
    v_add_u32 v14, 28672, v9
    v_mfma_f32_32x32x16_bf16 v[32:47], a[0:3], a[176:179], v[32:47]
    ds_read_b64_tr_b16 a[64:65], v11 offset:448
    ds_read_b64_tr_b16 a[66:67], v11 offset:4032
    v_mfma_f32_32x32x16_bf16 v[48:63], a[8:11], a[176:179], v[48:63]
    ds_read_b64_tr_b16 a[68:69], v11 offset:14784
    ds_read_b64_tr_b16 a[70:71], v11 offset:18368
    v_mfma_f32_32x32x16_bf16 v[64:79], a[16:19], a[176:179], v[64:79]
    ds_read_b64_tr_b16 a[72:73], v10 offset:512
    ds_read_b64_tr_b16 a[74:75], v10 offset:4096
    v_mfma_f32_32x32x16_bf16 v[80:95], a[24:27], a[176:179], v[80:95]
    ds_read_b64_tr_b16 a[76:77], v10 offset:14848
    ds_read_b64_tr_b16 a[78:79], v10 offset:18432
    v_mfma_f32_32x32x16_bf16 v[96:111], a[32:35], a[176:179], v[96:111]
    ds_read_b64_tr_b16 a[80:81], v11 offset:576
    ds_read_b64_tr_b16 a[82:83], v11 offset:4160
    v_mfma_f32_32x32x16_bf16 v[112:127], a[40:43], a[176:179], v[112:127]
    ds_read_b64_tr_b16 a[84:85], v11 offset:14912
    ds_read_b64_tr_b16 a[86:87], v11 offset:18496
    v_mfma_f32_32x32x16_bf16 v[128:143], a[48:51], a[176:179], v[128:143]
    ds_read_b64_tr_b16 a[88:89], v10 offset:640
    ds_read_b64_tr_b16 a[90:91], v10 offset:4224
    v_mfma_f32_32x32x16_bf16 v[32:47], a[4:7], a[180:183], v[32:47]
    ds_read_b64_tr_b16 a[92:93], v10 offset:14976
    ds_read_b64_tr_b16 a[94:95], v10 offset:18560
    v_mfma_f32_32x32x16_bf16 v[48:63], a[12:15], a[180:183], v[48:63]
    ds_read_b64_tr_b16 a[96:97], v11 offset:704
    ds_read_b64_tr_b16 a[98:99], v11 offset:4288
    v_mfma_f32_32x32x16_bf16 v[64:79], a[20:23], a[180:183], v[64:79]
    ds_read_b64_tr_b16 a[100:101], v11 offset:15040
    ds_read_b64_tr_b16 a[102:103], v11 offset:18624
    v_mfma_f32_32x32x16_bf16 v[80:95], a[28:31], a[180:183], v[80:95]
    ds_read_b64_tr_b16 a[104:105], v10 offset:768
    ds_read_b64_tr_b16 a[106:107], v10 offset:4352
    v_mfma_f32_32x32x16_bf16 v[96:111], a[36:39], a[180:183], v[96:111]
    ds_read_b64_tr_b16 a[108:109], v10 offset:15104
    ds_read_b64_tr_b16 a[110:111], v10 offset:18688
    v_mfma_f32_32x32x16_bf16 v[112:127], a[44:47], a[180:183], v[112:127]
    ds_read_b64_tr_b16 a[112:113], v11 offset:832
    ds_read_b64_tr_b16 a[114:115], v11 offset:4416
    v_mfma_f32_32x32x16_bf16 v[128:143], a[52:55], a[180:183], v[128:143]
    ds_read_b64_tr_b16 a[116:117], v11 offset:15168
    ds_read_b64_tr_b16 a[118:119], v11 offset:18752
    s_waitcnt lgkmcnt(15)
    v_mfma_f32_32x32x16_bf16 v[144:159], a[64:67], a[176:179], v[144:159]
    ds_read_b64_tr_b16 a[0:1], v13 offset:0
    ds_read_b64_tr_b16 a[2:3], v13 offset:3584
    v_mfma_f32_32x32x16_bf16 v[160:175], a[72:75], a[176:179], v[160:175]
    ds_read_b64_tr_b16 a[4:5], v13 offset:14336
    ds_read_b64_tr_b16 a[6:7], v13 offset:17920
    v_mfma_f32_32x32x16_bf16 v[176:191], a[80:83], a[176:179], v[176:191]
    ds_read_b64_tr_b16 a[8:9], v14 offset:64
    ds_read_b64_tr_b16 a[10:11], v14 offset:3648
    s_waitcnt lgkmcnt(15)
    v_mfma_f32_32x32x16_bf16 v[192:207], a[88:91], a[176:179], v[192:207]
    ds_read_b64_tr_b16 a[12:13], v14 offset:14400
    ds_read_b64_tr_b16 a[14:15], v14 offset:17984
    v_mfma_f32_32x32x16_bf16 v[208:223], a[96:99], a[176:179], v[208:223]
    ds_read_b64_tr_b16 a[16:17], v13 offset:128
    ds_read_b64_tr_b16 a[18:19], v13 offset:3712
    s_waitcnt lgkmcnt(15)
    v_mfma_f32_32x32x16_bf16 v[224:239], a[104:107], a[176:179], v[224:239]
    ds_read_b64_tr_b16 a[20:21], v13 offset:14464
    ds_read_b64_tr_b16 a[22:23], v13 offset:18048
    s_waitcnt lgkmcnt(14)
    v_mfma_f32_32x32x16_bf16 v[240:255], a[112:115], a[176:179], v[240:255]
    ds_read_b64_tr_b16 a[24:25], v14 offset:192
    ds_read_b64_tr_b16 a[26:27], v14 offset:3776
    v_mfma_f32_32x32x16_bf16 v[144:159], a[68:71], a[180:183], v[144:159]
    ds_read_b64_tr_b16 a[28:29], v14 offset:14528
    ds_read_b64_tr_b16 a[30:31], v14 offset:18112
    v_mfma_f32_32x32x16_bf16 v[160:175], a[76:79], a[180:183], v[160:175]
    ds_read_b64_tr_b16 a[32:33], v13 offset:256
    ds_read_b64_tr_b16 a[34:35], v13 offset:3840
    v_mfma_f32_32x32x16_bf16 v[176:191], a[84:87], a[180:183], v[176:191]
    ds_read_b64_tr_b16 a[36:37], v13 offset:14592
    ds_read_b64_tr_b16 a[38:39], v13 offset:18176
    v_mfma_f32_32x32x16_bf16 v[192:207], a[92:95], a[180:183], v[192:207]
    ds_read_b64_tr_b16 a[40:41], v14 offset:320
    ds_read_b64_tr_b16 a[42:43], v14 offset:3904
    v_mfma_f32_32x32x16_bf16 v[208:223], a[100:103], a[180:183], v[208:223]
    ds_read_b64_tr_b16 a[44:45], v14 offset:14656
    ds_read_b64_tr_b16 a[46:47], v14 offset:18240
    v_mfma_f32_32x32x16_bf16 v[224:239], a[108:111], a[180:183], v[224:239]
    ds_read_b64_tr_b16 a[48:49], v13 offset:384
    ds_read_b64_tr_b16 a[50:51], v13 offset:3968
    s_waitcnt lgkmcnt(15)
    v_mfma_f32_32x32x16_bf16 v[240:255], a[116:119], a[180:183], v[240:255]
    ds_read_b64_tr_b16 a[52:53], v13 offset:14720
    ds_read_b64_tr_b16 a[54:55], v13 offset:18304
    s_waitcnt lgkmcnt(0)
    s_barrier
    v_mfma_f32_32x32x16_bf16 v[32:47], a[0:3], a[184:187], v[32:47]
    ds_read_b64_tr_b16 a[64:65], v14 offset:448
    ds_read_b64_tr_b16 a[66:67], v14 offset:4032
    v_mfma_f32_32x32x16_bf16 v[48:63], a[8:11], a[184:187], v[48:63]
    ds_read_b64_tr_b16 a[68:69], v14 offset:14784
    ds_read_b64_tr_b16 a[70:71], v14 offset:18368
    v_mfma_f32_32x32x16_bf16 v[64:79], a[16:19], a[184:187], v[64:79]
    ds_read_b64_tr_b16 a[72:73], v13 offset:512
    ds_read_b64_tr_b16 a[74:75], v13 offset:4096
    v_mfma_f32_32x32x16_bf16 v[80:95], a[24:27], a[184:187], v[80:95]
    ds_read_b64_tr_b16 a[76:77], v13 offset:14848
    ds_read_b64_tr_b16 a[78:79], v13 offset:18432
    v_mfma_f32_32x32x16_bf16 v[96:111], a[32:35], a[184:187], v[96:111]
    ds_read_b64_tr_b16 a[80:81], v14 offset:576
    ds_read_b64_tr_b16 a[82:83], v14 offset:4160
    v_mfma_f32_32x32x16_bf16 v[112:127], a[40:43], a[184:187], v[112:127]
    ds_read_b64_tr_b16 a[84:85], v14 offset:14912
    ds_read_b64_tr_b16 a[86:87], v14 offset:18496
    v_mfma_f32_32x32x16_bf16 v[128:143], a[48:51], a[184:187], v[128:143]
    ds_read_b64_tr_b16 a[88:89], v13 offset:640
    ds_read_b64_tr_b16 a[90:91], v13 offset:4224
    v_mfma_f32_32x32x16_bf16 v[32:47], a[4:7], a[188:191], v[32:47]
    ds_read_b64_tr_b16 a[92:93], v13 offset:14976
    ds_read_b64_tr_b16 a[94:95], v13 offset:18560
    v_mfma_f32_32x32x16_bf16 v[48:63], a[12:15], a[188:191], v[48:63]
    ds_read_b64_tr_b16 a[96:97], v14 offset:704
    ds_read_b64_tr_b16 a[98:99], v14 offset:4288
    v_mfma_f32_32x32x16_bf16 v[64:79], a[20:23], a[188:191], v[64:79]
    ds_read_b64_tr_b16 a[100:101], v14 offset:15040
    ds_read_b64_tr_b16 a[102:103], v14 offset:18624
    v_mfma_f32_32x32x16_bf16 v[80:95], a[28:31], a[188:191], v[80:95]
    ds_read_b64_tr_b16 a[104:105], v13 offset:768
    ds_read_b64_tr_b16 a[106:107], v13 offset:4352
    v_mfma_f32_32x32x16_bf16 v[96:111], a[36:39], a[188:191], v[96:111]
    ds_read_b64_tr_b16 a[108:109], v13 offset:15104
    ds_read_b64_tr_b16 a[110:111], v13 offset:18688
    v_mfma_f32_32x32x16_bf16 v[112:127], a[44:47], a[188:191], v[112:127]
    ds_read_b64_tr_b16 a[112:113], v14 offset:832
    ds_read_b64_tr_b16 a[114:115], v14 offset:4416
    v_mfma_f32_32x32x16_bf16 v[128:143], a[52:55], a[188:191], v[128:143]
    ds_read_b64_tr_b16 a[116:117], v14 offset:15168
    ds_read_b64_tr_b16 a[118:119], v14 offset:18752
    s_waitcnt lgkmcnt(15)
    v_mfma_f32_32x32x16_bf16 v[144:159], a[64:67], a[184:187], v[144:159]
    v_mfma_f32_32x32x16_bf16 v[160:175], a[72:75], a[184:187], v[160:175]
    v_mfma_f32_32x32x16_bf16 v[176:191], a[80:83], a[184:187], v[176:191]
    s_waitcnt lgkmcnt(14)
    v_mfma_f32_32x32x16_bf16 v[192:207], a[88:91], a[184:187], v[192:207]
    s_waitcnt lgkmcnt(10)
    v_mfma_f32_32x32x16_bf16 v[208:223], a[96:99], a[184:187], v[208:223]
    s_waitcnt lgkmcnt(6)
    v_mfma_f32_32x32x16_bf16 v[224:239], a[104:107], a[184:187], v[224:239]
    s_waitcnt lgkmcnt(2)
    v_mfma_f32_32x32x16_bf16 v[240:255], a[112:115], a[184:187], v[240:255]
    v_mfma_f32_32x32x16_bf16 v[144:159], a[68:71], a[188:191], v[144:159]
    v_mfma_f32_32x32x16_bf16 v[160:175], a[76:79], a[188:191], v[160:175]
    v_mfma_f32_32x32x16_bf16 v[176:191], a[84:87], a[188:191], v[176:191]
    v_mfma_f32_32x32x16_bf16 v[192:207], a[92:95], a[188:191], v[192:207]
    v_mfma_f32_32x32x16_bf16 v[208:223], a[100:103], a[188:191], v[208:223]
    v_mfma_f32_32x32x16_bf16 v[224:239], a[108:111], a[188:191], v[224:239]
    s_waitcnt lgkmcnt(0)
    v_mfma_f32_32x32x16_bf16 v[240:255], a[116:119], a[188:191], v[240:255]
    s_waitcnt lgkmcnt(0)
    s_nop 11
    s_mov_b32 s45, 0
    v_cvt_pk_bf16_f32 v16, v32, v33
    v_cvt_pk_bf16_f32 v17, v34, v35
    v_cvt_pk_bf16_f32 v18, v36, v37
    v_cvt_pk_bf16_f32 v19, v38, v39
    buffer_store_dwordx4 v[16:19], v12, s[36:39], s45 offen offset:0
    v_cvt_pk_bf16_f32 v20, v40, v41
    v_cvt_pk_bf16_f32 v21, v42, v43
    v_cvt_pk_bf16_f32 v22, v44, v45
    v_cvt_pk_bf16_f32 v23, v46, v47
    buffer_store_dwordx4 v[20:23], v12, s[36:39], s45 offen offset:1024
    v_cvt_pk_bf16_f32 v16, v48, v49
    v_cvt_pk_bf16_f32 v17, v50, v51
    v_cvt_pk_bf16_f32 v18, v52, v53
    v_cvt_pk_bf16_f32 v19, v54, v55
    buffer_store_dwordx4 v[16:19], v12, s[36:39], s45 offen offset:2048
    v_cvt_pk_bf16_f32 v20, v56, v57
    v_cvt_pk_bf16_f32 v21, v58, v59
    v_cvt_pk_bf16_f32 v22, v60, v61
    v_cvt_pk_bf16_f32 v23, v62, v63
    buffer_store_dwordx4 v[20:23], v12, s[36:39], s45 offen offset:3072
    s_mov_b32 s45, 4096
    v_cvt_pk_bf16_f32 v16, v64, v65
    v_cvt_pk_bf16_f32 v17, v66, v67
    v_cvt_pk_bf16_f32 v18, v68, v69
    v_cvt_pk_bf16_f32 v19, v70, v71
    buffer_store_dwordx4 v[16:19], v12, s[36:39], s45 offen offset:0
    v_cvt_pk_bf16_f32 v20, v72, v73
    v_cvt_pk_bf16_f32 v21, v74, v75
    v_cvt_pk_bf16_f32 v22, v76, v77
    v_cvt_pk_bf16_f32 v23, v78, v79
    buffer_store_dwordx4 v[20:23], v12, s[36:39], s45 offen offset:1024
    v_cvt_pk_bf16_f32 v16, v80, v81
    v_cvt_pk_bf16_f32 v17, v82, v83
    v_cvt_pk_bf16_f32 v18, v84, v85
    v_cvt_pk_bf16_f32 v19, v86, v87
    buffer_store_dwordx4 v[16:19], v12, s[36:39], s45 offen offset:2048
    v_cvt_pk_bf16_f32 v20, v88, v89
    v_cvt_pk_bf16_f32 v21, v90, v91
    v_cvt_pk_bf16_f32 v22, v92, v93
    v_cvt_pk_bf16_f32 v23, v94, v95
    buffer_store_dwordx4 v[20:23], v12, s[36:39], s45 offen offset:3072
    s_mov_b32 s45, 8192
    v_cvt_pk_bf16_f32 v16, v96, v97
    v_cvt_pk_bf16_f32 v17, v98, v99
    v_cvt_pk_bf16_f32 v18, v100, v101
    v_cvt_pk_bf16_f32 v19, v102, v103
    buffer_store_dwordx4 v[16:19], v12, s[36:39], s45 offen offset:0
    v_cvt_pk_bf16_f32 v20, v104, v105
    v_cvt_pk_bf16_f32 v21, v106, v107
    v_cvt_pk_bf16_f32 v22, v108, v109
    v_cvt_pk_bf16_f32 v23, v110, v111
    buffer_store_dwordx4 v[20:23], v12, s[36:39], s45 offen offset:1024
    v_cvt_pk_bf16_f32 v16, v112, v113
    v_cvt_pk_bf16_f32 v17, v114, v115
    v_cvt_pk_bf16_f32 v18, v116, v117
    v_cvt_pk_bf16_f32 v19, v118, v119
    buffer_store_dwordx4 v[16:19], v12, s[36:39], s45 offen offset:2048
    v_cvt_pk_bf16_f32 v20, v120, v121
    v_cvt_pk_bf16_f32 v21, v122, v123
    v_cvt_pk_bf16_f32 v22, v124, v125
    v_cvt_pk_bf16_f32 v23, v126, v127
    buffer_store_dwordx4 v[20:23], v12, s[36:39], s45 offen offset:3072
    s_mov_b32 s45, 12288
    v_cvt_pk_bf16_f32 v16, v128, v129
    v_cvt_pk_bf16_f32 v17, v130, v131
    v_cvt_pk_bf16_f32 v18, v132, v133
    v_cvt_pk_bf16_f32 v19, v134, v135
    buffer_store_dwordx4 v[16:19], v12, s[36:39], s45 offen offset:0
    v_cvt_pk_bf16_f32 v20, v136, v137
    v_cvt_pk_bf16_f32 v21, v138, v139
    v_cvt_pk_bf16_f32 v22, v140, v141
    v_cvt_pk_bf16_f32 v23, v142, v143
    buffer_store_dwordx4 v[20:23], v12, s[36:39], s45 offen offset:1024
    v_cvt_pk_bf16_f32 v16, v144, v145
    v_cvt_pk_bf16_f32 v17, v146, v147
    v_cvt_pk_bf16_f32 v18, v148, v149
    v_cvt_pk_bf16_f32 v19, v150, v151
    buffer_store_dwordx4 v[16:19], v12, s[36:39], s45 offen offset:2048
    v_cvt_pk_bf16_f32 v20, v152, v153
    v_cvt_pk_bf16_f32 v21, v154, v155
    v_cvt_pk_bf16_f32 v22, v156, v157
    v_cvt_pk_bf16_f32 v23, v158, v159
    buffer_store_dwordx4 v[20:23], v12, s[36:39], s45 offen offset:3072
    s_mov_b32 s45, 16384
    v_cvt_pk_bf16_f32 v16, v160, v161
    v_cvt_pk_bf16_f32 v17, v162, v163
    v_cvt_pk_bf16_f32 v18, v164, v165
    v_cvt_pk_bf16_f32 v19, v166, v167
    buffer_store_dwordx4 v[16:19], v12, s[36:39], s45 offen offset:0
    v_cvt_pk_bf16_f32 v20, v168, v169
    v_cvt_pk_bf16_f32 v21, v170, v171
    v_cvt_pk_bf16_f32 v22, v172, v173
    v_cvt_pk_bf16_f32 v23, v174, v175
    buffer_store_dwordx4 v[20:23], v12, s[36:39], s45 offen offset:1024
    v_cvt_pk_bf16_f32 v16, v176, v177
    v_cvt_pk_bf16_f32 v17, v178, v179
    v_cvt_pk_bf16_f32 v18, v180, v181
    v_cvt_pk_bf16_f32 v19, v182, v183
    buffer_store_dwordx4 v[16:19], v12, s[36:39], s45 offen offset:2048
    v_cvt_pk_bf16_f32 v20, v184, v185
    v_cvt_pk_bf16_f32 v21, v186, v187
    v_cvt_pk_bf16_f32 v22, v188, v189
    v_cvt_pk_bf16_f32 v23, v190, v191
    buffer_store_dwordx4 v[20:23], v12, s[36:39], s45 offen offset:3072
    s_mov_b32 s45, 20480
    v_cvt_pk_bf16_f32 v16, v192, v193
    v_cvt_pk_bf16_f32 v17, v194, v195
    v_cvt_pk_bf16_f32 v18, v196, v197
    v_cvt_pk_bf16_f32 v19, v198, v199
    buffer_store_dwordx4 v[16:19], v12, s[36:39], s45 offen offset:0
    v_cvt_pk_bf16_f32 v20, v200, v201
    v_cvt_pk_bf16_f32 v21, v202, v203
    v_cvt_pk_bf16_f32 v22, v204, v205
    v_cvt_pk_bf16_f32 v23, v206, v207
    buffer_store_dwordx4 v[20:23], v12, s[36:39], s45 offen offset:1024
    v_cvt_pk_bf16_f32 v16, v208, v209
    v_cvt_pk_bf16_f32 v17, v210, v211
    v_cvt_pk_bf16_f32 v18, v212, v213
    v_cvt_pk_bf16_f32 v19, v214, v215
    buffer_store_dwordx4 v[16:19], v12, s[36:39], s45 offen offset:2048
    v_cvt_pk_bf16_f32 v20, v216, v217
    v_cvt_pk_bf16_f32 v21, v218, v219
    v_cvt_pk_bf16_f32 v22, v220, v221
    v_cvt_pk_bf16_f32 v23, v222, v223
    buffer_store_dwordx4 v[20:23], v12, s[36:39], s45 offen offset:3072
    s_mov_b32 s45, 24576
    v_cvt_pk_bf16_f32 v16, v224, v225
    v_cvt_pk_bf16_f32 v17, v226, v227
    v_cvt_pk_bf16_f32 v18, v228, v229
    v_cvt_pk_bf16_f32 v19, v230, v231
    buffer_store_dwordx4 v[16:19], v12, s[36:39], s45 offen offset:0
    v_cvt_pk_bf16_f32 v20, v232, v233
    v_cvt_pk_bf16_f32 v21, v234, v235
    v_cvt_pk_bf16_f32 v22, v236, v237
    v_cvt_pk_bf16_f32 v23, v238, v239
    buffer_store_dwordx4 v[20:23], v12, s[36:39], s45 offen offset:1024
    v_cvt_pk_bf16_f32 v16, v240, v241
    v_cvt_pk_bf16_f32 v17, v242, v243
    v_cvt_pk_bf16_f32 v18, v244, v245
    v_cvt_pk_bf16_f32 v19, v246, v247
    buffer_store_dwordx4 v[16:19], v12, s[36:39], s45 offen offset:2048
    v_cvt_pk_bf16_f32 v20, v248, v249
    v_cvt_pk_bf16_f32 v21, v250, v251
    v_cvt_pk_bf16_f32 v22, v252, v253
    v_cvt_pk_bf16_f32 v23, v254, v255
    buffer_store_dwordx4 v[20:23], v12, s[36:39], s45 offen offset:3072
    s_endpgm
attn_rs_1:
    s_nop 15
    v_max_f32 v74, v74, v72
    v_sub_f32 v75, v72, v74
    v_exp_f32 v75, v75
    v_mov_b32 v72, v74
    v_mul_f32 v73, v73, v75
    v_mul_f32 v128, v128, v75
    v_mul_f32 v129, v129, v75
    v_mul_f32 v130, v130, v75
    v_mul_f32 v131, v131, v75
    v_mul_f32 v132, v132, v75
    v_mul_f32 v133, v133, v75
    v_mul_f32 v134, v134, v75
    v_mul_f32 v135, v135, v75
    v_mul_f32 v136, v136, v75
    v_mul_f32 v137, v137, v75
    v_mul_f32 v138, v138, v75
    v_mul_f32 v139, v139, v75
    v_mul_f32 v140, v140, v75
    v_mul_f32 v141, v141, v75
    v_mul_f32 v142, v142, v75
    v_mul_f32 v143, v143, v75
    v_mul_f32 v144, v144, v75
    v_mul_f32 v145, v145, v75
    v_mul_f32 v146, v146, v75
    v_mul_f32 v147, v147, v75
    v_mul_f32 v148, v148, v75
    v_mul_f32 v149, v149, v75
    v_mul_f32 v150, v150, v75
    v_mul_f32 v151, v151, v75
    v_mul_f32 v152, v152, v75
    v_mul_f32 v153, v153, v75
    v_mul_f32 v154, v154, v75
    v_mul_f32 v155, v155, v75
    v_mul_f32 v156, v156, v75
    v_mul_f32 v157, v157, v75
    v_mul_f32 v158, v158, v75
    v_mul_f32 v159, v159, v75
    v_mul_f32 v160, v160, v75
    v_mul_f32 v161, v161, v75
    v_mul_f32 v162, v162, v75
    v_mul_f32 v163, v163, v75
    v_mul_f32 v164, v164, v75
    v_mul_f32 v165, v165, v75
    v_mul_f32 v166, v166, v75
    v_mul_f32 v167, v167, v75
    v_mul_f32 v168, v168, v75
    v_mul_f32 v169, v169, v75
    v_mul_f32 v170, v170, v75
    v_mul_f32 v171, v171, v75
    v_mul_f32 v172, v172, v75
    v_mul_f32 v173, v173, v75
    v_mul_f32 v174, v174, v75
    v_mul_f32 v175, v175, v75
    v_mul_f32 v176, v176, v75
    v_mul_f32 v177, v177, v75
    v_mul_f32 v178, v178, v75
    v_mul_f32 v179, v179, v75
    v_mul_f32 v180, v180, v75
    v_mul_f32 v181, v181, v75
    v_mul_f32 v182, v182, v75
    v_mul_f32 v183, v183, v75
    v_mul_f32 v184, v184, v75
    v_mul_f32 v185, v185, v75
    v_mul_f32 v186, v186, v75
    v_mul_f32 v187, v187, v75
    v_mul_f32 v188, v188, v75
    v_mul_f32 v189, v189, v75
    v_mul_f32 v190, v190, v75
    v_mul_f32 v191, v191, v75
    v_mul_f32 v192, v192, v75
    v_mul_f32 v193, v193, v75
    v_mul_f32 v194, v194, v75
    v_mul_f32 v195, v195, v75
    v_mul_f32 v196, v196, v75
    v_mul_f32 v197, v197, v75
    v_mul_f32 v198, v198, v75
    v_mul_f32 v199, v199, v75
    v_mul_f32 v200, v200, v75
    v_mul_f32 v201, v201, v75
    v_mul_f32 v202, v202, v75
    v_mul_f32 v203, v203, v75
    v_mul_f32 v204, v204, v75
    v_mul_f32 v205, v205, v75
    v_mul_f32 v206, v206, v75
    v_mul_f32 v207, v207, v75
    v_mul_f32 v208, v208, v75
    v_mul_f32 v209, v209, v75
    v_mul_f32 v210, v210, v75
    v_mul_f32 v211, v211, v75
    v_mul_f32 v212, v212, v75
    v_mul_f32 v213, v213, v75
    v_mul_f32 v214, v214, v75
    v_mul_f32 v215, v215, v75
    v_mul_f32 v216, v216, v75
    v_mul_f32 v217, v217, v75
    v_mul_f32 v218, v218, v75
    v_mul_f32 v219, v219, v75
    v_mul_f32 v220, v220, v75
    v_mul_f32 v221, v221, v75
    v_mul_f32 v222, v222, v75
    v_mul_f32 v223, v223, v75
    v_mul_f32 v224, v224, v75
    v_mul_f32 v225, v225, v75
    v_mul_f32 v226, v226, v75
    v_mul_f32 v227, v227, v75
    v_mul_f32 v228, v228, v75
    v_mul_f32 v229, v229, v75
    v_mul_f32 v230, v230, v75
    v_mul_f32 v231, v231, v75
    v_mul_f32 v232, v232, v75
    v_mul_f32 v233, v233, v75
    v_mul_f32 v234, v234, v75
    v_mul_f32 v235, v235, v75
    v_mul_f32 v236, v236, v75
    v_mul_f32 v237, v237, v75
    v_mul_f32 v238, v238, v75
    v_mul_f32 v239, v239, v75
    v_mul_f32 v240, v240, v75
    v_mul_f32 v241, v241, v75
    v_mul_f32 v242, v242, v75
    v_mul_f32 v243, v243, v75
    v_mul_f32 v244, v244, v75
    v_mul_f32 v245, v245, v75
    v_mul_f32 v246, v246, v75
    v_mul_f32 v247, v247, v75
    v_mul_f32 v248, v248, v75
    v_mul_f32 v249, v249, v75
    v_mul_f32 v250, v250, v75
    v_mul_f32 v251, v251, v75
    v_mul_f32 v252, v252, v75
    v_mul_f32 v253, v253, v75
    v_mul_f32 v254, v254, v75
    v_mul_f32 v255, v255, v75
    s_nop 3
    s_branch attn_rsb_2
attn_rs_3:
    s_nop 15
    v_max_f32 v74, v74, v72
    v_sub_f32 v75, v72, v74
    v_exp_f32 v75, v75
    v_mov_b32 v72, v74
    v_mul_f32 v73, v73, v75
    v_mul_f32 v128, v128, v75
    v_mul_f32 v129, v129, v75
    v_mul_f32 v130, v130, v75
    v_mul_f32 v131, v131, v75
    v_mul_f32 v132, v132, v75
    v_mul_f32 v133, v133, v75
    v_mul_f32 v134, v134, v75
    v_mul_f32 v135, v135, v75
    v_mul_f32 v136, v136, v75
    v_mul_f32 v137, v137, v75
    v_mul_f32 v138, v138, v75
    v_mul_f32 v139, v139, v75
    v_mul_f32 v140, v140, v75
    v_mul_f32 v141, v141, v75
    v_mul_f32 v142, v142, v75
    v_mul_f32 v143, v143, v75
    v_mul_f32 v144, v144, v75
    v_mul_f32 v145, v145, v75
    v_mul_f32 v146, v146, v75
    v_mul_f32 v147, v147, v75
    v_mul_f32 v148, v148, v75
    v_mul_f32 v149, v149, v75
    v_mul_f32 v150, v150, v75
    v_mul_f32 v151, v151, v75
    v_mul_f32 v152, v152, v75
    v_mul_f32 v153, v153, v75
    v_mul_f32 v154, v154, v75
    v_mul_f32 v155, v155, v75
    v_mul_f32 v156, v156, v75
    v_mul_f32 v157, v157, v75
    v_mul_f32 v158, v158, v75
    v_mul_f32 v159, v159, v75
    v_mul_f32 v160, v160, v75
    v_mul_f32 v161, v161, v75
    v_mul_f32 v162, v162, v75
    v_mul_f32 v163, v163, v75
    v_mul_f32 v164, v164, v75
    v_mul_f32 v165, v165, v75
    v_mul_f32 v166, v166, v75
    v_mul_f32 v167, v167, v75
    v_mul_f32 v168, v168, v75
    v_mul_f32 v169, v169, v75
    v_mul_f32 v170, v170, v75
    v_mul_f32 v171, v171, v75
    v_mul_f32 v172, v172, v75
    v_mul_f32 v173, v173, v75
    v_mul_f32 v174, v174, v75
    v_mul_f32 v175, v175, v75
    v_mul_f32 v176, v176, v75
    v_mul_f32 v177, v177, v75
    v_mul_f32 v178, v178, v75
    v_mul_f32 v179, v179, v75
    v_mul_f32 v180, v180, v75
    v_mul_f32 v181, v181, v75
    v_mul_f32 v182, v182, v75
    v_mul_f32 v183, v183, v75
    v_mul_f32 v184, v184, v75
    v_mul_f32 v185, v185, v75
    v_mul_f32 v186, v186, v75
    v_mul_f32 v187, v187, v75
    v_mul_f32 v188, v188, v75
    v_mul_f32 v189, v189, v75
    v_mul_f32 v190, v190, v75
    v_mul_f32 v191, v191, v75
    v_mul_f32 v192, v192, v75
    v_mul_f32 v193, v193, v75
    v_mul_f32 v194, v194, v75
    v_mul_f32 v195, v195, v75
    v_mul_f32 v196, v196, v75
    v_mul_f32 v197, v197, v75
    v_mul_f32 v198, v198, v75
    v_mul_f32 v199, v199, v75
    v_mul_f32 v200, v200, v75
    v_mul_f32 v201, v201, v75
    v_mul_f32 v202, v202, v75
    v_mul_f32 v203, v203, v75
    v_mul_f32 v204, v204, v75
    v_mul_f32 v205, v205, v75
    v_mul_f32 v206, v206, v75
    v_mul_f32 v207, v207, v75
    v_mul_f32 v208, v208, v75
    v_mul_f32 v209, v209, v75
    v_mul_f32 v210, v210, v75
    v_mul_f32 v211, v211, v75
    v_mul_f32 v212, v212, v75
    v_mul_f32 v213, v213, v75
    v_mul_f32 v214, v214, v75
    v_mul_f32 v215, v215, v75
    v_mul_f32 v216, v216, v75
    v_mul_f32 v217, v217, v75
    v_mul_f32 v218, v218, v75
    v_mul_f32 v219, v219, v75
    v_mul_f32 v220, v220, v75
    v_mul_f32 v221, v221, v75
    v_mul_f32 v222, v222, v75
    v_mul_f32 v223, v223, v75
    v_mul_f32 v224, v224, v75
    v_mul_f32 v225, v225, v75
    v_mul_f32 v226, v226, v75
    v_mul_f32 v227, v227, v75
    v_mul_f32 v228, v228, v75
    v_mul_f32 v229, v229, v75
    v_mul_f32 v230, v230, v75
    v_mul_f32 v231, v231, v75
    v_mul_f32 v232, v232, v75
    v_mul_f32 v233, v233, v75
    v_mul_f32 v234, v234, v75
    v_mul_f32 v235, v235, v75
    v_mul_f32 v236, v236, v75
    v_mul_f32 v237, v237, v75
    v_mul_f32 v238, v238, v75
    v_mul_f32 v239, v239, v75
    v_mul_f32 v240, v240, v75
    v_mul_f32 v241, v241, v75
    v_mul_f32 v242, v242, v75
    v_mul_f32 v243, v243, v75
    v_mul_f32 v244, v244, v75
    v_mul_f32 v245, v245, v75
    v_mul_f32 v246, v246, v75
    v_mul_f32 v247, v247, v75
    v_mul_f32 v248, v248, v75
    v_mul_f32 v249, v249, v75
    v_mul_f32 v250, v250, v75
    v_mul_f32 v251, v251, v75
    v_mul_f32 v252, v252, v75
    v_mul_f32 v253, v253, v75
    v_mul_f32 v254, v254, v75
    v_mul_f32 v255, v255, v75
    s_nop 3
    s_branch attn_rsb_4
attn_rs_5:
    s_nop 15
    v_max_f32 v74, v74, v72
    v_sub_f32 v75, v72, v74
    v_exp_f32 v75, v75
    v_mov_b32 v72, v74
    v_mul_f32 v73, v73, v75
    v_mul_f32 v128, v128, v75
    v_mul_f32 v129, v129, v75
    v_mul_f32 v130, v130, v75
    v_mul_f32 v131, v131, v75
    v_mul_f32 v132, v132, v75
    v_mul_f32 v133, v133, v75
    v_mul_f32 v134, v134, v75
    v_mul_f32 v135, v135, v75
    v_mul_f32 v136, v136, v75
    v_mul_f32 v137, v137, v75
    v_mul_f32 v138, v138, v75
    v_mul_f32 v139, v139, v75
    v_mul_f32 v140, v140, v75
    v_mul_f32 v141, v141, v75
    v_mul_f32 v142, v142, v75
    v_mul_f32 v143, v143, v75
    v_mul_f32 v144, v144, v75
    v_mul_f32 v145, v145, v75
    v_mul_f32 v146, v146, v75
    v_mul_f32 v147, v147, v75
    v_mul_f32 v148, v148, v75
    v_mul_f32 v149, v149, v75
    v_mul_f32 v150, v150, v75
    v_mul_f32 v151, v151, v75
    v_mul_f32 v152, v152, v75
    v_mul_f32 v153, v153, v75
    v_mul_f32 v154, v154, v75
    v_mul_f32 v155, v155, v75
    v_mul_f32 v156, v156, v75
    v_mul_f32 v157, v157, v75
    v_mul_f32 v158, v158, v75
    v_mul_f32 v159, v159, v75
    v_mul_f32 v160, v160, v75
    v_mul_f32 v161, v161, v75
    v_mul_f32 v162, v162, v75
    v_mul_f32 v163, v163, v75
    v_mul_f32 v164, v164, v75
    v_mul_f32 v165, v165, v75
    v_mul_f32 v166, v166, v75
    v_mul_f32 v167, v167, v75
    v_mul_f32 v168, v168, v75
    v_mul_f32 v169, v169, v75
    v_mul_f32 v170, v170, v75
    v_mul_f32 v171, v171, v75
    v_mul_f32 v172, v172, v75
    v_mul_f32 v173, v173, v75
    v_mul_f32 v174, v174, v75
    v_mul_f32 v175, v175, v75
    v_mul_f32 v176, v176, v75
    v_mul_f32 v177, v177, v75
    v_mul_f32 v178, v178, v75
    v_mul_f32 v179, v179, v75
    v_mul_f32 v180, v180, v75
    v_mul_f32 v181, v181, v75
    v_mul_f32 v182, v182, v75
    v_mul_f32 v183, v183, v75
    v_mul_f32 v184, v184, v75
    v_mul_f32 v185, v185, v75
    v_mul_f32 v186, v186, v75
    v_mul_f32 v187, v187, v75
    v_mul_f32 v188, v188, v75
    v_mul_f32 v189, v189, v75
    v_mul_f32 v190, v190, v75
    v_mul_f32 v191, v191, v75
    v_mul_f32 v192, v192, v75
    v_mul_f32 v193, v193, v75
    v_mul_f32 v194, v194, v75
    v_mul_f32 v195, v195, v75
    v_mul_f32 v196, v196, v75
    v_mul_f32 v197, v197, v75
    v_mul_f32 v198, v198, v75
    v_mul_f32 v199, v199, v75
    v_mul_f32 v200, v200, v75
    v_mul_f32 v201, v201, v75
    v_mul_f32 v202, v202, v75
    v_mul_f32 v203, v203, v75
    v_mul_f32 v204, v204, v75
    v_mul_f32 v205, v205, v75
    v_mul_f32 v206, v206, v75
    v_mul_f32 v207, v207, v75
    v_mul_f32 v208, v208, v75
    v_mul_f32 v209, v209, v75
    v_mul_f32 v210, v210, v75
    v_mul_f32 v211, v211, v75
    v_mul_f32 v212, v212, v75
    v_mul_f32 v213, v213, v75
    v_mul_f32 v214, v214, v75
    v_mul_f32 v215, v215, v75
    v_mul_f32 v216, v216, v75
    v_mul_f32 v217, v217, v75
    v_mul_f32 v218, v218, v75
    v_mul_f32 v219, v219, v75
    v_mul_f32 v220, v220, v75
    v_mul_f32 v221, v221, v75
    v_mul_f32 v222, v222, v75
    v_mul_f32 v223, v223, v75
    v_mul_f32 v224, v224, v75
    v_mul_f32 v225, v225, v75
    v_mul_f32 v226, v226, v75
    v_mul_f32 v227, v227, v75
    v_mul_f32 v228, v228, v75
    v_mul_f32 v229, v229, v75
    v_mul_f32 v230, v230, v75
    v_mul_f32 v231, v231, v75
    v_mul_f32 v232, v232, v75
    v_mul_f32 v233, v233, v75
    v_mul_f32 v234, v234, v75
    v_mul_f32 v235, v235, v75
    v_mul_f32 v236, v236, v75
    v_mul_f32 v237, v237, v75
    v_mul_f32 v238, v238, v75
    v_mul_f32 v239, v239, v75
    v_mul_f32 v240, v240, v75
    v_mul_f32 v241, v241, v75
    v_mul_f32 v242, v242, v75
    v_mul_f32 v243, v243, v75
    v_mul_f32 v244, v244, v75
    v_mul_f32 v245, v245, v75
    v_mul_f32 v246, v246, v75
    v_mul_f32 v247, v247, v75
    v_mul_f32 v248, v248, v75
    v_mul_f32 v249, v249, v75
    v_mul_f32 v250, v250, v75
    v_mul_f32 v251, v251, v75
    v_mul_f32 v252, v252, v75
    v_mul_f32 v253, v253, v75
    v_mul_f32 v254, v254, v75
    v_mul_f32 v255, v255, v75
    s_nop 3
    s_branch attn_rsb_6
attn_rs_7:
    s_nop 15
    v_max_f32 v74, v74, v72
    v_sub_f32 v75, v72, v74
    v_exp_f32 v75, v75
    v_mov_b32 v72, v74
    v_mul_f32 v73, v73, v75
    v_mul_f32 v128, v128, v75
    v_mul_f32 v129, v129, v75
    v_mul_f32 v130, v130, v75
    v_mul_f32 v131, v131, v75
    v_mul_f32 v132, v132, v75
    v_mul_f32 v133, v133, v75
    v_mul_f32 v134, v134, v75
    v_mul_f32 v135, v135, v75
    v_mul_f32 v136, v136, v75
    v_mul_f32 v137, v137, v75
    v_mul_f32 v138, v138, v75
    v_mul_f32 v139, v139, v75
    v_mul_f32 v140, v140, v75
    v_mul_f32 v141, v141, v75
    v_mul_f32 v142, v142, v75
    v_mul_f32 v143, v143, v75
    v_mul_f32 v144, v144, v75
    v_mul_f32 v145, v145, v75
    v_mul_f32 v146, v146, v75
    v_mul_f32 v147, v147, v75
    v_mul_f32 v148, v148, v75
    v_mul_f32 v149, v149, v75
    v_mul_f32 v150, v150, v75
    v_mul_f32 v151, v151, v75
    v_mul_f32 v152, v152, v75
    v_mul_f32 v153, v153, v75
    v_mul_f32 v154, v154, v75
    v_mul_f32 v155, v155, v75
    v_mul_f32 v156, v156, v75
    v_mul_f32 v157, v157, v75
    v_mul_f32 v158, v158, v75
    v_mul_f32 v159, v159, v75
    v_mul_f32 v160, v160, v75
    v_mul_f32 v161, v161, v75
    v_mul_f32 v162, v162, v75
    v_mul_f32 v163, v163, v75
    v_mul_f32 v164, v164, v75
    v_mul_f32 v165, v165, v75
    v_mul_f32 v166, v166, v75
    v_mul_f32 v167, v167, v75
    v_mul_f32 v168, v168, v75
    v_mul_f32 v169, v169, v75
    v_mul_f32 v170, v170, v75
    v_mul_f32 v171, v171, v75
    v_mul_f32 v172, v172, v75
    v_mul_f32 v173, v173, v75
    v_mul_f32 v174, v174, v75
    v_mul_f32 v175, v175, v75
    v_mul_f32 v176, v176, v75
    v_mul_f32 v177, v177, v75
    v_mul_f32 v178, v178, v75
    v_mul_f32 v179, v179, v75
    v_mul_f32 v180, v180, v75
    v_mul_f32 v181, v181, v75
    v_mul_f32 v182, v182, v75
    v_mul_f32 v183, v183, v75
    v_mul_f32 v184, v184, v75
    v_mul_f32 v185, v185, v75
    v_mul_f32 v186, v186, v75
    v_mul_f32 v187, v187, v75
    v_mul_f32 v188, v188, v75
    v_mul_f32 v189, v189, v75
    v_mul_f32 v190, v190, v75
    v_mul_f32 v191, v191, v75
    v_mul_f32 v192, v192, v75
    v_mul_f32 v193, v193, v75
    v_mul_f32 v194, v194, v75
    v_mul_f32 v195, v195, v75
    v_mul_f32 v196, v196, v75
    v_mul_f32 v197, v197, v75
    v_mul_f32 v198, v198, v75
    v_mul_f32 v199, v199, v75
    v_mul_f32 v200, v200, v75
    v_mul_f32 v201, v201, v75
    v_mul_f32 v202, v202, v75
    v_mul_f32 v203, v203, v75
    v_mul_f32 v204, v204, v75
    v_mul_f32 v205, v205, v75
    v_mul_f32 v206, v206, v75
    v_mul_f32 v207, v207, v75
    v_mul_f32 v208, v208, v75
    v_mul_f32 v209, v209, v75
    v_mul_f32 v210, v210, v75
    v_mul_f32 v211, v211, v75
    v_mul_f32 v212, v212, v75
    v_mul_f32 v213, v213, v75
    v_mul_f32 v214, v214, v75
    v_mul_f32 v215, v215, v75
    v_mul_f32 v216, v216, v75
    v_mul_f32 v217, v217, v75
    v_mul_f32 v218, v218, v75
    v_mul_f32 v219, v219, v75
    v_mul_f32 v220, v220, v75
    v_mul_f32 v221, v221, v75
    v_mul_f32 v222, v222, v75
    v_mul_f32 v223, v223, v75
    v_mul_f32 v224, v224, v75
    v_mul_f32 v225, v225, v75
    v_mul_f32 v226, v226, v75
    v_mul_f32 v227, v227, v75
    v_mul_f32 v228, v228, v75
    v_mul_f32 v229, v229, v75
    v_mul_f32 v230, v230, v75
    v_mul_f32 v231, v231, v75
    v_mul_f32 v232, v232, v75
    v_mul_f32 v233, v233, v75
    v_mul_f32 v234, v234, v75
    v_mul_f32 v235, v235, v75
    v_mul_f32 v236, v236, v75
    v_mul_f32 v237, v237, v75
    v_mul_f32 v238, v238, v75
    v_mul_f32 v239, v239, v75
    v_mul_f32 v240, v240, v75
    v_mul_f32 v241, v241, v75
    v_mul_f32 v242, v242, v75
    v_mul_f32 v243, v243, v75
    v_mul_f32 v244, v244, v75
    v_mul_f32 v245, v245, v75
    v_mul_f32 v246, v246, v75
    v_mul_f32 v247, v247, v75
    v_mul_f32 v248, v248, v75
    v_mul_f32 v249, v249, v75
    v_mul_f32 v250, v250, v75
    v_mul_f32 v251, v251, v75
    v_mul_f32 v252, v252, v75
    v_mul_f32 v253, v253, v75
    v_mul_f32 v254, v254, v75
    v_mul_f32 v255, v255, v75
    s_nop 3
    s_branch attn_rsb_8
attn_rs_9:
    s_nop 15
    v_max_f32 v74, v74, v72
    v_sub_f32 v75, v72, v74
    v_exp_f32 v75, v75
    v_mov_b32 v72, v74
    v_mul_f32 v73, v73, v75
    v_mul_f32 v128, v128, v75
    v_mul_f32 v129, v129, v75
    v_mul_f32 v130, v130, v75
    v_mul_f32 v131, v131, v75
    v_mul_f32 v132, v132, v75
    v_mul_f32 v133, v133, v75
    v_mul_f32 v134, v134, v75
    v_mul_f32 v135, v135, v75
    v_mul_f32 v136, v136, v75
    v_mul_f32 v137, v137, v75
    v_mul_f32 v138, v138, v75
    v_mul_f32 v139, v139, v75
    v_mul_f32 v140, v140, v75
    v_mul_f32 v141, v141, v75
    v_mul_f32 v142, v142, v75
    v_mul_f32 v143, v143, v75
    v_mul_f32 v144, v144, v75
    v_mul_f32 v145, v145, v75
    v_mul_f32 v146, v146, v75
    v_mul_f32 v147, v147, v75
    v_mul_f32 v148, v148, v75
    v_mul_f32 v149, v149, v75
    v_mul_f32 v150, v150, v75
    v_mul_f32 v151, v151, v75
    v_mul_f32 v152, v152, v75
    v_mul_f32 v153, v153, v75
    v_mul_f32 v154, v154, v75
    v_mul_f32 v155, v155, v75
    v_mul_f32 v156, v156, v75
    v_mul_f32 v157, v157, v75
    v_mul_f32 v158, v158, v75
    v_mul_f32 v159, v159, v75
    v_mul_f32 v160, v160, v75
    v_mul_f32 v161, v161, v75
    v_mul_f32 v162, v162, v75
    v_mul_f32 v163, v163, v75
    v_mul_f32 v164, v164, v75
    v_mul_f32 v165, v165, v75
    v_mul_f32 v166, v166, v75
    v_mul_f32 v167, v167, v75
    v_mul_f32 v168, v168, v75
    v_mul_f32 v169, v169, v75
    v_mul_f32 v170, v170, v75
    v_mul_f32 v171, v171, v75
    v_mul_f32 v172, v172, v75
    v_mul_f32 v173, v173, v75
    v_mul_f32 v174, v174, v75
    v_mul_f32 v175, v175, v75
    v_mul_f32 v176, v176, v75
    v_mul_f32 v177, v177, v75
    v_mul_f32 v178, v178, v75
    v_mul_f32 v179, v179, v75
    v_mul_f32 v180, v180, v75
    v_mul_f32 v181, v181, v75
    v_mul_f32 v182, v182, v75
    v_mul_f32 v183, v183, v75
    v_mul_f32 v184, v184, v75
    v_mul_f32 v185, v185, v75
    v_mul_f32 v186, v186, v75
    v_mul_f32 v187, v187, v75
    v_mul_f32 v188, v188, v75
    v_mul_f32 v189, v189, v75
    v_mul_f32 v190, v190, v75
    v_mul_f32 v191, v191, v75
    v_mul_f32 v192, v192, v75
    v_mul_f32 v193, v193, v75
    v_mul_f32 v194, v194, v75
    v_mul_f32 v195, v195, v75
    v_mul_f32 v196, v196, v75
    v_mul_f32 v197, v197, v75
    v_mul_f32 v198, v198, v75
    v_mul_f32 v199, v199, v75
    v_mul_f32 v200, v200, v75
    v_mul_f32 v201, v201, v75
    v_mul_f32 v202, v202, v75
    v_mul_f32 v203, v203, v75
    v_mul_f32 v204, v204, v75
    v_mul_f32 v205, v205, v75
    v_mul_f32 v206, v206, v75
    v_mul_f32 v207, v207, v75
    v_mul_f32 v208, v208, v75
    v_mul_f32 v209, v209, v75
    v_mul_f32 v210, v210, v75
    v_mul_f32 v211, v211, v75
    v_mul_f32 v212, v212, v75
    v_mul_f32 v213, v213, v75
    v_mul_f32 v214, v214, v75
    v_mul_f32 v215, v215, v75
    v_mul_f32 v216, v216, v75
    v_mul_f32 v217, v217, v75
    v_mul_f32 v218, v218, v75
    v_mul_f32 v219, v219, v75
    v_mul_f32 v220, v220, v75
    v_mul_f32 v221, v221, v75
    v_mul_f32 v222, v222, v75
    v_mul_f32 v223, v223, v75
    v_mul_f32 v224, v224, v75
    v_mul_f32 v225, v225, v75
    v_mul_f32 v226, v226, v75
    v_mul_f32 v227, v227, v75
    v_mul_f32 v228, v228, v75
    v_mul_f32 v229, v229, v75
    v_mul_f32 v230, v230, v75
    v_mul_f32 v231, v231, v75
    v_mul_f32 v232, v232, v75
    v_mul_f32 v233, v233, v75
    v_mul_f32 v234, v234, v75
    v_mul_f32 v235, v235, v75
    v_mul_f32 v236, v236, v75
    v_mul_f32 v237, v237, v75
    v_mul_f32 v238, v238, v75
    v_mul_f32 v239, v239, v75
    v_mul_f32 v240, v240, v75
    v_mul_f32 v241, v241, v75
    v_mul_f32 v242, v242, v75
    v_mul_f32 v243, v243, v75
    v_mul_f32 v244, v244, v75
    v_mul_f32 v245, v245, v75
    v_mul_f32 v246, v246, v75
    v_mul_f32 v247, v247, v75
    v_mul_f32 v248, v248, v75
    v_mul_f32 v249, v249, v75
    v_mul_f32 v250, v250, v75
    v_mul_f32 v251, v251, v75
    v_mul_f32 v252, v252, v75
    v_mul_f32 v253, v253, v75
    v_mul_f32 v254, v254, v75
    v_mul_f32 v255, v255, v75
    s_nop 3
    s_branch attn_rsb_10
attn_rs_11:
    s_nop 15
    v_max_f32 v74, v74, v72
    v_sub_f32 v75, v72, v74
    v_exp_f32 v75, v75
    v_mov_b32 v72, v74
    v_mul_f32 v73, v73, v75
    v_mul_f32 v128, v128, v75
    v_mul_f32 v129, v129, v75
    v_mul_f32 v130, v130, v75
    v_mul_f32 v131, v131, v75
    v_mul_f32 v132, v132, v75
    v_mul_f32 v133, v133, v75
    v_mul_f32 v134, v134, v75
    v_mul_f32 v135, v135, v75
    v_mul_f32 v136, v136, v75
    v_mul_f32 v137, v137, v75
    v_mul_f32 v138, v138, v75
    v_mul_f32 v139, v139, v75
    v_mul_f32 v140, v140, v75
    v_mul_f32 v141, v141, v75
    v_mul_f32 v142, v142, v75
    v_mul_f32 v143, v143, v75
    v_mul_f32 v144, v144, v75
    v_mul_f32 v145, v145, v75
    v_mul_f32 v146, v146, v75
    v_mul_f32 v147, v147, v75
    v_mul_f32 v148, v148, v75
    v_mul_f32 v149, v149, v75
    v_mul_f32 v150, v150, v75
    v_mul_f32 v151, v151, v75
    v_mul_f32 v152, v152, v75
    v_mul_f32 v153, v153, v75
    v_mul_f32 v154, v154, v75
    v_mul_f32 v155, v155, v75
    v_mul_f32 v156, v156, v75
    v_mul_f32 v157, v157, v75
    v_mul_f32 v158, v158, v75
    v_mul_f32 v159, v159, v75
    v_mul_f32 v160, v160, v75
    v_mul_f32 v161, v161, v75
    v_mul_f32 v162, v162, v75
    v_mul_f32 v163, v163, v75
    v_mul_f32 v164, v164, v75
    v_mul_f32 v165, v165, v75
    v_mul_f32 v166, v166, v75
    v_mul_f32 v167, v167, v75
    v_mul_f32 v168, v168, v75
    v_mul_f32 v169, v169, v75
    v_mul_f32 v170, v170, v75
    v_mul_f32 v171, v171, v75
    v_mul_f32 v172, v172, v75
    v_mul_f32 v173, v173, v75
    v_mul_f32 v174, v174, v75
    v_mul_f32 v175, v175, v75
    v_mul_f32 v176, v176, v75
    v_mul_f32 v177, v177, v75
    v_mul_f32 v178, v178, v75
    v_mul_f32 v179, v179, v75
    v_mul_f32 v180, v180, v75
    v_mul_f32 v181, v181, v75
    v_mul_f32 v182, v182, v75
    v_mul_f32 v183, v183, v75
    v_mul_f32 v184, v184, v75
    v_mul_f32 v185, v185, v75
    v_mul_f32 v186, v186, v75
    v_mul_f32 v187, v187, v75
    v_mul_f32 v188, v188, v75
    v_mul_f32 v189, v189, v75
    v_mul_f32 v190, v190, v75
    v_mul_f32 v191, v191, v75
    v_mul_f32 v192, v192, v75
    v_mul_f32 v193, v193, v75
    v_mul_f32 v194, v194, v75
    v_mul_f32 v195, v195, v75
    v_mul_f32 v196, v196, v75
    v_mul_f32 v197, v197, v75
    v_mul_f32 v198, v198, v75
    v_mul_f32 v199, v199, v75
    v_mul_f32 v200, v200, v75
    v_mul_f32 v201, v201, v75
    v_mul_f32 v202, v202, v75
    v_mul_f32 v203, v203, v75
    v_mul_f32 v204, v204, v75
    v_mul_f32 v205, v205, v75
    v_mul_f32 v206, v206, v75
    v_mul_f32 v207, v207, v75
    v_mul_f32 v208, v208, v75
    v_mul_f32 v209, v209, v75
    v_mul_f32 v210, v210, v75
    v_mul_f32 v211, v211, v75
    v_mul_f32 v212, v212, v75
    v_mul_f32 v213, v213, v75
    v_mul_f32 v214, v214, v75
    v_mul_f32 v215, v215, v75
    v_mul_f32 v216, v216, v75
    v_mul_f32 v217, v217, v75
    v_mul_f32 v218, v218, v75
    v_mul_f32 v219, v219, v75
    v_mul_f32 v220, v220, v75
    v_mul_f32 v221, v221, v75
    v_mul_f32 v222, v222, v75
    v_mul_f32 v223, v223, v75
    v_mul_f32 v224, v224, v75
    v_mul_f32 v225, v225, v75
    v_mul_f32 v226, v226, v75
    v_mul_f32 v227, v227, v75
    v_mul_f32 v228, v228, v75
    v_mul_f32 v229, v229, v75
    v_mul_f32 v230, v230, v75
    v_mul_f32 v231, v231, v75
    v_mul_f32 v232, v232, v75
    v_mul_f32 v233, v233, v75
    v_mul_f32 v234, v234, v75
    v_mul_f32 v235, v235, v75
    v_mul_f32 v236, v236, v75
    v_mul_f32 v237, v237, v75
    v_mul_f32 v238, v238, v75
    v_mul_f32 v239, v239, v75
    v_mul_f32 v240, v240, v75
    v_mul_f32 v241, v241, v75
    v_mul_f32 v242, v242, v75
    v_mul_f32 v243, v243, v75
    v_mul_f32 v244, v244, v75
    v_mul_f32 v245, v245, v75
    v_mul_f32 v246, v246, v75
    v_mul_f32 v247, v247, v75
    v_mul_f32 v248, v248, v75
    v_mul_f32 v249, v249, v75
    v_mul_f32 v250, v250, v75
    v_mul_f32 v251, v251, v75
    v_mul_f32 v252, v252, v75
    v_mul_f32 v253, v253, v75
    v_mul_f32 v254, v254, v75
    v_mul_f32 v255, v255, v75
    s_nop 3
    s_branch attn_rsb_12
attn_rs_13:
    s_nop 15
    v_max_f32 v74, v74, v72
    v_sub_f32 v75, v72, v74
    v_exp_f32 v75, v75
    v_mov_b32 v72, v74
    v_mul_f32 v73, v73, v75
    v_mul_f32 v128, v128, v75
    v_mul_f32 v129, v129, v75
    v_mul_f32 v130, v130, v75
    v_mul_f32 v131, v131, v75
    v_mul_f32 v132, v132, v75
    v_mul_f32 v133, v133, v75
    v_mul_f32 v134, v134, v75
    v_mul_f32 v135, v135, v75
    v_mul_f32 v136, v136, v75
    v_mul_f32 v137, v137, v75
    v_mul_f32 v138, v138, v75
    v_mul_f32 v139, v139, v75
    v_mul_f32 v140, v140, v75
    v_mul_f32 v141, v141, v75
    v_mul_f32 v142, v142, v75
    v_mul_f32 v143, v143, v75
    v_mul_f32 v144, v144, v75
    v_mul_f32 v145, v145, v75
    v_mul_f32 v146, v146, v75
    v_mul_f32 v147, v147, v75
    v_mul_f32 v148, v148, v75
    v_mul_f32 v149, v149, v75
    v_mul_f32 v150, v150, v75
    v_mul_f32 v151, v151, v75
    v_mul_f32 v152, v152, v75
    v_mul_f32 v153, v153, v75
    v_mul_f32 v154, v154, v75
    v_mul_f32 v155, v155, v75
    v_mul_f32 v156, v156, v75
    v_mul_f32 v157, v157, v75
    v_mul_f32 v158, v158, v75
    v_mul_f32 v159, v159, v75
    v_mul_f32 v160, v160, v75
    v_mul_f32 v161, v161, v75
    v_mul_f32 v162, v162, v75
    v_mul_f32 v163, v163, v75
    v_mul_f32 v164, v164, v75
    v_mul_f32 v165, v165, v75
    v_mul_f32 v166, v166, v75
    v_mul_f32 v167, v167, v75
    v_mul_f32 v168, v168, v75
    v_mul_f32 v169, v169, v75
    v_mul_f32 v170, v170, v75
    v_mul_f32 v171, v171, v75
    v_mul_f32 v172, v172, v75
    v_mul_f32 v173, v173, v75
    v_mul_f32 v174, v174, v75
    v_mul_f32 v175, v175, v75
    v_mul_f32 v176, v176, v75
    v_mul_f32 v177, v177, v75
    v_mul_f32 v178, v178, v75
    v_mul_f32 v179, v179, v75
    v_mul_f32 v180, v180, v75
    v_mul_f32 v181, v181, v75
    v_mul_f32 v182, v182, v75
    v_mul_f32 v183, v183, v75
    v_mul_f32 v184, v184, v75
    v_mul_f32 v185, v185, v75
    v_mul_f32 v186, v186, v75
    v_mul_f32 v187, v187, v75
    v_mul_f32 v188, v188, v75
    v_mul_f32 v189, v189, v75
    v_mul_f32 v190, v190, v75
    v_mul_f32 v191, v191, v75
    v_mul_f32 v192, v192, v75
    v_mul_f32 v193, v193, v75
    v_mul_f32 v194, v194, v75
    v_mul_f32 v195, v195, v75
    v_mul_f32 v196, v196, v75
    v_mul_f32 v197, v197, v75
    v_mul_f32 v198, v198, v75
    v_mul_f32 v199, v199, v75
    v_mul_f32 v200, v200, v75
    v_mul_f32 v201, v201, v75
    v_mul_f32 v202, v202, v75
    v_mul_f32 v203, v203, v75
    v_mul_f32 v204, v204, v75
    v_mul_f32 v205, v205, v75
    v_mul_f32 v206, v206, v75
    v_mul_f32 v207, v207, v75
    v_mul_f32 v208, v208, v75
    v_mul_f32 v209, v209, v75
    v_mul_f32 v210, v210, v75
    v_mul_f32 v211, v211, v75
    v_mul_f32 v212, v212, v75
    v_mul_f32 v213, v213, v75
    v_mul_f32 v214, v214, v75
    v_mul_f32 v215, v215, v75
    v_mul_f32 v216, v216, v75
    v_mul_f32 v217, v217, v75
    v_mul_f32 v218, v218, v75
    v_mul_f32 v219, v219, v75
    v_mul_f32 v220, v220, v75
    v_mul_f32 v221, v221, v75
    v_mul_f32 v222, v222, v75
    v_mul_f32 v223, v223, v75
    v_mul_f32 v224, v224, v75
    v_mul_f32 v225, v225, v75
    v_mul_f32 v226, v226, v75
    v_mul_f32 v227, v227, v75
    v_mul_f32 v228, v228, v75
    v_mul_f32 v229, v229, v75
    v_mul_f32 v230, v230, v75
    v_mul_f32 v231, v231, v75
    v_mul_f32 v232, v232, v75
    v_mul_f32 v233, v233, v75
    v_mul_f32 v234, v234, v75
    v_mul_f32 v235, v235, v75
    v_mul_f32 v236, v236, v75
    v_mul_f32 v237, v237, v75
    v_mul_f32 v238, v238, v75
    v_mul_f32 v239, v239, v75
    v_mul_f32 v240, v240, v75
    v_mul_f32 v241, v241, v75
    v_mul_f32 v242, v242, v75
    v_mul_f32 v243, v243, v75
    v_mul_f32 v244, v244, v75
    v_mul_f32 v245, v245, v75
    v_mul_f32 v246, v246, v75
    v_mul_f32 v247, v247, v75
    v_mul_f32 v248, v248, v75
    v_mul_f32 v249, v249, v75
    v_mul_f32 v250, v250, v75
    v_mul_f32 v251, v251, v75
    v_mul_f32 v252, v252, v75
    v_mul_f32 v253, v253, v75
    v_mul_f32 v254, v254, v75
    v_mul_f32 v255, v255, v75
    s_nop 3
    s_branch attn_rsb_14
attn_rs_15:
    s_nop 15
    v_max_f32 v74, v74, v72
    v_sub_f32 v75, v72, v74
    v_exp_f32 v75, v75
    v_mov_b32 v72, v74
    v_mul_f32 v73, v73, v75
    v_mul_f32 v128, v128, v75
    v_mul_f32 v129, v129, v75
    v_mul_f32 v130, v130, v75
    v_mul_f32 v131, v131, v75
    v_mul_f32 v132, v132, v75
    v_mul_f32 v133, v133, v75
    v_mul_f32 v134, v134, v75
    v_mul_f32 v135, v135, v75
    v_mul_f32 v136, v136, v75
    v_mul_f32 v137, v137, v75
    v_mul_f32 v138, v138, v75
    v_mul_f32 v139, v139, v75
    v_mul_f32 v140, v140, v75
    v_mul_f32 v141, v141, v75
    v_mul_f32 v142, v142, v75
    v_mul_f32 v143, v143, v75
    v_mul_f32 v144, v144, v75
    v_mul_f32 v145, v145, v75
    v_mul_f32 v146, v146, v75
    v_mul_f32 v147, v147, v75
    v_mul_f32 v148, v148, v75
    v_mul_f32 v149, v149, v75
    v_mul_f32 v150, v150, v75
    v_mul_f32 v151, v151, v75
    v_mul_f32 v152, v152, v75
    v_mul_f32 v153, v153, v75
    v_mul_f32 v154, v154, v75
    v_mul_f32 v155, v155, v75
    v_mul_f32 v156, v156, v75
    v_mul_f32 v157, v157, v75
    v_mul_f32 v158, v158, v75
    v_mul_f32 v159, v159, v75
    v_mul_f32 v160, v160, v75
    v_mul_f32 v161, v161, v75
    v_mul_f32 v162, v162, v75
    v_mul_f32 v163, v163, v75
    v_mul_f32 v164, v164, v75
    v_mul_f32 v165, v165, v75
    v_mul_f32 v166, v166, v75
    v_mul_f32 v167, v167, v75
    v_mul_f32 v168, v168, v75
    v_mul_f32 v169, v169, v75
    v_mul_f32 v170, v170, v75
    v_mul_f32 v171, v171, v75
    v_mul_f32 v172, v172, v75
    v_mul_f32 v173, v173, v75
    v_mul_f32 v174, v174, v75
    v_mul_f32 v175, v175, v75
    v_mul_f32 v176, v176, v75
    v_mul_f32 v177, v177, v75
    v_mul_f32 v178, v178, v75
    v_mul_f32 v179, v179, v75
    v_mul_f32 v180, v180, v75
    v_mul_f32 v181, v181, v75
    v_mul_f32 v182, v182, v75
    v_mul_f32 v183, v183, v75
    v_mul_f32 v184, v184, v75
    v_mul_f32 v185, v185, v75
    v_mul_f32 v186, v186, v75
    v_mul_f32 v187, v187, v75
    v_mul_f32 v188, v188, v75
    v_mul_f32 v189, v189, v75
    v_mul_f32 v190, v190, v75
    v_mul_f32 v191, v191, v75
    v_mul_f32 v192, v192, v75
    v_mul_f32 v193, v193, v75
    v_mul_f32 v194, v194, v75
    v_mul_f32 v195, v195, v75
    v_mul_f32 v196, v196, v75
    v_mul_f32 v197, v197, v75
    v_mul_f32 v198, v198, v75
    v_mul_f32 v199, v199, v75
    v_mul_f32 v200, v200, v75
    v_mul_f32 v201, v201, v75
    v_mul_f32 v202, v202, v75
    v_mul_f32 v203, v203, v75
    v_mul_f32 v204, v204, v75
    v_mul_f32 v205, v205, v75
    v_mul_f32 v206, v206, v75
    v_mul_f32 v207, v207, v75
    v_mul_f32 v208, v208, v75
    v_mul_f32 v209, v209, v75
    v_mul_f32 v210, v210, v75
    v_mul_f32 v211, v211, v75
    v_mul_f32 v212, v212, v75
    v_mul_f32 v213, v213, v75
    v_mul_f32 v214, v214, v75
    v_mul_f32 v215, v215, v75
    v_mul_f32 v216, v216, v75
    v_mul_f32 v217, v217, v75
    v_mul_f32 v218, v218, v75
    v_mul_f32 v219, v219, v75
    v_mul_f32 v220, v220, v75
    v_mul_f32 v221, v221, v75
    v_mul_f32 v222, v222, v75
    v_mul_f32 v223, v223, v75
    v_mul_f32 v224, v224, v75
    v_mul_f32 v225, v225, v75
    v_mul_f32 v226, v226, v75
    v_mul_f32 v227, v227, v75
    v_mul_f32 v228, v228, v75
    v_mul_f32 v229, v229, v75
    v_mul_f32 v230, v230, v75
    v_mul_f32 v231, v231, v75
    v_mul_f32 v232, v232, v75
    v_mul_f32 v233, v233, v75
    v_mul_f32 v234, v234, v75
    v_mul_f32 v235, v235, v75
    v_mul_f32 v236, v236, v75
    v_mul_f32 v237, v237, v75
    v_mul_f32 v238, v238, v75
    v_mul_f32 v239, v239, v75
    v_mul_f32 v240, v240, v75
    v_mul_f32 v241, v241, v75
    v_mul_f32 v242, v242, v75
    v_mul_f32 v243, v243, v75
    v_mul_f32 v244, v244, v75
    v_mul_f32 v245, v245, v75
    v_mul_f32 v246, v246, v75
    v_mul_f32 v247, v247, v75
    v_mul_f32 v248, v248, v75
    v_mul_f32 v249, v249, v75
    v_mul_f32 v250, v250, v75
    v_mul_f32 v251, v251, v75
    v_mul_f32 v252, v252, v75
    v_mul_f32 v253, v253, v75
    v_mul_f32 v254, v254, v75
    v_mul_f32 v255, v255, v75
    s_nop 3
    s_branch attn_rsb_16
attn_loader:
    s_mov_b32 s52, s58
    s_mov_b32 s53, 0
    s_mov_b32 s54, s58
    s_mov_b32 s55, 0
    s_add_u32 s86, s65, s67
    s_cmp_ge_u32 s86, 14
    s_cselect_b32 s46, 14, 0
    s_sub_u32 s86, s86, s46
    s_add_u32 s67, s67, 1
    s_lshl_b32 s86, s86, 18
    s_add_u32 s86, s86, s85
    s_add_u32 s87, s83, s84
    s_add_u32 m0, s87, 0
    s_nop 0
    buffer_load_dwordx4 v42, s[28:31], s86 offen offset:0 lds
    s_add_u32 s86, s86, 16384
    s_add_u32 m0, s87, 1024
    s_nop 0
    buffer_load_dwordx4 v43, s[28:31], s86 offen offset:0 lds
    s_add_u32 s86, s86, 16384
    s_add_u32 m0, s87, 2048
    s_nop 0
    buffer_load_dwordx4 v42, s[28:31], s86 offen offset:0 lds
    s_add_u32 s86, s86, 16384
    s_add_u32 m0, s87, 3072
    s_nop 0
    buffer_load_dwordx4 v43, s[28:31], s86 offen offset:0 lds
    s_add_u32 s86, s86, 16384
    s_add_u32 m0, s87, 4096
    s_nop 0
    buffer_load_dwordx4 v42, s[28:31], s86 offen offset:0 lds
    s_add_u32 s86, s86, 16384
    s_add_u32 m0, s87, 5120
    s_nop 0
    buffer_load_dwordx4 v43, s[28:31], s86 offen offset:0 lds
    s_add_u32 s86, s86, 16384
    s_add_u32 m0, s87, 6144
    s_nop 0
    buffer_load_dwordx4 v42, s[28:31], s86 offen offset:0 lds
    s_add_u32 s86, s86, 16384
    s_add_u32 m0, s87, 7168
    s_nop 0
    buffer_load_dwordx4 v43, s[28:31], s86 offen offset:0 lds
    s_add_u32 s86, s86, 16384
    s_add_u32 m0, s87, 8192
    s_nop 0
    buffer_load_dwordx4 v42, s[28:31], s86 offen offset:0 lds
    s_add_u32 s86, s86, 16384
    s_add_u32 m0, s87, 9216
    s_nop 0
    buffer_load_dwordx4 v43, s[28:31], s86 offen offset:0 lds
    s_add_u32 s86, s86, 16384
    s_add_u32 m0, s87, 10240
    s_nop 0
    buffer_load_dwordx4 v42, s[28:31], s86 offen offset:0 lds
    s_add_u32 s86, s86, 16384
    s_add_u32 m0, s87, 11264
    s_nop 0
    buffer_load_dwordx4 v43, s[28:31], s86 offen offset:0 lds
    s_add_u32 s86, s86, 16384
    s_add_u32 m0, s87, 12288
    s_nop 0
    buffer_load_dwordx4 v42, s[28:31], s86 offen offset:0 lds
    s_add_u32 s86, s86, 16384
    s_add_u32 m0, s87, 13312
    s_nop 0
    buffer_load_dwordx4 v43, s[28:31], s86 offen offset:0 lds
    s_add_u32 s86, s86, 16384
    s_add_u32 m0, s87, 14336
    s_nop 0
    buffer_load_dwordx4 v42, s[28:31], s86 offen offset:0 lds
    s_add_u32 s86, s86, 16384
    s_add_u32 m0, s87, 15360
    s_nop 0
    buffer_load_dwordx4 v43, s[28:31], s86 offen offset:0 lds
    s_add_u32 s83, s83, 16384
    s_and_b32 s83, s83, 65535
    s_add_u32 s55, s55, 16384
    s_and_b32 s55, s55, 65535
    s_add_u32 s86, s65, s67
    s_cmp_ge_u32 s86, 14
    s_cselect_b32 s46, 14, 0
    s_sub_u32 s86, s86, s46
    s_add_u32 s67, s67, 1
    s_lshl_b32 s86, s86, 18
    s_add_u32 s86, s86, s85
    s_add_u32 s87, s83, s84
    s_add_u32 m0, s87, 0
    s_nop 0
    buffer_load_dwordx4 v42, s[28:31], s86 offen offset:0 lds
    s_add_u32 s86, s86, 16384
    s_add_u32 m0, s87, 1024
    s_nop 0
    buffer_load_dwordx4 v43, s[28:31], s86 offen offset:0 lds
    s_add_u32 s86, s86, 16384
    s_add_u32 m0, s87, 2048
    s_nop 0
    buffer_load_dwordx4 v42, s[28:31], s86 offen offset:0 lds
    s_add_u32 s86, s86, 16384
    s_add_u32 m0, s87, 3072
    s_nop 0
    buffer_load_dwordx4 v43, s[28:31], s86 offen offset:0 lds
    s_add_u32 s86, s86, 16384
    s_add_u32 m0, s87, 4096
    s_nop 0
    buffer_load_dwordx4 v42, s[28:31], s86 offen offset:0 lds
    s_add_u32 s86, s86, 16384
    s_add_u32 m0, s87, 5120
    s_nop 0
    buffer_load_dwordx4 v43, s[28:31], s86 offen offset:0 lds
    s_add_u32 s86, s86, 16384
    s_add_u32 m0, s87, 6144
    s_nop 0
    buffer_load_dwordx4 v42, s[28:31], s86 offen offset:0 lds
    s_add_u32 s86, s86, 16384
    s_add_u32 m0, s87, 7168
    s_nop 0
    buffer_load_dwordx4 v43, s[28:31], s86 offen offset:0 lds
    s_add_u32 s86, s86, 16384
    s_add_u32 m0, s87, 8192
    s_nop 0
    buffer_load_dwordx4 v42, s[28:31], s86 offen offset:0 lds
    s_add_u32 s86, s86, 16384
    s_add_u32 m0, s87, 9216
    s_nop 0
    buffer_load_dwordx4 v43, s[28:31], s86 offen offset:0 lds
    s_add_u32 s86, s86, 16384
    s_add_u32 m0, s87, 10240
    s_nop 0
    buffer_load_dwordx4 v42, s[28:31], s86 offen offset:0 lds
    s_add_u32 s86, s86, 16384
    s_add_u32 m0, s87, 11264
    s_nop 0
    buffer_load_dwordx4 v43, s[28:31], s86 offen offset:0 lds
    s_add_u32 s86, s86, 16384
    s_add_u32 m0, s87, 12288
    s_nop 0
    buffer_load_dwordx4 v42, s[28:31], s86 offen offset:0 lds
    s_add_u32 s86, s86, 16384
    s_add_u32 m0, s87, 13312
    s_nop 0
    buffer_load_dwordx4 v43, s[28:31], s86 offen offset:0 lds
    s_add_u32 s86, s86, 16384
    s_add_u32 m0, s87, 14336
    s_nop 0
    buffer_load_dwordx4 v42, s[28:31], s86 offen offset:0 lds
    s_add_u32 s86, s86, 16384
    s_add_u32 m0, s87, 15360
    s_nop 0
    buffer_load_dwordx4 v43, s[28:31], s86 offen offset:0 lds
    s_add_u32 s83, s83, 16384
    s_and_b32 s83, s83, 65535
    s_add_u32 s55, s55, 16384
    s_and_b32 s55, s55, 65535
    s_add_u32 s86, s65, s67
    s_cmp_ge_u32 s86, 14
    s_cselect_b32 s46, 14, 0
    s_sub_u32 s86, s86, s46
    s_add_u32 s67, s67, 1
    s_lshl_b32 s86, s86, 18
    s_add_u32 s86, s86, s85
    s_add_u32 s87, s83, s84
    s_add_u32 m0, s87, 0
    s_nop 0
    buffer_load_dwordx4 v42, s[28:31], s86 offen offset:0 lds
    s_add_u32 s86, s86, 16384
    s_add_u32 m0, s87, 1024
    s_nop 0
    buffer_load_dwordx4 v43, s[28:31], s86 offen offset:0 lds
    s_add_u32 s86, s86, 16384
    s_add_u32 m0, s87, 2048
    s_nop 0
    buffer_load_dwordx4 v42, s[28:31], s86 offen offset:0 lds
    s_add_u32 s86, s86, 16384
    s_add_u32 m0, s87, 3072
    s_nop 0
    buffer_load_dwordx4 v43, s[28:31], s86 offen offset:0 lds
    s_add_u32 s86, s86, 16384
    s_add_u32 m0, s87, 4096
    s_nop 0
    buffer_load_dwordx4 v42, s[28:31], s86 offen offset:0 lds
    s_add_u32 s86, s86, 16384
    s_add_u32 m0, s87, 5120
    s_nop 0
    buffer_load_dwordx4 v43, s[28:31], s86 offen offset:0 lds
    s_add_u32 s86, s86, 16384
    s_add_u32 m0, s87, 6144
    s_nop 0
    buffer_load_dwordx4 v42, s[28:31], s86 offen offset:0 lds
    s_add_u32 s86, s86, 16384
    s_add_u32 m0, s87, 7168
    s_nop 0
    buffer_load_dwordx4 v43, s[28:31], s86 offen offset:0 lds
    s_add_u32 s86, s86, 16384
    s_add_u32 m0, s87, 8192
    s_nop 0
    buffer_load_dwordx4 v42, s[28:31], s86 offen offset:0 lds
    s_add_u32 s86, s86, 16384
    s_add_u32 m0, s87, 9216
    s_nop 0
    buffer_load_dwordx4 v43, s[28:31], s86 offen offset:0 lds
    s_add_u32 s86, s86, 16384
    s_add_u32 m0, s87, 10240
    s_nop 0
    buffer_load_dwordx4 v42, s[28:31], s86 offen offset:0 lds
    s_add_u32 s86, s86, 16384
    s_add_u32 m0, s87, 11264
    s_nop 0
    buffer_load_dwordx4 v43, s[28:31], s86 offen offset:0 lds
    s_add_u32 s86, s86, 16384
    s_add_u32 m0, s87, 12288
    s_nop 0
    buffer_load_dwordx4 v42, s[28:31], s86 offen offset:0 lds
    s_add_u32 s86, s86, 16384
    s_add_u32 m0, s87, 13312
    s_nop 0
    buffer_load_dwordx4 v43, s[28:31], s86 offen offset:0 lds
    s_add_u32 s86, s86, 16384
    s_add_u32 m0, s87, 14336
    s_nop 0
    buffer_load_dwordx4 v42, s[28:31], s86 offen offset:0 lds
    s_add_u32 s86, s86, 16384
    s_add_u32 m0, s87, 15360
    s_nop 0
    buffer_load_dwordx4 v43, s[28:31], s86 offen offset:0 lds
    s_add_u32 s83, s83, 16384
    s_and_b32 s83, s83, 65535
    s_add_u32 s55, s55, 16384
    s_and_b32 s55, s55, 65535
    s_add_u32 s86, s65, s67
    s_cmp_ge_u32 s86, 14
    s_cselect_b32 s46, 14, 0
    s_sub_u32 s86, s86, s46
    s_add_u32 s67, s67, 1
    s_lshl_b32 s86, s86, 18
    s_add_u32 s86, s86, s85
    s_add_u32 s87, s83, s84
    s_add_u32 m0, s87, 0
    s_nop 0
    buffer_load_dwordx4 v42, s[28:31], s86 offen offset:0 lds
    s_add_u32 s86, s86, 16384
    s_add_u32 m0, s87, 1024
    s_nop 0
    buffer_load_dwordx4 v43, s[28:31], s86 offen offset:0 lds
    s_add_u32 s86, s86, 16384
    s_add_u32 m0, s87, 2048
    s_nop 0
    buffer_load_dwordx4 v42, s[28:31], s86 offen offset:0 lds
    s_add_u32 s86, s86, 16384
    s_add_u32 m0, s87, 3072
    s_nop 0
    buffer_load_dwordx4 v43, s[28:31], s86 offen offset:0 lds
    s_add_u32 s86, s86, 16384
    s_add_u32 m0, s87, 4096
    s_nop 0
    buffer_load_dwordx4 v42, s[28:31], s86 offen offset:0 lds
    s_add_u32 s86, s86, 16384
    s_add_u32 m0, s87, 5120
    s_nop 0
    buffer_load_dwordx4 v43, s[28:31], s86 offen offset:0 lds
    s_add_u32 s86, s86, 16384
    s_add_u32 m0, s87, 6144
    s_nop 0
    buffer_load_dwordx4 v42, s[28:31], s86 offen offset:0 lds
    s_add_u32 s86, s86, 16384
    s_add_u32 m0, s87, 7168
    s_nop 0
    buffer_load_dwordx4 v43, s[28:31], s86 offen offset:0 lds
    s_add_u32 s86, s86, 16384
    s_add_u32 m0, s87, 8192
    s_nop 0
    buffer_load_dwordx4 v42, s[28:31], s86 offen offset:0 lds
    s_add_u32 s86, s86, 16384
    s_add_u32 m0, s87, 9216
    s_nop 0
    buffer_load_dwordx4 v43, s[28:31], s86 offen offset:0 lds
    s_add_u32 s86, s86, 16384
    s_add_u32 m0, s87, 10240
    s_nop 0
    buffer_load_dwordx4 v42, s[28:31], s86 offen offset:0 lds
    s_add_u32 s86, s86, 16384
    s_add_u32 m0, s87, 11264
    s_nop 0
    buffer_load_dwordx4 v43, s[28:31], s86 offen offset:0 lds
    s_add_u32 s86, s86, 16384
    s_add_u32 m0, s87, 12288
    s_nop 0
    buffer_load_dwordx4 v42, s[28:31], s86 offen offset:0 lds
    s_add_u32 s86, s86, 16384
    s_add_u32 m0, s87, 13312
    s_nop 0
    buffer_load_dwordx4 v43, s[28:31], s86 offen offset:0 lds
    s_add_u32 s86, s86, 16384
    s_add_u32 m0, s87, 14336
    s_nop 0
    buffer_load_dwordx4 v42, s[28:31], s86 offen offset:0 lds
    s_add_u32 s86, s86, 16384
    s_add_u32 m0, s87, 15360
    s_nop 0
    buffer_load_dwordx4 v43, s[28:31], s86 offen offset:0 lds
    s_add_u32 s83, s83, 16384
    s_and_b32 s83, s83, 65535
    s_add_u32 s55, s55, 16384
    s_and_b32 s55, s55, 65535
    s_mov_b32 s45, 0x4924925
    s_mov_b32 s46, 56
    v_add_u32 v24, 0, v1
    v_mul_hi_u32 v25, v24, s45
    v_mul_lo_u32 v26, v25, s46
    v_sub_u32 v24, v24, v26
    v_lshrrev_b32 v26, 1, v25
    v_and_b32 v26, 1, v26
    v_lshlrev_b32 v26, 2, v26
    v_xor_b32 v24, v24, v26
    v_lshlrev_b32 v24, 4, v24
    v_mul_u32_u24 v25, 896, v25
    v_add_u32 v48, v24, v25
    v_add_u32 v24, 64, v1
    v_mul_hi_u32 v25, v24, s45
    v_mul_lo_u32 v26, v25, s46
    v_sub_u32 v24, v24, v26
    v_lshrrev_b32 v26, 1, v25
    v_and_b32 v26, 1, v26
    v_lshlrev_b32 v26, 2, v26
    v_xor_b32 v24, v24, v26
    v_lshlrev_b32 v24, 4, v24
    v_mul_u32_u24 v25, 896, v25
    v_add_u32 v49, v24, v25
    v_add_u32 v24, 128, v1
    v_mul_hi_u32 v25, v24, s45
    v_mul_lo_u32 v26, v25, s46
    v_sub_u32 v24, v24, v26
    v_lshrrev_b32 v26, 1, v25
    v_and_b32 v26, 1, v26
    v_lshlrev_b32 v26, 2, v26
    v_xor_b32 v24, v24, v26
    v_lshlrev_b32 v24, 4, v24
    v_mul_u32_u24 v25, 896, v25
    v_add_u32 v50, v24, v25
    v_add_u32 v24, 192, v1
    v_mul_hi_u32 v25, v24, s45
    v_mul_lo_u32 v26, v25, s46
    v_sub_u32 v24, v24, v26
    v_lshrrev_b32 v26, 1, v25
    v_and_b32 v26, 1, v26
    v_lshlrev_b32 v26, 2, v26
    v_xor_b32 v24, v24, v26
    v_lshlrev_b32 v24, 4, v24
    v_mul_u32_u24 v25, 896, v25
    v_add_u32 v51, v24, v25
    v_add_u32 v24, 256, v1
    v_mul_hi_u32 v25, v24, s45
    v_mul_lo_u32 v26, v25, s46
    v_sub_u32 v24, v24, v26
    v_lshrrev_b32 v26, 1, v25
    v_and_b32 v26, 1, v26
    v_lshlrev_b32 v26, 2, v26
    v_xor_b32 v24, v24, v26
    v_lshlrev_b32 v24, 4, v24
    v_mul_u32_u24 v25, 896, v25
    v_add_u32 v52, v24, v25
    v_add_u32 v24, 320, v1
    v_mul_hi_u32 v25, v24, s45
    v_mul_lo_u32 v26, v25, s46
    v_sub_u32 v24, v24, v26
    v_lshrrev_b32 v26, 1, v25
    v_and_b32 v26, 1, v26
    v_lshlrev_b32 v26, 2, v26
    v_xor_b32 v24, v24, v26
    v_lshlrev_b32 v24, 4, v24
    v_mul_u32_u24 v25, 896, v25
    v_add_u32 v53, v24, v25
    v_add_u32 v24, 384, v1
    v_mul_hi_u32 v25, v24, s45
    v_mul_lo_u32 v26, v25, s46
    v_sub_u32 v24, v24, v26
    v_lshrrev_b32 v26, 1, v25
    v_and_b32 v26, 1, v26
    v_lshlrev_b32 v26, 2, v26
    v_xor_b32 v24, v24, v26
    v_lshlrev_b32 v24, 4, v24
    v_mul_u32_u24 v25, 896, v25
    v_add_u32 v54, v24, v25
    s_waitcnt vmcnt(32)
    s_barrier
    s_waitcnt vmcnt(16)
    s_barrier
    s_add_u32 s86, s65, s67
    s_cmp_ge_u32 s86, 14
    s_cselect_b32 s46, 14, 0
    s_sub_u32 s86, s86, s46
    s_add_u32 s67, s67, 1
    s_lshl_b32 s86, s86, 18
    s_add_u32 s86, s86, s85
    s_add_u32 s87, s83, s84
    s_add_u32 m0, s87, 0
    s_nop 0
    buffer_load_dwordx4 v42, s[28:31], s86 offen offset:0 lds
    s_add_u32 s86, s86, 16384
    s_add_u32 m0, s87, 1024
    s_nop 0
    buffer_load_dwordx4 v43, s[28:31], s86 offen offset:0 lds
    s_add_u32 s86, s86, 16384
    s_add_u32 m0, s87, 2048
    s_nop 0
    buffer_load_dwordx4 v42, s[28:31], s86 offen offset:0 lds
    s_add_u32 s86, s86, 16384
    s_add_u32 m0, s87, 3072
    s_nop 0
    buffer_load_dwordx4 v43, s[28:31], s86 offen offset:0 lds
    s_add_u32 s86, s86, 16384
    s_add_u32 m0, s87, 4096
    s_nop 0
    buffer_load_dwordx4 v42, s[28:31], s86 offen offset:0 lds
    s_add_u32 s86, s86, 16384
    s_add_u32 m0, s87, 5120
    s_nop 0
    buffer_load_dwordx4 v43, s[28:31], s86 offen offset:0 lds
    s_add_u32 s86, s86, 16384
    s_add_u32 m0, s87, 6144
    s_nop 0
    buffer_load_dwordx4 v42, s[28:31], s86 offen offset:0 lds
    s_add_u32 s86, s86, 16384
    s_add_u32 m0, s87, 7168
    s_nop 0
    buffer_load_dwordx4 v43, s[28:31], s86 offen offset:0 lds
    s_add_u32 s86, s86, 16384
    s_add_u32 m0, s87, 8192
    s_nop 0
    buffer_load_dwordx4 v42, s[28:31], s86 offen offset:0 lds
    s_add_u32 s86, s86, 16384
    s_add_u32 m0, s87, 9216
    s_nop 0
    buffer_load_dwordx4 v43, s[28:31], s86 offen offset:0 lds
    s_add_u32 s86, s86, 16384
    s_add_u32 m0, s87, 10240
    s_nop 0
    buffer_load_dwordx4 v42, s[28:31], s86 offen offset:0 lds
    s_add_u32 s86, s86, 16384
    s_add_u32 m0, s87, 11264
    s_nop 0
    buffer_load_dwordx4 v43, s[28:31], s86 offen offset:0 lds
    s_add_u32 s86, s86, 16384
    s_add_u32 m0, s87, 12288
    s_nop 0
    buffer_load_dwordx4 v42, s[28:31], s86 offen offset:0 lds
    s_add_u32 s86, s86, 16384
    s_add_u32 m0, s87, 13312
    s_nop 0
    buffer_load_dwordx4 v43, s[28:31], s86 offen offset:0 lds
    s_add_u32 s86, s86, 16384
    s_add_u32 m0, s87, 14336
    s_nop 0
    buffer_load_dwordx4 v42, s[28:31], s86 offen offset:0 lds
    s_add_u32 s86, s86, 16384
    s_add_u32 m0, s87, 15360
    s_nop 0
    buffer_load_dwordx4 v43, s[28:31], s86 offen offset:0 lds
    s_add_u32 s83, s83, 16384
    s_and_b32 s83, s83, 65535
    s_add_u32 s55, s55, 16384
    s_and_b32 s55, s55, 65535
    s_add_u32 s86, s65, s67
    s_cmp_ge_u32 s86, 14
    s_cselect_b32 s46, 14, 0
    s_sub_u32 s86, s86, s46
    s_add_u32 s67, s67, 1
    s_lshl_b32 s86, s86, 18
    s_add_u32 s86, s86, s85
    s_add_u32 s87, s83, s84
    s_add_u32 m0, s87, 0
    s_nop 0
    buffer_load_dwordx4 v42, s[28:31], s86 offen offset:0 lds
    s_add_u32 s86, s86, 16384
    s_add_u32 m0, s87, 1024
    s_nop 0
    buffer_load_dwordx4 v43, s[28:31], s86 offen offset:0 lds
    s_add_u32 s86, s86, 16384
    s_add_u32 m0, s87, 2048
    s_nop 0
    buffer_load_dwordx4 v42, s[28:31], s86 offen offset:0 lds
    s_add_u32 s86, s86, 16384
    s_add_u32 m0, s87, 3072
    s_nop 0
    buffer_load_dwordx4 v43, s[28:31], s86 offen offset:0 lds
    s_add_u32 s86, s86, 16384
    s_add_u32 m0, s87, 4096
    s_nop 0
    buffer_load_dwordx4 v42, s[28:31], s86 offen offset:0 lds
    s_add_u32 s86, s86, 16384
    s_add_u32 m0, s87, 5120
    s_nop 0
    buffer_load_dwordx4 v43, s[28:31], s86 offen offset:0 lds
    s_add_u32 s86, s86, 16384
    s_add_u32 m0, s87, 6144
    s_nop 0
    buffer_load_dwordx4 v42, s[28:31], s86 offen offset:0 lds
    s_add_u32 s86, s86, 16384
    s_add_u32 m0, s87, 7168
    s_nop 0
    buffer_load_dwordx4 v43, s[28:31], s86 offen offset:0 lds
    s_add_u32 s86, s86, 16384
    s_add_u32 m0, s87, 8192
    s_nop 0
    buffer_load_dwordx4 v42, s[28:31], s86 offen offset:0 lds
    s_add_u32 s86, s86, 16384
    s_add_u32 m0, s87, 9216
    s_nop 0
    buffer_load_dwordx4 v43, s[28:31], s86 offen offset:0 lds
    s_add_u32 s86, s86, 16384
    s_add_u32 m0, s87, 10240
    s_nop 0
    buffer_load_dwordx4 v42, s[28:31], s86 offen offset:0 lds
    s_add_u32 s86, s86, 16384
    s_add_u32 m0, s87, 11264
    s_nop 0
    buffer_load_dwordx4 v43, s[28:31], s86 offen offset:0 lds
    s_add_u32 s86, s86, 16384
    s_add_u32 m0, s87, 12288
    s_nop 0
    buffer_load_dwordx4 v42, s[28:31], s86 offen offset:0 lds
    s_add_u32 s86, s86, 16384
    s_add_u32 m0, s87, 13312
    s_nop 0
    buffer_load_dwordx4 v43, s[28:31], s86 offen offset:0 lds
    s_add_u32 s86, s86, 16384
    s_add_u32 m0, s87, 14336
    s_nop 0
    buffer_load_dwordx4 v42, s[28:31], s86 offen offset:0 lds
    s_add_u32 s86, s86, 16384
    s_add_u32 m0, s87, 15360
    s_nop 0
    buffer_load_dwordx4 v43, s[28:31], s86 offen offset:0 lds
    s_add_u32 s83, s83, 16384
    s_and_b32 s83, s83, 65535
    s_add_u32 s55, s55, 16384
    s_and_b32 s55, s55, 65535
    s_mov_b32 s57, 0
attn_ldloop_17:
    s_waitcnt vmcnt(32)
    s_barrier
    s_add_u32 s86, s65, s67
    s_cmp_ge_u32 s86, 14
    s_cselect_b32 s46, 14, 0
    s_sub_u32 s86, s86, s46
    s_add_u32 s67, s67, 1
    s_lshl_b32 s86, s86, 18
    s_add_u32 s86, s86, s85
    s_add_u32 s87, s83, s84
    s_add_u32 m0, s87, 0
    s_nop 0
    buffer_load_dwordx4 v42, s[28:31], s86 offen offset:0 lds
    s_add_u32 s86, s86, 16384
    s_add_u32 m0, s87, 1024
    s_nop 0
    buffer_load_dwordx4 v43, s[28:31], s86 offen offset:0 lds
    s_add_u32 s86, s86, 16384
    s_add_u32 m0, s87, 2048
    s_nop 0
    buffer_load_dwordx4 v42, s[28:31], s86 offen offset:0 lds
    s_add_u32 s86, s86, 16384
    s_add_u32 m0, s87, 3072
    s_nop 0
    buffer_load_dwordx4 v43, s[28:31], s86 offen offset:0 lds
    s_add_u32 s86, s86, 16384
    s_add_u32 m0, s87, 4096
    s_nop 0
    buffer_load_dwordx4 v42, s[28:31], s86 offen offset:0 lds
    s_add_u32 s86, s86, 16384
    s_add_u32 m0, s87, 5120
    s_nop 0
    buffer_load_dwordx4 v43, s[28:31], s86 offen offset:0 lds
    s_add_u32 s86, s86, 16384
    s_add_u32 m0, s87, 6144
    s_nop 0
    buffer_load_dwordx4 v42, s[28:31], s86 offen offset:0 lds
    s_add_u32 s86, s86, 16384
    s_add_u32 m0, s87, 7168
    s_nop 0
    buffer_load_dwordx4 v43, s[28:31], s86 offen offset:0 lds
    s_add_u32 s86, s86, 16384
    s_add_u32 m0, s87, 8192
    s_nop 0
    buffer_load_dwordx4 v42, s[28:31], s86 offen offset:0 lds
    s_add_u32 s86, s86, 16384
    s_add_u32 m0, s87, 9216
    s_nop 0
    buffer_load_dwordx4 v43, s[28:31], s86 offen offset:0 lds
    s_add_u32 s86, s86, 16384
    s_add_u32 m0, s87, 10240
    s_nop 0
    buffer_load_dwordx4 v42, s[28:31], s86 offen offset:0 lds
    s_add_u32 s86, s86, 16384
    s_add_u32 m0, s87, 11264
    s_nop 0
    buffer_load_dwordx4 v43, s[28:31], s86 offen offset:0 lds
    s_add_u32 s86, s86, 16384
    s_add_u32 m0, s87, 12288
    s_nop 0
    buffer_load_dwordx4 v42, s[28:31], s86 offen offset:0 lds
    s_add_u32 s86, s86, 16384
    s_add_u32 m0, s87, 13312
    s_nop 0
    buffer_load_dwordx4 v43, s[28:31], s86 offen offset:0 lds
    s_add_u32 s86, s86, 16384
    s_add_u32 m0, s87, 14336
    s_nop 0
    buffer_load_dwordx4 v42, s[28:31], s86 offen offset:0 lds
    s_add_u32 s86, s86, 16384
    s_add_u32 m0, s87, 15360
    s_nop 0
    buffer_load_dwordx4 v43, s[28:31], s86 offen offset:0 lds
    s_add_u32 s83, s83, 16384
    s_and_b32 s83, s83, 65535
    s_add_u32 s55, s55, 16384
    s_and_b32 s55, s55, 65535
    s_add_u32 s57, s57, 1
    s_cmp_lt_u32 s57, 7
    s_cbranch_scc1 attn_ldloop_17
    s_waitcnt vmcnt(32)
    s_barrier
    s_add_u32 s86, s65, s67
    s_cmp_ge_u32 s86, 14
    s_cselect_b32 s46, 14, 0
    s_sub_u32 s86, s86, s46
    s_add_u32 s67, s67, 1
    s_lshl_b32 s86, s86, 18
    s_add_u32 s86, s86, s85
    s_add_u32 s87, s83, s84
    s_add_u32 m0, s87, 0
    s_nop 0
    buffer_load_dwordx4 v42, s[28:31], s86 offen offset:0 lds
    s_add_u32 s86, s86, 16384
    s_add_u32 m0, s87, 1024
    s_nop 0
    buffer_load_dwordx4 v43, s[28:31], s86 offen offset:0 lds
    s_add_u32 s86, s86, 16384
    s_add_u32 m0, s87, 2048
    s_nop 0
    buffer_load_dwordx4 v42, s[28:31], s86 offen offset:0 lds
    s_add_u32 s86, s86, 16384
    s_add_u32 m0, s87, 3072
    s_nop 0
    buffer_load_dwordx4 v43, s[28:31], s86 offen offset:0 lds
    s_add_u32 s86, s86, 16384
    s_add_u32 m0, s87, 4096
    s_nop 0
    buffer_load_dwordx4 v42, s[28:31], s86 offen offset:0 lds
    s_add_u32 s86, s86, 16384
    s_add_u32 m0, s87, 5120
    s_nop 0
    buffer_load_dwordx4 v43, s[28:31], s86 offen offset:0 lds
    s_add_u32 s86, s86, 16384
    s_add_u32 m0, s87, 6144
    s_nop 0
    buffer_load_dwordx4 v42, s[28:31], s86 offen offset:0 lds
    s_add_u32 s86, s86, 16384
    s_add_u32 m0, s87, 7168
    s_nop 0
    buffer_load_dwordx4 v43, s[28:31], s86 offen offset:0 lds
    s_add_u32 s86, s86, 16384
    s_add_u32 m0, s87, 8192
    s_nop 0
    buffer_load_dwordx4 v42, s[28:31], s86 offen offset:0 lds
    s_add_u32 s86, s86, 16384
    s_add_u32 m0, s87, 9216
    s_nop 0
    buffer_load_dwordx4 v43, s[28:31], s86 offen offset:0 lds
    s_add_u32 s86, s86, 16384
    s_add_u32 m0, s87, 10240
    s_nop 0
    buffer_load_dwordx4 v42, s[28:31], s86 offen offset:0 lds
    s_add_u32 s86, s86, 16384
    s_add_u32 m0, s87, 11264
    s_nop 0
    buffer_load_dwordx4 v43, s[28:31], s86 offen offset:0 lds
    s_add_u32 s86, s86, 16384
    s_add_u32 m0, s87, 12288
    s_nop 0
    buffer_load_dwordx4 v42, s[28:31], s86 offen offset:0 lds
    s_add_u32 s86, s86, 16384
    s_add_u32 m0, s87, 13312
    s_nop 0
    buffer_load_dwordx4 v43, s[28:31], s86 offen offset:0 lds
    s_add_u32 s86, s86, 16384
    s_add_u32 m0, s87, 14336
    s_nop 0
    buffer_load_dwordx4 v42, s[28:31], s86 offen offset:0 lds
    s_add_u32 s86, s86, 16384
    s_add_u32 m0, s87, 15360
    s_nop 0
    buffer_load_dwordx4 v43, s[28:31], s86 offen offset:0 lds
    s_add_u32 s83, s83, 16384
    s_and_b32 s83, s83, 65535
    s_add_u32 s55, s55, 16384
    s_and_b32 s55, s55, 65535
    s_add_u32 m0, s53, 0
    s_add_u32 s45, s52, 0
    buffer_load_dwordx4 v32, s[20:23], s45 offen offset:0 nt lds
    buffer_load_dwordx4 v33, s[20:23], s45 offen offset:1024 nt lds
    buffer_load_dwordx4 v34, s[20:23], s45 offen offset:2048 nt lds
    buffer_load_dwordx4 v35, s[20:23], s45 offen offset:3072 nt lds
    s_add_u32 m0, s53, 4096
    s_add_u32 s45, s52, 4096
    buffer_load_dwordx4 v36, s[20:23], s45 offen offset:0 nt lds
    buffer_load_dwordx4 v37, s[20:23], s45 offen offset:1024 nt lds
    buffer_load_dwordx4 v38, s[20:23], s45 offen offset:2048 nt lds
    buffer_load_dwordx4 v39, s[20:23], s45 offen offset:3072 nt lds
    s_add_u32 m0, s53, 8192
    s_add_u32 s45, s52, 8192
    buffer_load_dwordx4 v32, s[20:23], s45 offen offset:0 nt lds
    buffer_load_dwordx4 v33, s[20:23], s45 offen offset:1024 nt lds
    buffer_load_dwordx4 v34, s[20:23], s45 offen offset:2048 nt lds
    buffer_load_dwordx4 v35, s[20:23], s45 offen offset:3072 nt lds
    s_add_u32 m0, s53, 12288
    s_add_u32 s45, s52, 12288
    buffer_load_dwordx4 v36, s[20:23], s45 offen offset:0 nt lds
    buffer_load_dwordx4 v37, s[20:23], s45 offen offset:1024 nt lds
    buffer_load_dwordx4 v38, s[20:23], s45 offen offset:2048 nt lds
    buffer_load_dwordx4 v39, s[20:23], s45 offen offset:3072 nt lds
    s_add_u32 s52, s52, 16384
    s_and_b32 s52, s52, 524287
    s_add_u32 s53, s53, 16384
    s_cmp_eq_u32 s53, 98304
    s_cselect_b32 s53, 0, s53
    s_waitcnt vmcnt(48)
    s_barrier
    s_add_u32 m0, s53, 0
    s_add_u32 s45, s52, 0
    buffer_load_dwordx4 v32, s[20:23], s45 offen offset:0 nt lds
    buffer_load_dwordx4 v33, s[20:23], s45 offen offset:1024 nt lds
    buffer_load_dwordx4 v34, s[20:23], s45 offen offset:2048 nt lds
    buffer_load_dwordx4 v35, s[20:23], s45 offen offset:3072 nt lds
    s_add_u32 m0, s53, 4096
    s_add_u32 s45, s52, 4096
    buffer_load_dwordx4 v36, s[20:23], s45 offen offset:0 nt lds
    buffer_load_dwordx4 v37, s[20:23], s45 offen offset:1024 nt lds
    buffer_load_dwordx4 v38, s[20:23], s45 offen offset:2048 nt lds
    buffer_load_dwordx4 v39, s[20:23], s45 offen offset:3072 nt lds
    s_add_u32 m0, s53, 8192
    s_add_u32 s45, s52, 8192
    buffer_load_dwordx4 v32, s[20:23], s45 offen offset:0 nt lds
    buffer_load_dwordx4 v33, s[20:23], s45 offen offset:1024 nt lds
    buffer_load_dwordx4 v34, s[20:23], s45 offen offset:2048 nt lds
    buffer_load_dwordx4 v35, s[20:23], s45 offen offset:3072 nt lds
    s_add_u32 m0, s53, 12288
    s_add_u32 s45, s52, 12288
    buffer_load_dwordx4 v36, s[20:23], s45 offen offset:0 nt lds
    buffer_load_dwordx4 v37, s[20:23], s45 offen offset:1024 nt lds
    buffer_load_dwordx4 v38, s[20:23], s45 offen offset:2048 nt lds
    buffer_load_dwordx4 v39, s[20:23], s45 offen offset:3072 nt lds
    s_add_u32 s52, s52, 16384
    s_and_b32 s52, s52, 524287
    s_add_u32 s53, s53, 16384
    s_cmp_eq_u32 s53, 98304
    s_cselect_b32 s53, 0, s53
    s_waitcnt vmcnt(48)
    s_barrier
    s_add_u32 s59, s55, 98304
    s_add_u32 m0, s59, 0
    s_add_u32 s45, s54, 0
    buffer_load_dwordx4 v40, s[24:27], s45 offen offset:0 nt lds
    buffer_load_dwordx4 v41, s[24:27], s45 offen offset:1024 nt lds
    buffer_load_dwordx4 v40, s[24:27], s45 offen offset:2048 nt lds
    buffer_load_dwordx4 v41, s[24:27], s45 offen offset:3072 nt lds
    s_add_u32 m0, s59, 4096
    s_add_u32 s45, s54, 4096
    buffer_load_dwordx4 v40, s[24:27], s45 offen offset:0 nt lds
    buffer_load_dwordx4 v41, s[24:27], s45 offen offset:1024 nt lds
    buffer_load_dwordx4 v40, s[24:27], s45 offen offset:2048 nt lds
    buffer_load_dwordx4 v41, s[24:27], s45 offen offset:3072 nt lds
    s_add_u32 m0, s59, 8192
    s_add_u32 s45, s54, 8192
    buffer_load_dwordx4 v40, s[24:27], s45 offen offset:0 nt lds
    buffer_load_dwordx4 v41, s[24:27], s45 offen offset:1024 nt lds
    buffer_load_dwordx4 v40, s[24:27], s45 offen offset:2048 nt lds
    buffer_load_dwordx4 v41, s[24:27], s45 offen offset:3072 nt lds
    s_add_u32 m0, s59, 12288
    s_add_u32 s45, s54, 12288
    buffer_load_dwordx4 v40, s[24:27], s45 offen offset:0 nt lds
    buffer_load_dwordx4 v41, s[24:27], s45 offen offset:1024 nt lds
    buffer_load_dwordx4 v40, s[24:27], s45 offen offset:2048 nt lds
    buffer_load_dwordx4 v41, s[24:27], s45 offen offset:3072 nt lds
    s_add_u32 s54, s54, 16384
    s_and_b32 s54, s54, 524287
    s_add_u32 s55, s55, 16384
    s_and_b32 s55, s55, 65535
    s_waitcnt vmcnt(48)
    s_barrier
    s_waitcnt vmcnt(48)
    s_barrier
    s_add_u32 m0, s53, 0
    s_add_u32 s45, s52, 0
    buffer_load_dwordx4 v32, s[20:23], s45 offen offset:0 nt lds
    buffer_load_dwordx4 v33, s[20:23], s45 offen offset:1024 nt lds
    buffer_load_dwordx4 v34, s[20:23], s45 offen offset:2048 nt lds
    buffer_load_dwordx4 v35, s[20:23], s45 offen offset:3072 nt lds
    s_add_u32 m0, s53, 4096
    s_add_u32 s45, s52, 4096
    buffer_load_dwordx4 v36, s[20:23], s45 offen offset:0 nt lds
    buffer_load_dwordx4 v37, s[20:23], s45 offen offset:1024 nt lds
    buffer_load_dwordx4 v38, s[20:23], s45 offen offset:2048 nt lds
    buffer_load_dwordx4 v39, s[20:23], s45 offen offset:3072 nt lds
    s_add_u32 m0, s53, 8192
    s_add_u32 s45, s52, 8192
    buffer_load_dwordx4 v32, s[20:23], s45 offen offset:0 nt lds
    buffer_load_dwordx4 v33, s[20:23], s45 offen offset:1024 nt lds
    buffer_load_dwordx4 v34, s[20:23], s45 offen offset:2048 nt lds
    buffer_load_dwordx4 v35, s[20:23], s45 offen offset:3072 nt lds
    s_add_u32 m0, s53, 12288
    s_add_u32 s45, s52, 12288
    buffer_load_dwordx4 v36, s[20:23], s45 offen offset:0 nt lds
    buffer_load_dwordx4 v37, s[20:23], s45 offen offset:1024 nt lds
    buffer_load_dwordx4 v38, s[20:23], s45 offen offset:2048 nt lds
    buffer_load_dwordx4 v39, s[20:23], s45 offen offset:3072 nt lds
    s_add_u32 s52, s52, 16384
    s_and_b32 s52, s52, 524287
    s_add_u32 s53, s53, 16384
    s_cmp_eq_u32 s53, 98304
    s_cselect_b32 s53, 0, s53
    s_add_u32 s59, s55, 98304
    s_add_u32 m0, s59, 0
    s_add_u32 s45, s54, 0
    buffer_load_dwordx4 v40, s[24:27], s45 offen offset:0 nt lds
    buffer_load_dwordx4 v41, s[24:27], s45 offen offset:1024 nt lds
    buffer_load_dwordx4 v40, s[24:27], s45 offen offset:2048 nt lds
    buffer_load_dwordx4 v41, s[24:27], s45 offen offset:3072 nt lds
    s_add_u32 m0, s59, 4096
    s_add_u32 s45, s54, 4096
    buffer_load_dwordx4 v40, s[24:27], s45 offen offset:0 nt lds
    buffer_load_dwordx4 v41, s[24:27], s45 offen offset:1024 nt lds
    buffer_load_dwordx4 v40, s[24:27], s45 offen offset:2048 nt lds
    buffer_load_dwordx4 v41, s[24:27], s45 offen offset:3072 nt lds
    s_add_u32 m0, s59, 8192
    s_add_u32 s45, s54, 8192
    buffer_load_dwordx4 v40, s[24:27], s45 offen offset:0 nt lds
    buffer_load_dwordx4 v41, s[24:27], s45 offen offset:1024 nt lds
    buffer_load_dwordx4 v40, s[24:27], s45 offen offset:2048 nt lds
    buffer_load_dwordx4 v41, s[24:27], s45 offen offset:3072 nt lds
    s_add_u32 m0, s59, 12288
    s_add_u32 s45, s54, 12288
    buffer_load_dwordx4 v40, s[24:27], s45 offen offset:0 nt lds
    buffer_load_dwordx4 v41, s[24:27], s45 offen offset:1024 nt lds
    buffer_load_dwordx4 v40, s[24:27], s45 offen offset:2048 nt lds
    buffer_load_dwordx4 v41, s[24:27], s45 offen offset:3072 nt lds
    s_add_u32 s54, s54, 16384
    s_and_b32 s54, s54, 524287
    s_add_u32 s55, s55, 16384
    s_and_b32 s55, s55, 65535
    s_add_u32 m0, s53, 0
    s_add_u32 s45, s52, 0
    buffer_load_dwordx4 v32, s[20:23], s45 offen offset:0 nt lds
    buffer_load_dwordx4 v33, s[20:23], s45 offen offset:1024 nt lds
    buffer_load_dwordx4 v34, s[20:23], s45 offen offset:2048 nt lds
    buffer_load_dwordx4 v35, s[20:23], s45 offen offset:3072 nt lds
    s_add_u32 m0, s53, 4096
    s_add_u32 s45, s52, 4096
    buffer_load_dwordx4 v36, s[20:23], s45 offen offset:0 nt lds
    buffer_load_dwordx4 v37, s[20:23], s45 offen offset:1024 nt lds
    buffer_load_dwordx4 v38, s[20:23], s45 offen offset:2048 nt lds
    buffer_load_dwordx4 v39, s[20:23], s45 offen offset:3072 nt lds
    s_add_u32 m0, s53, 8192
    s_add_u32 s45, s52, 8192
    buffer_load_dwordx4 v32, s[20:23], s45 offen offset:0 nt lds
    buffer_load_dwordx4 v33, s[20:23], s45 offen offset:1024 nt lds
    buffer_load_dwordx4 v34, s[20:23], s45 offen offset:2048 nt lds
    buffer_load_dwordx4 v35, s[20:23], s45 offen offset:3072 nt lds
    s_add_u32 m0, s53, 12288
    s_add_u32 s45, s52, 12288
    buffer_load_dwordx4 v36, s[20:23], s45 offen offset:0 nt lds
    buffer_load_dwordx4 v37, s[20:23], s45 offen offset:1024 nt lds
    buffer_load_dwordx4 v38, s[20:23], s45 offen offset:2048 nt lds
    buffer_load_dwordx4 v39, s[20:23], s45 offen offset:3072 nt lds
    s_add_u32 s52, s52, 16384
    s_and_b32 s52, s52, 524287
    s_add_u32 s53, s53, 16384
    s_cmp_eq_u32 s53, 98304
    s_cselect_b32 s53, 0, s53
    s_mov_b32 s57, 0
attn_ldloop_18:
    s_waitcnt vmcnt(48)
    s_barrier
    s_add_u32 s59, s55, 98304
    s_add_u32 m0, s59, 0
    s_add_u32 s45, s54, 0
    buffer_load_dwordx4 v40, s[24:27], s45 offen offset:0 nt lds
    buffer_load_dwordx4 v41, s[24:27], s45 offen offset:1024 nt lds
    buffer_load_dwordx4 v40, s[24:27], s45 offen offset:2048 nt lds
    buffer_load_dwordx4 v41, s[24:27], s45 offen offset:3072 nt lds
    s_add_u32 m0, s59, 4096
    s_add_u32 s45, s54, 4096
    buffer_load_dwordx4 v40, s[24:27], s45 offen offset:0 nt lds
    buffer_load_dwordx4 v41, s[24:27], s45 offen offset:1024 nt lds
    buffer_load_dwordx4 v40, s[24:27], s45 offen offset:2048 nt lds
    buffer_load_dwordx4 v41, s[24:27], s45 offen offset:3072 nt lds
    s_add_u32 m0, s59, 8192
    s_add_u32 s45, s54, 8192
    buffer_load_dwordx4 v40, s[24:27], s45 offen offset:0 nt lds
    buffer_load_dwordx4 v41, s[24:27], s45 offen offset:1024 nt lds
    buffer_load_dwordx4 v40, s[24:27], s45 offen offset:2048 nt lds
    buffer_load_dwordx4 v41, s[24:27], s45 offen offset:3072 nt lds
    s_add_u32 m0, s59, 12288
    s_add_u32 s45, s54, 12288
    buffer_load_dwordx4 v40, s[24:27], s45 offen offset:0 nt lds
    buffer_load_dwordx4 v41, s[24:27], s45 offen offset:1024 nt lds
    buffer_load_dwordx4 v40, s[24:27], s45 offen offset:2048 nt lds
    buffer_load_dwordx4 v41, s[24:27], s45 offen offset:3072 nt lds
    s_add_u32 s54, s54, 16384
    s_and_b32 s54, s54, 524287
    s_add_u32 s55, s55, 16384
    s_and_b32 s55, s55, 65535
    s_add_u32 m0, s53, 0
    s_add_u32 s45, s52, 0
    buffer_load_dwordx4 v32, s[20:23], s45 offen offset:0 nt lds
    buffer_load_dwordx4 v33, s[20:23], s45 offen offset:1024 nt lds
    buffer_load_dwordx4 v34, s[20:23], s45 offen offset:2048 nt lds
    buffer_load_dwordx4 v35, s[20:23], s45 offen offset:3072 nt lds
    s_add_u32 m0, s53, 4096
    s_add_u32 s45, s52, 4096
    buffer_load_dwordx4 v36, s[20:23], s45 offen offset:0 nt lds
    buffer_load_dwordx4 v37, s[20:23], s45 offen offset:1024 nt lds
    buffer_load_dwordx4 v38, s[20:23], s45 offen offset:2048 nt lds
    buffer_load_dwordx4 v39, s[20:23], s45 offen offset:3072 nt lds
    s_add_u32 m0, s53, 8192
    s_add_u32 s45, s52, 8192
    buffer_load_dwordx4 v32, s[20:23], s45 offen offset:0 nt lds
    buffer_load_dwordx4 v33, s[20:23], s45 offen offset:1024 nt lds
    buffer_load_dwordx4 v34, s[20:23], s45 offen offset:2048 nt lds
    buffer_load_dwordx4 v35, s[20:23], s45 offen offset:3072 nt lds
    s_add_u32 m0, s53, 12288
    s_add_u32 s45, s52, 12288
    buffer_load_dwordx4 v36, s[20:23], s45 offen offset:0 nt lds
    buffer_load_dwordx4 v37, s[20:23], s45 offen offset:1024 nt lds
    buffer_load_dwordx4 v38, s[20:23], s45 offen offset:2048 nt lds
    buffer_load_dwordx4 v39, s[20:23], s45 offen offset:3072 nt lds
    s_add_u32 s52, s52, 16384
    s_and_b32 s52, s52, 524287
    s_add_u32 s53, s53, 16384
    s_cmp_eq_u32 s53, 98304
    s_cselect_b32 s53, 0, s53
    s_add_u32 s57, s57, 1
    s_cmp_lt_u32 s57, 28
    s_cbranch_scc1 attn_ldloop_18
    s_waitcnt vmcnt(48)
    s_barrier
    s_add_u32 s59, s55, 98304
    s_add_u32 m0, s59, 0
    s_add_u32 s45, s54, 0
    buffer_load_dwordx4 v40, s[24:27], s45 offen offset:0 nt lds
    buffer_load_dwordx4 v41, s[24:27], s45 offen offset:1024 nt lds
    buffer_load_dwordx4 v40, s[24:27], s45 offen offset:2048 nt lds
    buffer_load_dwordx4 v41, s[24:27], s45 offen offset:3072 nt lds
    s_add_u32 m0, s59, 4096
    s_add_u32 s45, s54, 4096
    buffer_load_dwordx4 v40, s[24:27], s45 offen offset:0 nt lds
    buffer_load_dwordx4 v41, s[24:27], s45 offen offset:1024 nt lds
    buffer_load_dwordx4 v40, s[24:27], s45 offen offset:2048 nt lds
    buffer_load_dwordx4 v41, s[24:27], s45 offen offset:3072 nt lds
    s_add_u32 m0, s59, 8192
    s_add_u32 s45, s54, 8192
    buffer_load_dwordx4 v40, s[24:27], s45 offen offset:0 nt lds
    buffer_load_dwordx4 v41, s[24:27], s45 offen offset:1024 nt lds
    buffer_load_dwordx4 v40, s[24:27], s45 offen offset:2048 nt lds
    buffer_load_dwordx4 v41, s[24:27], s45 offen offset:3072 nt lds
    s_add_u32 m0, s59, 12288
    s_add_u32 s45, s54, 12288
    buffer_load_dwordx4 v40, s[24:27], s45 offen offset:0 nt lds
    buffer_load_dwordx4 v41, s[24:27], s45 offen offset:1024 nt lds
    buffer_load_dwordx4 v40, s[24:27], s45 offen offset:2048 nt lds
    buffer_load_dwordx4 v41, s[24:27], s45 offen offset:3072 nt lds
    s_add_u32 s54, s54, 16384
    s_and_b32 s54, s54, 524287
    s_add_u32 s55, s55, 16384
    s_and_b32 s55, s55, 65535
    s_waitcnt vmcnt(32)
    s_barrier
    s_add_u32 s59, s55, 98304
    s_add_u32 m0, s59, 0
    s_add_u32 s45, s54, 0
    buffer_load_dwordx4 v40, s[24:27], s45 offen offset:0 nt lds
    buffer_load_dwordx4 v41, s[24:27], s45 offen offset:1024 nt lds
    buffer_load_dwordx4 v40, s[24:27], s45 offen offset:2048 nt lds
    buffer_load_dwordx4 v41, s[24:27], s45 offen offset:3072 nt lds
    s_add_u32 m0, s59, 4096
    s_add_u32 s45, s54, 4096
    buffer_load_dwordx4 v40, s[24:27], s45 offen offset:0 nt lds
    buffer_load_dwordx4 v41, s[24:27], s45 offen offset:1024 nt lds
    buffer_load_dwordx4 v40, s[24:27], s45 offen offset:2048 nt lds
    buffer_load_dwordx4 v41, s[24:27], s45 offen offset:3072 nt lds
    s_add_u32 m0, s59, 8192
    s_add_u32 s45, s54, 8192
    buffer_load_dwordx4 v40, s[24:27], s45 offen offset:0 nt lds
    buffer_load_dwordx4 v41, s[24:27], s45 offen offset:1024 nt lds
    buffer_load_dwordx4 v40, s[24:27], s45 offen offset:2048 nt lds
    buffer_load_dwordx4 v41, s[24:27], s45 offen offset:3072 nt lds
    s_add_u32 m0, s59, 12288
    s_add_u32 s45, s54, 12288
    buffer_load_dwordx4 v40, s[24:27], s45 offen offset:0 nt lds
    buffer_load_dwordx4 v41, s[24:27], s45 offen offset:1024 nt lds
    buffer_load_dwordx4 v40, s[24:27], s45 offen offset:2048 nt lds
    buffer_load_dwordx4 v41, s[24:27], s45 offen offset:3072 nt lds
    s_add_u32 s54, s54, 16384
    s_and_b32 s54, s54, 524287
    s_add_u32 s55, s55, 16384
    s_and_b32 s55, s55, 65535
    s_mov_b32 m0, 57344
    s_mov_b32 s45, 0
    buffer_load_dwordx4 v48, s[76:79], s45 offen offset:0 lds
    s_mov_b32 m0, 58368
    s_mov_b32 s45, 0
    buffer_load_dwordx4 v49, s[76:79], s45 offen offset:0 lds
    s_mov_b32 m0, 59392
    s_mov_b32 s45, 0
    buffer_load_dwordx4 v50, s[76:79], s45 offen offset:0 lds
    s_mov_b32 m0, 60416
    s_mov_b32 s45, 0
    buffer_load_dwordx4 v51, s[76:79], s45 offen offset:0 lds
    s_mov_b32 m0, 61440
    s_mov_b32 s45, 0
    buffer_load_dwordx4 v52, s[76:79], s45 offen offset:0 lds
    s_mov_b32 m0, 62464
    s_mov_b32 s45, 0
    buffer_load_dwordx4 v53, s[76:79], s45 offen offset:0 lds
    s_mov_b32 m0, 63488
    s_mov_b32 s45, 0
    buffer_load_dwordx4 v54, s[76:79], s45 offen offset:0 lds
    s_mov_b32 m0, 64512
    s_mov_b32 s45, 7168
    buffer_load_dwordx4 v48, s[76:79], s45 offen offset:0 lds
    s_mov_b32 m0, 65536
    s_mov_b32 s45, 7168
    buffer_load_dwordx4 v49, s[76:79], s45 offen offset:0 lds
    s_mov_b32 m0, 66560
    s_mov_b32 s45, 7168
    buffer_load_dwordx4 v50, s[76:79], s45 offen offset:0 lds
    s_mov_b32 m0, 67584
    s_mov_b32 s45, 7168
    buffer_load_dwordx4 v51, s[76:79], s45 offen offset:0 lds
    s_mov_b32 m0, 68608
    s_mov_b32 s45, 7168
    buffer_load_dwordx4 v52, s[76:79], s45 offen offset:0 lds
    s_mov_b32 m0, 69632
    s_mov_b32 s45, 7168
    buffer_load_dwordx4 v53, s[76:79], s45 offen offset:0 lds
    s_mov_b32 m0, 70656
    s_mov_b32 s45, 7168
    buffer_load_dwordx4 v54, s[76:79], s45 offen offset:0 lds
    s_mov_b32 m0, 71680
    s_mov_b32 s45, 14336
    buffer_load_dwordx4 v48, s[76:79], s45 offen offset:0 lds
    s_mov_b32 m0, 72704
    s_mov_b32 s45, 14336
    buffer_load_dwordx4 v49, s[76:79], s45 offen offset:0 lds
    s_mov_b32 m0, 73728
    s_mov_b32 s45, 14336
    buffer_load_dwordx4 v50, s[76:79], s45 offen offset:0 lds
    s_mov_b32 m0, 74752
    s_mov_b32 s45, 14336
    buffer_load_dwordx4 v51, s[76:79], s45 offen offset:0 lds
    s_mov_b32 m0, 75776
    s_mov_b32 s45, 14336
    buffer_load_dwordx4 v52, s[76:79], s45 offen offset:0 lds
    s_mov_b32 m0, 76800
    s_mov_b32 s45, 14336
    buffer_load_dwordx4 v53, s[76:79], s45 offen offset:0 lds
    s_mov_b32 m0, 77824
    s_mov_b32 s45, 14336
    buffer_load_dwordx4 v54, s[76:79], s45 offen offset:0 lds
    s_mov_b32 m0, 78848
    s_mov_b32 s45, 21504
    buffer_load_dwordx4 v48, s[76:79], s45 offen offset:0 lds
    s_mov_b32 m0, 79872
    s_mov_b32 s45, 21504
    buffer_load_dwordx4 v49, s[76:79], s45 offen offset:0 lds
    s_mov_b32 m0, 80896
    s_mov_b32 s45, 21504
    buffer_load_dwordx4 v50, s[76:79], s45 offen offset:0 lds
    s_mov_b32 m0, 81920
    s_mov_b32 s45, 21504
    buffer_load_dwordx4 v51, s[76:79], s45 offen offset:0 lds
    s_mov_b32 m0, 82944
    s_mov_b32 s45, 21504
    buffer_load_dwordx4 v52, s[76:79], s45 offen offset:0 lds
    s_mov_b32 m0, 83968
    s_mov_b32 s45, 21504
    buffer_load_dwordx4 v53, s[76:79], s45 offen offset:0 lds
    s_mov_b32 m0, 84992
    s_mov_b32 s45, 21504
    buffer_load_dwordx4 v54, s[76:79], s45 offen offset:0 lds
    s_waitcnt vmcnt(44)
    s_barrier
    s_waitcnt vmcnt(28)
    s_barrier
    s_mov_b32 m0, 0
    s_mov_b32 s45, 28672
    buffer_load_dwordx4 v48, s[76:79], s45 offen offset:0 lds
    s_mov_b32 m0, 1024
    s_mov_b32 s45, 28672
    buffer_load_dwordx4 v49, s[76:79], s45 offen offset:0 lds
    s_mov_b32 m0, 2048
    s_mov_b32 s45, 28672
    buffer_load_dwordx4 v50, s[76:79], s45 offen offset:0 lds
    s_mov_b32 m0, 3072
    s_mov_b32 s45, 28672
    buffer_load_dwordx4 v51, s[76:79], s45 offen offset:0 lds
    s_mov_b32 m0, 4096
    s_mov_b32 s45, 28672
    buffer_load_dwordx4 v52, s[76:79], s45 offen offset:0 lds
    s_mov_b32 m0, 5120
    s_mov_b32 s45, 28672
    buffer_load_dwordx4 v53, s[76:79], s45 offen offset:0 lds
    s_mov_b32 m0, 6144
    s_mov_b32 s45, 28672
    buffer_load_dwordx4 v54, s[76:79], s45 offen offset:0 lds
    s_mov_b32 m0, 7168
    s_mov_b32 s45, 35840
    buffer_load_dwordx4 v48, s[76:79], s45 offen offset:0 lds
    s_mov_b32 m0, 8192
    s_mov_b32 s45, 35840
    buffer_load_dwordx4 v49, s[76:79], s45 offen offset:0 lds
    s_mov_b32 m0, 9216
    s_mov_b32 s45, 35840
    buffer_load_dwordx4 v50, s[76:79], s45 offen offset:0 lds
    s_mov_b32 m0, 10240
    s_mov_b32 s45, 35840
    buffer_load_dwordx4 v51, s[76:79], s45 offen offset:0 lds
    s_mov_b32 m0, 11264
    s_mov_b32 s45, 35840
    buffer_load_dwordx4 v52, s[76:79], s45 offen offset:0 lds
    s_mov_b32 m0, 12288
    s_mov_b32 s45, 35840
    buffer_load_dwordx4 v53, s[76:79], s45 offen offset:0 lds
    s_mov_b32 m0, 13312
    s_mov_b32 s45, 35840
    buffer_load_dwordx4 v54, s[76:79], s45 offen offset:0 lds
    s_mov_b32 m0, 14336
    s_mov_b32 s45, 43008
    buffer_load_dwordx4 v48, s[76:79], s45 offen offset:0 lds
    s_mov_b32 m0, 15360
    s_mov_b32 s45, 43008
    buffer_load_dwordx4 v49, s[76:79], s45 offen offset:0 lds
    s_mov_b32 m0, 16384
    s_mov_b32 s45, 43008
    buffer_load_dwordx4 v50, s[76:79], s45 offen offset:0 lds
    s_mov_b32 m0, 17408
    s_mov_b32 s45, 43008
    buffer_load_dwordx4 v51, s[76:79], s45 offen offset:0 lds
    s_mov_b32 m0, 18432
    s_mov_b32 s45, 43008
    buffer_load_dwordx4 v52, s[76:79], s45 offen offset:0 lds
    s_mov_b32 m0, 19456
    s_mov_b32 s45, 43008
    buffer_load_dwordx4 v53, s[76:79], s45 offen offset:0 lds
    s_mov_b32 m0, 20480
    s_mov_b32 s45, 43008
    buffer_load_dwordx4 v54, s[76:79], s45 offen offset:0 lds
    s_mov_b32 m0, 21504
    s_mov_b32 s45, 50176
    buffer_load_dwordx4 v48, s[76:79], s45 offen offset:0 lds
    s_mov_b32 m0, 22528
    s_mov_b32 s45, 50176
    buffer_load_dwordx4 v49, s[76:79], s45 offen offset:0 lds
    s_mov_b32 m0, 23552
    s_mov_b32 s45, 50176
    buffer_load_dwordx4 v50, s[76:79], s45 offen offset:0 lds
    s_mov_b32 m0, 24576
    s_mov_b32 s45, 50176
    buffer_load_dwordx4 v51, s[76:79], s45 offen offset:0 lds
    s_mov_b32 m0, 25600
    s_mov_b32 s45, 50176
    buffer_load_dwordx4 v52, s[76:79], s45 offen offset:0 lds
    s_mov_b32 m0, 26624
    s_mov_b32 s45, 50176
    buffer_load_dwordx4 v53, s[76:79], s45 offen offset:0 lds
    s_mov_b32 m0, 27648
    s_mov_b32 s45, 50176
    buffer_load_dwordx4 v54, s[76:79], s45 offen offset:0 lds
    s_waitcnt vmcnt(56)
    s_barrier
    s_mov_b32 m0, 28672
    s_mov_b32 s45, 57344
    buffer_load_dwordx4 v48, s[76:79], s45 offen offset:0 lds
    s_mov_b32 m0, 29696
    s_mov_b32 s45, 57344
    buffer_load_dwordx4 v49, s[76:79], s45 offen offset:0 lds
    s_mov_b32 m0, 30720
    s_mov_b32 s45, 57344
    buffer_load_dwordx4 v50, s[76:79], s45 offen offset:0 lds
    s_mov_b32 m0, 31744
    s_mov_b32 s45, 57344
    buffer_load_dwordx4 v51, s[76:79], s45 offen offset:0 lds
    s_mov_b32 m0, 32768
    s_mov_b32 s45, 57344
    buffer_load_dwordx4 v52, s[76:79], s45 offen offset:0 lds
    s_mov_b32 m0, 33792
    s_mov_b32 s45, 57344
    buffer_load_dwordx4 v53, s[76:79], s45 offen offset:0 lds
    s_mov_b32 m0, 34816
    s_mov_b32 s45, 57344
    buffer_load_dwordx4 v54, s[76:79], s45 offen offset:0 lds
    s_mov_b32 m0, 35840
    s_mov_b32 s45, 64512
    buffer_load_dwordx4 v48, s[76:79], s45 offen offset:0 lds
    s_mov_b32 m0, 36864
    s_mov_b32 s45, 64512
    buffer_load_dwordx4 v49, s[76:79], s45 offen offset:0 lds
    s_mov_b32 m0, 37888
    s_mov_b32 s45, 64512
    buffer_load_dwordx4 v50, s[76:79], s45 offen offset:0 lds
    s_mov_b32 m0, 38912
    s_mov_b32 s45, 64512
    buffer_load_dwordx4 v51, s[76:79], s45 offen offset:0 lds
    s_mov_b32 m0, 39936
    s_mov_b32 s45, 64512
    buffer_load_dwordx4 v52, s[76:79], s45 offen offset:0 lds
    s_mov_b32 m0, 40960
    s_mov_b32 s45, 64512
    buffer_load_dwordx4 v53, s[76:79], s45 offen offset:0 lds
    s_mov_b32 m0, 41984
    s_mov_b32 s45, 64512
    buffer_load_dwordx4 v54, s[76:79], s45 offen offset:0 lds
    s_mov_b32 m0, 43008
    s_mov_b32 s45, 71680
    buffer_load_dwordx4 v48, s[76:79], s45 offen offset:0 lds
    s_mov_b32 m0, 44032
    s_mov_b32 s45, 71680
    buffer_load_dwordx4 v49, s[76:79], s45 offen offset:0 lds
    s_mov_b32 m0, 45056
    s_mov_b32 s45, 71680
    buffer_load_dwordx4 v50, s[76:79], s45 offen offset:0 lds
    s_mov_b32 m0, 46080
    s_mov_b32 s45, 71680
    buffer_load_dwordx4 v51, s[76:79], s45 offen offset:0 lds
    s_mov_b32 m0, 47104
    s_mov_b32 s45, 71680
    buffer_load_dwordx4 v52, s[76:79], s45 offen offset:0 lds
    s_mov_b32 m0, 48128
    s_mov_b32 s45, 71680
    buffer_load_dwordx4 v53, s[76:79], s45 offen offset:0 lds
    s_mov_b32 m0, 49152
    s_mov_b32 s45, 71680
    buffer_load_dwordx4 v54, s[76:79], s45 offen offset:0 lds
    s_mov_b32 m0, 50176
    s_mov_b32 s45, 78848
    buffer_load_dwordx4 v48, s[76:79], s45 offen offset:0 lds
    s_mov_b32 m0, 51200
    s_mov_b32 s45, 78848
    buffer_load_dwordx4 v49, s[76:79], s45 offen offset:0 lds
    s_mov_b32 m0, 52224
    s_mov_b32 s45, 78848
    buffer_load_dwordx4 v50, s[76:79], s45 offen offset:0 lds
    s_mov_b32 m0, 53248
    s_mov_b32 s45, 78848
    buffer_load_dwordx4 v51, s[76:79], s45 offen offset:0 lds
    s_mov_b32 m0, 54272
    s_mov_b32 s45, 78848
    buffer_load_dwordx4 v52, s[76:79], s45 offen offset:0 lds
    s_mov_b32 m0, 55296
    s_mov_b32 s45, 78848
    buffer_load_dwordx4 v53, s[76:79], s45 offen offset:0 lds
    s_mov_b32 m0, 56320
    s_mov_b32 s45, 78848
    buffer_load_dwordx4 v54, s[76:79], s45 offen offset:0 lds
    s_waitcnt vmcnt(28)
    s_barrier
    s_mov_b32 m0, 98304
    s_mov_b32 s45, 86016
    buffer_load_dwordx4 v48, s[76:79], s45 offen offset:0 lds
    s_mov_b32 m0, 99328
    s_mov_b32 s45, 86016
    buffer_load_dwordx4 v49, s[76:79], s45 offen offset:0 lds
    s_mov_b32 m0, 100352
    s_mov_b32 s45, 86016
    buffer_load_dwordx4 v50, s[76:79], s45 offen offset:0 lds
    s_mov_b32 m0, 101376
    s_mov_b32 s45, 86016
    buffer_load_dwordx4 v51, s[76:79], s45 offen offset:0 lds
    s_mov_b32 m0, 102400
    s_mov_b32 s45, 86016
    buffer_load_dwordx4 v52, s[76:79], s45 offen offset:0 lds
    s_mov_b32 m0, 103424
    s_mov_b32 s45, 86016
    buffer_load_dwordx4 v53, s[76:79], s45 offen offset:0 lds
    s_mov_b32 m0, 104448
    s_mov_b32 s45, 86016
    buffer_load_dwordx4 v54, s[76:79], s45 offen offset:0 lds
    s_mov_b32 m0, 105472
    s_mov_b32 s45, 93184
    buffer_load_dwordx4 v48, s[76:79], s45 offen offset:0 lds
    s_mov_b32 m0, 106496
    s_mov_b32 s45, 93184
    buffer_load_dwordx4 v49, s[76:79], s45 offen offset:0 lds
    s_mov_b32 m0, 107520
    s_mov_b32 s45, 93184
    buffer_load_dwordx4 v50, s[76:79], s45 offen offset:0 lds
    s_mov_b32 m0, 108544
    s_mov_b32 s45, 93184
    buffer_load_dwordx4 v51, s[76:79], s45 offen offset:0 lds
    s_mov_b32 m0, 109568
    s_mov_b32 s45, 93184
    buffer_load_dwordx4 v52, s[76:79], s45 offen offset:0 lds
    s_mov_b32 m0, 110592
    s_mov_b32 s45, 93184
    buffer_load_dwordx4 v53, s[76:79], s45 offen offset:0 lds
    s_mov_b32 m0, 111616
    s_mov_b32 s45, 93184
    buffer_load_dwordx4 v54, s[76:79], s45 offen offset:0 lds
    s_mov_b32 m0, 112640
    s_mov_b32 s45, 100352
    buffer_load_dwordx4 v48, s[76:79], s45 offen offset:0 lds
    s_mov_b32 m0, 113664
    s_mov_b32 s45, 100352
    buffer_load_dwordx4 v49, s[76:79], s45 offen offset:0 lds
    s_mov_b32 m0, 114688
    s_mov_b32 s45, 100352
    buffer_load_dwordx4 v50, s[76:79], s45 offen offset:0 lds
    s_mov_b32 m0, 115712
    s_mov_b32 s45, 100352
    buffer_load_dwordx4 v51, s[76:79], s45 offen offset:0 lds
    s_mov_b32 m0, 116736
    s_mov_b32 s45, 100352
    buffer_load_dwordx4 v52, s[76:79], s45 offen offset:0 lds
    s_mov_b32 m0, 117760
    s_mov_b32 s45, 100352
    buffer_load_dwordx4 v53, s[76:79], s45 offen offset:0 lds
    s_mov_b32 m0, 118784
    s_mov_b32 s45, 100352
    buffer_load_dwordx4 v54, s[76:79], s45 offen offset:0 lds
    s_mov_b32 m0, 119808
    s_mov_b32 s45, 107520
    buffer_load_dwordx4 v48, s[76:79], s45 offen offset:0 lds
    s_mov_b32 m0, 120832
    s_mov_b32 s45, 107520
    buffer_load_dwordx4 v49, s[76:79], s45 offen offset:0 lds
    s_mov_b32 m0, 121856
    s_mov_b32 s45, 107520
    buffer_load_dwordx4 v50, s[76:79], s45 offen offset:0 lds
    s_mov_b32 m0, 122880
    s_mov_b32 s45, 107520
    buffer_load_dwordx4 v51, s[76:79], s45 offen offset:0 lds
    s_mov_b32 m0, 123904
    s_mov_b32 s45, 107520
    buffer_load_dwordx4 v52, s[76:79], s45 offen offset:0 lds
    s_mov_b32 m0, 124928
    s_mov_b32 s45, 107520
    buffer_load_dwordx4 v53, s[76:79], s45 offen offset:0 lds
    s_mov_b32 m0, 125952
    s_mov_b32 s45, 107520
    buffer_load_dwordx4 v54, s[76:79], s45 offen offset:0 lds
    s_mov_b32 m0, 126976
    s_mov_b32 s45, 114688
    buffer_load_dwordx4 v48, s[76:79], s45 offen offset:0 lds
    s_mov_b32 m0, 128000
    s_mov_b32 s45, 114688
    buffer_load_dwordx4 v49, s[76:79], s45 offen offset:0 lds
    s_mov_b32 m0, 129024
    s_mov_b32 s45, 114688
    buffer_load_dwordx4 v50, s[76:79], s45 offen offset:0 lds
    s_mov_b32 m0, 130048
    s_mov_b32 s45, 114688
    buffer_load_dwordx4 v51, s[76:79], s45 offen offset:0 lds
    s_mov_b32 m0, 131072
    s_mov_b32 s45, 114688
    buffer_load_dwordx4 v52, s[76:79], s45 offen offset:0 lds
    s_mov_b32 m0, 132096
    s_mov_b32 s45, 114688
    buffer_load_dwordx4 v53, s[76:79], s45 offen offset:0 lds
    s_mov_b32 m0, 133120
    s_mov_b32 s45, 114688
    buffer_load_dwordx4 v54, s[76:79], s45 offen offset:0 lds
    s_mov_b32 m0, 134144
    s_mov_b32 s45, 121856
    buffer_load_dwordx4 v48, s[76:79], s45 offen offset:0 lds
    s_mov_b32 m0, 135168
    s_mov_b32 s45, 121856
    buffer_load_dwordx4 v49, s[76:79], s45 offen offset:0 lds
    s_mov_b32 m0, 136192
    s_mov_b32 s45, 121856
    buffer_load_dwordx4 v50, s[76:79], s45 offen offset:0 lds
    s_mov_b32 m0, 137216
    s_mov_b32 s45, 121856
    buffer_load_dwordx4 v51, s[76:79], s45 offen offset:0 lds
    s_mov_b32 m0, 138240
    s_mov_b32 s45, 121856
    buffer_load_dwordx4 v52, s[76:79], s45 offen offset:0 lds
    s_mov_b32 m0, 139264
    s_mov_b32 s45, 121856
    buffer_load_dwordx4 v53, s[76:79], s45 offen offset:0 lds
    s_mov_b32 m0, 140288
    s_mov_b32 s45, 121856
    buffer_load_dwordx4 v54, s[76:79], s45 offen offset:0 lds
    s_mov_b32 m0, 141312
    s_mov_b32 s45, 129024
    buffer_load_dwordx4 v48, s[76:79], s45 offen offset:0 lds
    s_mov_b32 m0, 142336
    s_mov_b32 s45, 129024
    buffer_load_dwordx4 v49, s[76:79], s45 offen offset:0 lds
    s_mov_b32 m0, 143360
    s_mov_b32 s45, 129024
    buffer_load_dwordx4 v50, s[76:79], s45 offen offset:0 lds
    s_mov_b32 m0, 144384
    s_mov_b32 s45, 129024
    buffer_load_dwordx4 v51, s[76:79], s45 offen offset:0 lds
    s_mov_b32 m0, 145408
    s_mov_b32 s45, 129024
    buffer_load_dwordx4 v52, s[76:79], s45 offen offset:0 lds
    s_mov_b32 m0, 146432
    s_mov_b32 s45, 129024
    buffer_load_dwordx4 v53, s[76:79], s45 offen offset:0 lds
    s_mov_b32 m0, 147456
    s_mov_b32 s45, 129024
    buffer_load_dwordx4 v54, s[76:79], s45 offen offset:0 lds
    s_mov_b32 m0, 148480
    s_mov_b32 s45, 136192
    buffer_load_dwordx4 v48, s[76:79], s45 offen offset:0 lds
    s_mov_b32 m0, 149504
    s_mov_b32 s45, 136192
    buffer_load_dwordx4 v49, s[76:79], s45 offen offset:0 lds
    s_mov_b32 m0, 150528
    s_mov_b32 s45, 136192
    buffer_load_dwordx4 v50, s[76:79], s45 offen offset:0 lds
    s_mov_b32 m0, 151552
    s_mov_b32 s45, 136192
    buffer_load_dwordx4 v51, s[76:79], s45 offen offset:0 lds
    s_mov_b32 m0, 152576
    s_mov_b32 s45, 136192
    buffer_load_dwordx4 v52, s[76:79], s45 offen offset:0 lds
    s_mov_b32 m0, 153600
    s_mov_b32 s45, 136192
    buffer_load_dwordx4 v53, s[76:79], s45 offen offset:0 lds
    s_mov_b32 m0, 154624
    s_mov_b32 s45, 136192
    buffer_load_dwordx4 v54, s[76:79], s45 offen offset:0 lds
    s_waitcnt vmcnt(56)
    s_barrier
    s_mov_b32 m0, 57344
    s_mov_b32 s45, 143360
    buffer_load_dwordx4 v48, s[76:79], s45 offen offset:0 lds
    s_mov_b32 m0, 58368
    s_mov_b32 s45, 143360
    buffer_load_dwordx4 v49, s[76:79], s45 offen offset:0 lds
    s_mov_b32 m0, 59392
    s_mov_b32 s45, 143360
    buffer_load_dwordx4 v50, s[76:79], s45 offen offset:0 lds
    s_mov_b32 m0, 60416
    s_mov_b32 s45, 143360
    buffer_load_dwordx4 v51, s[76:79], s45 offen offset:0 lds
    s_mov_b32 m0, 61440
    s_mov_b32 s45, 143360
    buffer_load_dwordx4 v52, s[76:79], s45 offen offset:0 lds
    s_mov_b32 m0, 62464
    s_mov_b32 s45, 143360
    buffer_load_dwordx4 v53, s[76:79], s45 offen offset:0 lds
    s_mov_b32 m0, 63488
    s_mov_b32 s45, 143360
    buffer_load_dwordx4 v54, s[76:79], s45 offen offset:0 lds
    s_mov_b32 m0, 64512
    s_mov_b32 s45, 150528
    buffer_load_dwordx4 v48, s[76:79], s45 offen offset:0 lds
    s_mov_b32 m0, 65536
    s_mov_b32 s45, 150528
    buffer_load_dwordx4 v49, s[76:79], s45 offen offset:0 lds
    s_mov_b32 m0, 66560
    s_mov_b32 s45, 150528
    buffer_load_dwordx4 v50, s[76:79], s45 offen offset:0 lds
    s_mov_b32 m0, 67584
    s_mov_b32 s45, 150528
    buffer_load_dwordx4 v51, s[76:79], s45 offen offset:0 lds
    s_mov_b32 m0, 68608
    s_mov_b32 s45, 150528
    buffer_load_dwordx4 v52, s[76:79], s45 offen offset:0 lds
    s_mov_b32 m0, 69632
    s_mov_b32 s45, 150528
    buffer_load_dwordx4 v53, s[76:79], s45 offen offset:0 lds
    s_mov_b32 m0, 70656
    s_mov_b32 s45, 150528
    buffer_load_dwordx4 v54, s[76:79], s45 offen offset:0 lds
    s_mov_b32 m0, 71680
    s_mov_b32 s45, 157696
    buffer_load_dwordx4 v48, s[76:79], s45 offen offset:0 lds
    s_mov_b32 m0, 72704
    s_mov_b32 s45, 157696
    buffer_load_dwordx4 v49, s[76:79], s45 offen offset:0 lds
    s_mov_b32 m0, 73728
    s_mov_b32 s45, 157696
    buffer_load_dwordx4 v50, s[76:79], s45 offen offset:0 lds
    s_mov_b32 m0, 74752
    s_mov_b32 s45, 157696
    buffer_load_dwordx4 v51, s[76:79], s45 offen offset:0 lds
    s_mov_b32 m0, 75776
    s_mov_b32 s45, 157696
    buffer_load_dwordx4 v52, s[76:79], s45 offen offset:0 lds
    s_mov_b32 m0, 76800
    s_mov_b32 s45, 157696
    buffer_load_dwordx4 v53, s[76:79], s45 offen offset:0 lds
    s_mov_b32 m0, 77824
    s_mov_b32 s45, 157696
    buffer_load_dwordx4 v54, s[76:79], s45 offen offset:0 lds
    s_mov_b32 m0, 78848
    s_mov_b32 s45, 164864
    buffer_load_dwordx4 v48, s[76:79], s45 offen offset:0 lds
    s_mov_b32 m0, 79872
    s_mov_b32 s45, 164864
    buffer_load_dwordx4 v49, s[76:79], s45 offen offset:0 lds
    s_mov_b32 m0, 80896
    s_mov_b32 s45, 164864
    buffer_load_dwordx4 v50, s[76:79], s45 offen offset:0 lds
    s_mov_b32 m0, 81920
    s_mov_b32 s45, 164864
    buffer_load_dwordx4 v51, s[76:79], s45 offen offset:0 lds
    s_mov_b32 m0, 82944
    s_mov_b32 s45, 164864
    buffer_load_dwordx4 v52, s[76:79], s45 offen offset:0 lds
    s_mov_b32 m0, 83968
    s_mov_b32 s45, 164864
    buffer_load_dwordx4 v53, s[76:79], s45 offen offset:0 lds
    s_mov_b32 m0, 84992
    s_mov_b32 s45, 164864
    buffer_load_dwordx4 v54, s[76:79], s45 offen offset:0 lds
    s_waitcnt vmcnt(56)
    s_barrier
    s_mov_b32 m0, 0
    s_mov_b32 s45, 172032
    buffer_load_dwordx4 v48, s[76:79], s45 offen offset:0 lds
    s_mov_b32 m0, 1024
    s_mov_b32 s45, 172032
    buffer_load_dwordx4 v49, s[76:79], s45 offen offset:0 lds
    s_mov_b32 m0, 2048
    s_mov_b32 s45, 172032
    buffer_load_dwordx4 v50, s[76:79], s45 offen offset:0 lds
    s_mov_b32 m0, 3072
    s_mov_b32 s45, 172032
    buffer_load_dwordx4 v51, s[76:79], s45 offen offset:0 lds
    s_mov_b32 m0, 4096
    s_mov_b32 s45, 172032
    buffer_load_dwordx4 v52, s[76:79], s45 offen offset:0 lds
    s_mov_b32 m0, 5120
    s_mov_b32 s45, 172032
    buffer_load_dwordx4 v53, s[76:79], s45 offen offset:0 lds
    s_mov_b32 m0, 6144
    s_mov_b32 s45, 172032
    buffer_load_dwordx4 v54, s[76:79], s45 offen offset:0 lds
    s_mov_b32 m0, 7168
    s_mov_b32 s45, 179200
    buffer_load_dwordx4 v48, s[76:79], s45 offen offset:0 lds
    s_mov_b32 m0, 8192
    s_mov_b32 s45, 179200
    buffer_load_dwordx4 v49, s[76:79], s45 offen offset:0 lds
    s_mov_b32 m0, 9216
    s_mov_b32 s45, 179200
    buffer_load_dwordx4 v50, s[76:79], s45 offen offset:0 lds
    s_mov_b32 m0, 10240
    s_mov_b32 s45, 179200
    buffer_load_dwordx4 v51, s[76:79], s45 offen offset:0 lds
    s_mov_b32 m0, 11264
    s_mov_b32 s45, 179200
    buffer_load_dwordx4 v52, s[76:79], s45 offen offset:0 lds
    s_mov_b32 m0, 12288
    s_mov_b32 s45, 179200
    buffer_load_dwordx4 v53, s[76:79], s45 offen offset:0 lds
    s_mov_b32 m0, 13312
    s_mov_b32 s45, 179200
    buffer_load_dwordx4 v54, s[76:79], s45 offen offset:0 lds
    s_mov_b32 m0, 14336
    s_mov_b32 s45, 186368
    buffer_load_dwordx4 v48, s[76:79], s45 offen offset:0 lds
    s_mov_b32 m0, 15360
    s_mov_b32 s45, 186368
    buffer_load_dwordx4 v49, s[76:79], s45 offen offset:0 lds
    s_mov_b32 m0, 16384
    s_mov_b32 s45, 186368
    buffer_load_dwordx4 v50, s[76:79], s45 offen offset:0 lds
    s_mov_b32 m0, 17408
    s_mov_b32 s45, 186368
    buffer_load_dwordx4 v51, s[76:79], s45 offen offset:0 lds
    s_mov_b32 m0, 18432
    s_mov_b32 s45, 186368
    buffer_load_dwordx4 v52, s[76:79], s45 offen offset:0 lds
    s_mov_b32 m0, 19456
    s_mov_b32 s45, 186368
    buffer_load_dwordx4 v53, s[76:79], s45 offen offset:0 lds
    s_mov_b32 m0, 20480
    s_mov_b32 s45, 186368
    buffer_load_dwordx4 v54, s[76:79], s45 offen offset:0 lds
    s_mov_b32 m0, 21504
    s_mov_b32 s45, 193536
    buffer_load_dwordx4 v48, s[76:79], s45 offen offset:0 lds
    s_mov_b32 m0, 22528
    s_mov_b32 s45, 193536
    buffer_load_dwordx4 v49, s[76:79], s45 offen offset:0 lds
    s_mov_b32 m0, 23552
    s_mov_b32 s45, 193536
    buffer_load_dwordx4 v50, s[76:79], s45 offen offset:0 lds
    s_mov_b32 m0, 24576
    s_mov_b32 s45, 193536
    buffer_load_dwordx4 v51, s[76:79], s45 offen offset:0 lds
    s_mov_b32 m0, 25600
    s_mov_b32 s45, 193536
    buffer_load_dwordx4 v52, s[76:79], s45 offen offset:0 lds
    s_mov_b32 m0, 26624
    s_mov_b32 s45, 193536
    buffer_load_dwordx4 v53, s[76:79], s45 offen offset:0 lds
    s_mov_b32 m0, 27648
    s_mov_b32 s45, 193536
    buffer_load_dwordx4 v54, s[76:79], s45 offen offset:0 lds
    s_waitcnt vmcnt(56)
    s_barrier
    s_mov_b32 m0, 28672
    s_mov_b32 s45, 200704
    buffer_load_dwordx4 v48, s[76:79], s45 offen offset:0 lds
    s_mov_b32 m0, 29696
    s_mov_b32 s45, 200704
    buffer_load_dwordx4 v49, s[76:79], s45 offen offset:0 lds
    s_mov_b32 m0, 30720
    s_mov_b32 s45, 200704
    buffer_load_dwordx4 v50, s[76:79], s45 offen offset:0 lds
    s_mov_b32 m0, 31744
    s_mov_b32 s45, 200704
    buffer_load_dwordx4 v51, s[76:79], s45 offen offset:0 lds
    s_mov_b32 m0, 32768
    s_mov_b32 s45, 200704
    buffer_load_dwordx4 v52, s[76:79], s45 offen offset:0 lds
    s_mov_b32 m0, 33792
    s_mov_b32 s45, 200704
    buffer_load_dwordx4 v53, s[76:79], s45 offen offset:0 lds
    s_mov_b32 m0, 34816
    s_mov_b32 s45, 200704
    buffer_load_dwordx4 v54, s[76:79], s45 offen offset:0 lds
    s_mov_b32 m0, 35840
    s_mov_b32 s45, 207872
    buffer_load_dwordx4 v48, s[76:79], s45 offen offset:0 lds
    s_mov_b32 m0, 36864
    s_mov_b32 s45, 207872
    buffer_load_dwordx4 v49, s[76:79], s45 offen offset:0 lds
    s_mov_b32 m0, 37888
    s_mov_b32 s45, 207872
    buffer_load_dwordx4 v50, s[76:79], s45 offen offset:0 lds
    s_mov_b32 m0, 38912
    s_mov_b32 s45, 207872
    buffer_load_dwordx4 v51, s[76:79], s45 offen offset:0 lds
    s_mov_b32 m0, 39936
    s_mov_b32 s45, 207872
    buffer_load_dwordx4 v52, s[76:79], s45 offen offset:0 lds
    s_mov_b32 m0, 40960
    s_mov_b32 s45, 207872
    buffer_load_dwordx4 v53, s[76:79], s45 offen offset:0 lds
    s_mov_b32 m0, 41984
    s_mov_b32 s45, 207872
    buffer_load_dwordx4 v54, s[76:79], s45 offen offset:0 lds
    s_mov_b32 m0, 43008
    s_mov_b32 s45, 215040
    buffer_load_dwordx4 v48, s[76:79], s45 offen offset:0 lds
    s_mov_b32 m0, 44032
    s_mov_b32 s45, 215040
    buffer_load_dwordx4 v49, s[76:79], s45 offen offset:0 lds
    s_mov_b32 m0, 45056
    s_mov_b32 s45, 215040
    buffer_load_dwordx4 v50, s[76:79], s45 offen offset:0 lds
    s_mov_b32 m0, 46080
    s_mov_b32 s45, 215040
    buffer_load_dwordx4 v51, s[76:79], s45 offen offset:0 lds
    s_mov_b32 m0, 47104
    s_mov_b32 s45, 215040
    buffer_load_dwordx4 v52, s[76:79], s45 offen offset:0 lds
    s_mov_b32 m0, 48128
    s_mov_b32 s45, 215040
    buffer_load_dwordx4 v53, s[76:79], s45 offen offset:0 lds
    s_mov_b32 m0, 49152
    s_mov_b32 s45, 215040
    buffer_load_dwordx4 v54, s[76:79], s45 offen offset:0 lds
    s_mov_b32 m0, 50176
    s_mov_b32 s45, 222208
    buffer_load_dwordx4 v48, s[76:79], s45 offen offset:0 lds
    s_mov_b32 m0, 51200
    s_mov_b32 s45, 222208
    buffer_load_dwordx4 v49, s[76:79], s45 offen offset:0 lds
    s_mov_b32 m0, 52224
    s_mov_b32 s45, 222208
    buffer_load_dwordx4 v50, s[76:79], s45 offen offset:0 lds
    s_mov_b32 m0, 53248
    s_mov_b32 s45, 222208
    buffer_load_dwordx4 v51, s[76:79], s45 offen offset:0 lds
    s_mov_b32 m0, 54272
    s_mov_b32 s45, 222208
    buffer_load_dwordx4 v52, s[76:79], s45 offen offset:0 lds
    s_mov_b32 m0, 55296
    s_mov_b32 s45, 222208
    buffer_load_dwordx4 v53, s[76:79], s45 offen offset:0 lds
    s_mov_b32 m0, 56320
    s_mov_b32 s45, 222208
    buffer_load_dwordx4 v54, s[76:79], s45 offen offset:0 lds
    s_waitcnt vmcnt(56)
    s_barrier
    s_waitcnt vmcnt(28)
    s_barrier
    s_waitcnt vmcnt(0)
    s_barrier
    s_waitcnt vmcnt(0)
    s_barrier
attn_end:
    s_endpgm
.section .rodata,"a"
.p2align 6
.amdhsa_kernel attn_kernel
  .amdhsa_next_free_vgpr 512
  .amdhsa_next_free_sgpr 102
  .amdhsa_accum_offset 256
  .amdhsa_group_segment_fixed_size 0
  .amdhsa_kernarg_size 64
  .amdhsa_user_sgpr_count 2
  .amdhsa_user_sgpr_kernarg_segment_ptr 1
  .amdhsa_system_sgpr_workgroup_id_x 1
.end_amdhsa_kernel
.text
.globl reduce_kernel
.p2align 8
.type reduce_kernel,@function
reduce_kernel:
    s_cmp_ge_u32 s2, 336
    s_cbranch_scc1 reduce_end
    s_load_dwordx16 s[4:19], s[0:1], 0
    s_lshl_b32 s40, s2, 8
    v_add_u32 v1, s40, v0
    v_lshlrev_b32 v2, 4, v1
    v_lshrrev_b32 v4, 6, v1
    s_mov_b32 s41, 0x924924a
    v_mul_hi_u32 v5, v4, s41
    v_mul_u32_u24 v6, 28, v5
    v_sub_u32 v4, v4, v6
    v_and_b32 v6, 31, v1
    v_lshl_add_u32 v5, v5, 5, v6
    v_mul_u32_u24 v3, 896, v5
    v_lshl_add_u32 v3, v4, 5, v3
    v_bfe_u32 v5, v1, 5, 1
    v_lshl_add_u32 v3, v5, 4, v3
    s_waitcnt lgkmcnt(0)
    s_mov_b32 s20, s18
    s_mov_b32 s21, s19
    s_mov_b32 s22, 0x1500000
    s_mov_b32 s23, 0x00020000
    s_mov_b32 s24, s14
    s_mov_b32 s25, s15
    s_mov_b32 s26, 0x150000
    s_mov_b32 s27, 0x00020000
    s_mov_b32 s44, 0
    s_mov_b32 s45, 1376256
    s_mov_b32 s46, 2752512
    s_mov_b32 s47, 4128768
    s_mov_b32 s48, 5505024
    s_mov_b32 s49, 6881280
    s_mov_b32 s50, 8257536
    s_mov_b32 s51, 9633792
    s_mov_b32 s52, 11010048
    s_mov_b32 s53, 12386304
    s_mov_b32 s54, 13762560
    s_mov_b32 s55, 15138816
    s_mov_b32 s56, 16515072
    s_mov_b32 s57, 17891328
    s_mov_b32 s58, 19267584
    s_mov_b32 s59, 20643840
    buffer_load_dwordx4 v[16:19], v2, s[20:23], s44 offen offset:0
    buffer_load_dwordx4 v[20:23], v2, s[20:23], s45 offen offset:0
    buffer_load_dwordx4 v[24:27], v2, s[20:23], s46 offen offset:0
    buffer_load_dwordx4 v[28:31], v2, s[20:23], s47 offen offset:0
    buffer_load_dwordx4 v[32:35], v2, s[20:23], s48 offen offset:0
    buffer_load_dwordx4 v[36:39], v2, s[20:23], s49 offen offset:0
    buffer_load_dwordx4 v[40:43], v2, s[20:23], s50 offen offset:0
    buffer_load_dwordx4 v[44:47], v2, s[20:23], s51 offen offset:0
    buffer_load_dwordx4 v[48:51], v2, s[20:23], s52 offen offset:0
    buffer_load_dwordx4 v[52:55], v2, s[20:23], s53 offen offset:0
    buffer_load_dwordx4 v[56:59], v2, s[20:23], s54 offen offset:0
    buffer_load_dwordx4 v[60:63], v2, s[20:23], s55 offen offset:0
    buffer_load_dwordx4 v[64:67], v2, s[20:23], s56 offen offset:0
    buffer_load_dwordx4 v[68:71], v2, s[20:23], s57 offen offset:0
    buffer_load_dwordx4 v[72:75], v2, s[20:23], s58 offen offset:0
    buffer_load_dwordx4 v[76:79], v2, s[20:23], s59 offen offset:0
    s_waitcnt vmcnt(15)
    v_lshlrev_b32 v8, 16, v16
    v_and_b32 v9, 0xffff0000, v16
    v_lshlrev_b32 v10, 16, v17
    v_and_b32 v11, 0xffff0000, v17
    v_lshlrev_b32 v12, 16, v18
    v_and_b32 v13, 0xffff0000, v18
    v_lshlrev_b32 v14, 16, v19
    v_and_b32 v15, 0xffff0000, v19
    s_waitcnt vmcnt(14)
    v_lshlrev_b32 v80, 16, v20
    v_and_b32 v81, 0xffff0000, v20
    v_add_f32 v8, v8, v80
    v_add_f32 v9, v9, v81
    v_lshlrev_b32 v80, 16, v21
    v_and_b32 v81, 0xffff0000, v21
    v_add_f32 v10, v10, v80
    v_add_f32 v11, v11, v81
    v_lshlrev_b32 v80, 16, v22
    v_and_b32 v81, 0xffff0000, v22
    v_add_f32 v12, v12, v80
    v_add_f32 v13, v13, v81
    v_lshlrev_b32 v80, 16, v23
    v_and_b32 v81, 0xffff0000, v23
    v_add_f32 v14, v14, v80
    v_add_f32 v15, v15, v81
    s_waitcnt vmcnt(13)
    v_lshlrev_b32 v80, 16, v24
    v_and_b32 v81, 0xffff0000, v24
    v_add_f32 v8, v8, v80
    v_add_f32 v9, v9, v81
    v_lshlrev_b32 v80, 16, v25
    v_and_b32 v81, 0xffff0000, v25
    v_add_f32 v10, v10, v80
    v_add_f32 v11, v11, v81
    v_lshlrev_b32 v80, 16, v26
    v_and_b32 v81, 0xffff0000, v26
    v_add_f32 v12, v12, v80
    v_add_f32 v13, v13, v81
    v_lshlrev_b32 v80, 16, v27
    v_and_b32 v81, 0xffff0000, v27
    v_add_f32 v14, v14, v80
    v_add_f32 v15, v15, v81
    s_waitcnt vmcnt(12)
    v_lshlrev_b32 v80, 16, v28
    v_and_b32 v81, 0xffff0000, v28
    v_add_f32 v8, v8, v80
    v_add_f32 v9, v9, v81
    v_lshlrev_b32 v80, 16, v29
    v_and_b32 v81, 0xffff0000, v29
    v_add_f32 v10, v10, v80
    v_add_f32 v11, v11, v81
    v_lshlrev_b32 v80, 16, v30
    v_and_b32 v81, 0xffff0000, v30
    v_add_f32 v12, v12, v80
    v_add_f32 v13, v13, v81
    v_lshlrev_b32 v80, 16, v31
    v_and_b32 v81, 0xffff0000, v31
    v_add_f32 v14, v14, v80
    v_add_f32 v15, v15, v81
    s_waitcnt vmcnt(11)
    v_lshlrev_b32 v80, 16, v32
    v_and_b32 v81, 0xffff0000, v32
    v_add_f32 v8, v8, v80
    v_add_f32 v9, v9, v81
    v_lshlrev_b32 v80, 16, v33
    v_and_b32 v81, 0xffff0000, v33
    v_add_f32 v10, v10, v80
    v_add_f32 v11, v11, v81
    v_lshlrev_b32 v80, 16, v34
    v_and_b32 v81, 0xffff0000, v34
    v_add_f32 v12, v12, v80
    v_add_f32 v13, v13, v81
    v_lshlrev_b32 v80, 16, v35
    v_and_b32 v81, 0xffff0000, v35
    v_add_f32 v14, v14, v80
    v_add_f32 v15, v15, v81
    s_waitcnt vmcnt(10)
    v_lshlrev_b32 v80, 16, v36
    v_and_b32 v81, 0xffff0000, v36
    v_add_f32 v8, v8, v80
    v_add_f32 v9, v9, v81
    v_lshlrev_b32 v80, 16, v37
    v_and_b32 v81, 0xffff0000, v37
    v_add_f32 v10, v10, v80
    v_add_f32 v11, v11, v81
    v_lshlrev_b32 v80, 16, v38
    v_and_b32 v81, 0xffff0000, v38
    v_add_f32 v12, v12, v80
    v_add_f32 v13, v13, v81
    v_lshlrev_b32 v80, 16, v39
    v_and_b32 v81, 0xffff0000, v39
    v_add_f32 v14, v14, v80
    v_add_f32 v15, v15, v81
    s_waitcnt vmcnt(9)
    v_lshlrev_b32 v80, 16, v40
    v_and_b32 v81, 0xffff0000, v40
    v_add_f32 v8, v8, v80
    v_add_f32 v9, v9, v81
    v_lshlrev_b32 v80, 16, v41
    v_and_b32 v81, 0xffff0000, v41
    v_add_f32 v10, v10, v80
    v_add_f32 v11, v11, v81
    v_lshlrev_b32 v80, 16, v42
    v_and_b32 v81, 0xffff0000, v42
    v_add_f32 v12, v12, v80
    v_add_f32 v13, v13, v81
    v_lshlrev_b32 v80, 16, v43
    v_and_b32 v81, 0xffff0000, v43
    v_add_f32 v14, v14, v80
    v_add_f32 v15, v15, v81
    s_waitcnt vmcnt(8)
    v_lshlrev_b32 v80, 16, v44
    v_and_b32 v81, 0xffff0000, v44
    v_add_f32 v8, v8, v80
    v_add_f32 v9, v9, v81
    v_lshlrev_b32 v80, 16, v45
    v_and_b32 v81, 0xffff0000, v45
    v_add_f32 v10, v10, v80
    v_add_f32 v11, v11, v81
    v_lshlrev_b32 v80, 16, v46
    v_and_b32 v81, 0xffff0000, v46
    v_add_f32 v12, v12, v80
    v_add_f32 v13, v13, v81
    v_lshlrev_b32 v80, 16, v47
    v_and_b32 v81, 0xffff0000, v47
    v_add_f32 v14, v14, v80
    v_add_f32 v15, v15, v81
    s_waitcnt vmcnt(7)
    v_lshlrev_b32 v80, 16, v48
    v_and_b32 v81, 0xffff0000, v48
    v_add_f32 v8, v8, v80
    v_add_f32 v9, v9, v81
    v_lshlrev_b32 v80, 16, v49
    v_and_b32 v81, 0xffff0000, v49
    v_add_f32 v10, v10, v80
    v_add_f32 v11, v11, v81
    v_lshlrev_b32 v80, 16, v50
    v_and_b32 v81, 0xffff0000, v50
    v_add_f32 v12, v12, v80
    v_add_f32 v13, v13, v81
    v_lshlrev_b32 v80, 16, v51
    v_and_b32 v81, 0xffff0000, v51
    v_add_f32 v14, v14, v80
    v_add_f32 v15, v15, v81
    s_waitcnt vmcnt(6)
    v_lshlrev_b32 v80, 16, v52
    v_and_b32 v81, 0xffff0000, v52
    v_add_f32 v8, v8, v80
    v_add_f32 v9, v9, v81
    v_lshlrev_b32 v80, 16, v53
    v_and_b32 v81, 0xffff0000, v53
    v_add_f32 v10, v10, v80
    v_add_f32 v11, v11, v81
    v_lshlrev_b32 v80, 16, v54
    v_and_b32 v81, 0xffff0000, v54
    v_add_f32 v12, v12, v80
    v_add_f32 v13, v13, v81
    v_lshlrev_b32 v80, 16, v55
    v_and_b32 v81, 0xffff0000, v55
    v_add_f32 v14, v14, v80
    v_add_f32 v15, v15, v81
    s_waitcnt vmcnt(5)
    v_lshlrev_b32 v80, 16, v56
    v_and_b32 v81, 0xffff0000, v56
    v_add_f32 v8, v8, v80
    v_add_f32 v9, v9, v81
    v_lshlrev_b32 v80, 16, v57
    v_and_b32 v81, 0xffff0000, v57
    v_add_f32 v10, v10, v80
    v_add_f32 v11, v11, v81
    v_lshlrev_b32 v80, 16, v58
    v_and_b32 v81, 0xffff0000, v58
    v_add_f32 v12, v12, v80
    v_add_f32 v13, v13, v81
    v_lshlrev_b32 v80, 16, v59
    v_and_b32 v81, 0xffff0000, v59
    v_add_f32 v14, v14, v80
    v_add_f32 v15, v15, v81
    s_waitcnt vmcnt(4)
    v_lshlrev_b32 v80, 16, v60
    v_and_b32 v81, 0xffff0000, v60
    v_add_f32 v8, v8, v80
    v_add_f32 v9, v9, v81
    v_lshlrev_b32 v80, 16, v61
    v_and_b32 v81, 0xffff0000, v61
    v_add_f32 v10, v10, v80
    v_add_f32 v11, v11, v81
    v_lshlrev_b32 v80, 16, v62
    v_and_b32 v81, 0xffff0000, v62
    v_add_f32 v12, v12, v80
    v_add_f32 v13, v13, v81
    v_lshlrev_b32 v80, 16, v63
    v_and_b32 v81, 0xffff0000, v63
    v_add_f32 v14, v14, v80
    v_add_f32 v15, v15, v81
    s_waitcnt vmcnt(3)
    v_lshlrev_b32 v80, 16, v64
    v_and_b32 v81, 0xffff0000, v64
    v_add_f32 v8, v8, v80
    v_add_f32 v9, v9, v81
    v_lshlrev_b32 v80, 16, v65
    v_and_b32 v81, 0xffff0000, v65
    v_add_f32 v10, v10, v80
    v_add_f32 v11, v11, v81
    v_lshlrev_b32 v80, 16, v66
    v_and_b32 v81, 0xffff0000, v66
    v_add_f32 v12, v12, v80
    v_add_f32 v13, v13, v81
    v_lshlrev_b32 v80, 16, v67
    v_and_b32 v81, 0xffff0000, v67
    v_add_f32 v14, v14, v80
    v_add_f32 v15, v15, v81
    s_waitcnt vmcnt(2)
    v_lshlrev_b32 v80, 16, v68
    v_and_b32 v81, 0xffff0000, v68
    v_add_f32 v8, v8, v80
    v_add_f32 v9, v9, v81
    v_lshlrev_b32 v80, 16, v69
    v_and_b32 v81, 0xffff0000, v69
    v_add_f32 v10, v10, v80
    v_add_f32 v11, v11, v81
    v_lshlrev_b32 v80, 16, v70
    v_and_b32 v81, 0xffff0000, v70
    v_add_f32 v12, v12, v80
    v_add_f32 v13, v13, v81
    v_lshlrev_b32 v80, 16, v71
    v_and_b32 v81, 0xffff0000, v71
    v_add_f32 v14, v14, v80
    v_add_f32 v15, v15, v81
    s_waitcnt vmcnt(1)
    v_lshlrev_b32 v80, 16, v72
    v_and_b32 v81, 0xffff0000, v72
    v_add_f32 v8, v8, v80
    v_add_f32 v9, v9, v81
    v_lshlrev_b32 v80, 16, v73
    v_and_b32 v81, 0xffff0000, v73
    v_add_f32 v10, v10, v80
    v_add_f32 v11, v11, v81
    v_lshlrev_b32 v80, 16, v74
    v_and_b32 v81, 0xffff0000, v74
    v_add_f32 v12, v12, v80
    v_add_f32 v13, v13, v81
    v_lshlrev_b32 v80, 16, v75
    v_and_b32 v81, 0xffff0000, v75
    v_add_f32 v14, v14, v80
    v_add_f32 v15, v15, v81
    s_waitcnt vmcnt(0)
    v_lshlrev_b32 v80, 16, v76
    v_and_b32 v81, 0xffff0000, v76
    v_add_f32 v8, v8, v80
    v_add_f32 v9, v9, v81
    v_lshlrev_b32 v80, 16, v77
    v_and_b32 v81, 0xffff0000, v77
    v_add_f32 v10, v10, v80
    v_add_f32 v11, v11, v81
    v_lshlrev_b32 v80, 16, v78
    v_and_b32 v81, 0xffff0000, v78
    v_add_f32 v12, v12, v80
    v_add_f32 v13, v13, v81
    v_lshlrev_b32 v80, 16, v79
    v_and_b32 v81, 0xffff0000, v79
    v_add_f32 v14, v14, v80
    v_add_f32 v15, v15, v81
    v_cvt_pk_bf16_f32 v84, v8, v9
    v_cvt_pk_bf16_f32 v85, v10, v11
    v_cvt_pk_bf16_f32 v86, v12, v13
    v_cvt_pk_bf16_f32 v87, v14, v15
    buffer_store_dwordx4 v[84:87], v3, s[24:27], 0 offen offset:0
reduce_end:
    s_endpgm
.section .rodata,"a"
.p2align 6
.amdhsa_kernel reduce_kernel
  .amdhsa_next_free_vgpr 88
  .amdhsa_next_free_sgpr 102
  .amdhsa_accum_offset 88
  .amdhsa_group_segment_fixed_size 0
  .amdhsa_kernarg_size 64
  .amdhsa_user_sgpr_count 2
  .amdhsa_user_sgpr_kernarg_segment_ptr 1
  .amdhsa_system_sgpr_workgroup_id_x 1
.end_amdhsa_kernel
.text
```
